```python
import torch

def _softmax(x, axis=-1):
    return torch.softmax(x, dim=axis)
def _gelu(x):
    return torch.nn.functional.gelu(x, approximate="tanh")
def _silu(x):
    return torch.nn.functional.silu(x)
def _sigmoid(x):
    return torch.sigmoid(x)
def _layernorm(x, axis=-1, eps=1e-5):
    m = x.mean(dim=axis, keepdim=True)
    v = x.var(dim=axis, keepdim=True, unbiased=False)
    return (x - m) / torch.sqrt(v + eps)
def _scatter_add(tgt, idx, src, axis=0):
    return tgt.clone().index_add_(axis, idx, src)
def _segment_sum(src, seg, n):
    out = torch.zeros((n,) + src.shape[1:], dtype=src.dtype)
    return out.index_add_(0, seg, src)
def _pad(x, pw):
    flat = tuple(v for pair in reversed(pw) for v in pair)
    return torch.nn.functional.pad(x, flat)

kernel_name = 'sequential_preLN__grouped_kv_mqa__swiglu_ffn__prompt'

def setup_inputs():

    _w = (lambda a: (lambda t: t.to(torch.bfloat16) if t.is_floating_point() else t)(torch.as_tensor(a)))
    def _A_setup():
        B, S, D, H = 1, 2048, 512, 32
        Dh = D // H
        return {
            "x": _w((lambda *s: torch.randn(*s, dtype=torch.bfloat16) * 0.05)(B, S, D)),
            "wq": _w((lambda *s: torch.randn(*s, dtype=torch.bfloat16) * 0.05)(D, H * Dh)),
            "wk": _w((lambda *s: torch.randn(*s, dtype=torch.bfloat16) * 0.05)(D, Dh)),
            "wv": _w((lambda *s: torch.randn(*s, dtype=torch.bfloat16) * 0.05)(D, Dh)),
            "wo": _w((lambda *s: torch.randn(*s, dtype=torch.bfloat16) * 0.05)(H * Dh, D)),
        }
    _A_in = _A_setup()

    def _B_setup():
        B, S, D, F = 1, 2048, 512, 1376
        return {
            "x": _w((lambda *s: torch.randn(*s, dtype=torch.bfloat16) * 0.05)(B, S, D)),
            "w_gate": _w((lambda *s: torch.randn(*s, dtype=torch.bfloat16) * 0.05)(D, F)),
            "w_up": _w((lambda *s: torch.randn(*s, dtype=torch.bfloat16) * 0.05)(D, F)),
            "w_down": _w((lambda *s: torch.randn(*s, dtype=torch.bfloat16) * 0.05)(F, D)),
        }
    _B_in = _B_setup()

    return {
        "A_x": _A_in["x"],
        "A_wq": _A_in["wq"],
        "A_wk": _A_in["wk"],
        "A_wv": _A_in["wv"],
        "A_wo": _A_in["wo"],
        "B_x": _B_in["x"],
        "B_w_gate": _B_in["w_gate"],
        "B_w_up": _B_in["w_up"],
        "B_w_down": _B_in["w_down"],
    }

def reference(A_x, A_wq, A_wk, A_wv, A_wo, B_x, B_w_gate, B_w_up, B_w_down):
    def _A_ref(x, wq, wk, wv, wo):
        B, S, D = x.shape
        H = 32
        Dh = D // H
        q = (lambda x, *d: x.permute(*d))((x @ wq).reshape(B, S, H, Dh), 0, 2, 1, 3)
        k = x @ wk
        v = x @ wv
        scores = torch.einsum("bhqd,bkd->bhqk", q, k) * (Dh ** -0.5)
        p = _softmax(scores, axis=-1)
        o = torch.einsum("bhqk,bkd->bhqd", p, v)
        return (lambda x, *d: x.permute(*d))(o, 0, 2, 1, 3).reshape(B, S, H * Dh) @ wo

    def _B_ref(x, w_gate, w_up, w_down):
        g = _silu(x @ w_gate)
        u = x @ w_up
        return (g * u) @ w_down

    x = A_x
    h = x + _A_ref(_layernorm(x, axis=-1), A_wq, A_wk, A_wv, A_wo)
    h2 = h + _B_ref(_layernorm(h, axis=-1), B_w_gate, B_w_up, B_w_down)
    return h2
```

```asm
; @launch kernel=sequential_preLN__grouped_kv_mqa__swiglu_ffn__prompt_kernel grid=(256,1,1) block=(256,1,1) lds=163840
; @launch kernel=attn_kernel grid=(256,1,1) block=(1024,1,1) lds=163840
; @launch kernel=ffn_kernel grid=(256,1,1) block=(256,1,1) lds=163840
.amdgcn_target "amdgcn-amd-amdhsa--gfx950"
.text
.globl sequential_preLN__grouped_kv_mqa__swiglu_ffn__prompt_kernel
.p2align 8
.type sequential_preLN__grouped_kv_mqa__swiglu_ffn__prompt_kernel,@function
sequential_preLN__grouped_kv_mqa__swiglu_ffn__prompt_kernel:
    s_cmp_ge_u32 s2, 256
    s_cbranch_scc1 sequenti_end1
    s_load_dwordx8 s[24:31], s[0:1], 0
    s_load_dwordx2 s[32:33], s[0:1], 88
    v_and_b32 v1, 63, v0
    v_lshrrev_b32 v2, 6, v0
    s_nop 1
    v_readfirstlane_b32 s3, v2
    s_and_b32 s48, s2, 7
    s_lshl_b32 s48, s48, 2
    s_bfe_u32 s49, s2, 0x20003
    s_add_u32 s48, s48, s49
    s_lshr_b32 s49, s2, 5
    v_lshrrev_b32 v3, 4, v1
    s_lshl_b32 s50, s3, 2
    v_add_u32 v3, s50, v3
    v_and_b32 v4, 15, v1
    v_xor_b32 v4, v4, v3
    v_lshlrev_b32 v4, 4, v4
    s_lshl_b32 s51, s48, 6
    v_add_u32 v3, s51, v3
    v_lshl_add_u32 v4, v3, 10, v4
    v_lshrrev_b32 v3, 3, v1
    s_lshl_b32 s50, s3, 3
    v_add_u32 v3, s50, v3
    v_and_b32 v5, 7, v1
    v_bfe_u32 v6, v1, 4, 1
    v_lshlrev_b32 v6, 2, v6
    v_xor_b32 v5, v5, v6
    v_lshlrev_b32 v5, 4, v5
    v_lshl_add_u32 v5, v3, 10, v5
    s_lshl_b32 s50, s49, 7
    v_add_u32 v5, s50, v5
    v_lshlrev_b32 v6, 4, v1
    s_lshl_b32 s52, s3, 10
    s_and_b32 s56, s3, 1
    s_lshr_b32 s57, s3, 1
    s_lshl_b32 s62, s56, 11
    s_and_b32 s50, s48, 7
    s_lshl_b32 s63, s57, 8
    s_or_b32 s50, s50, s63
    s_cmp_eq_u32 s50, s49
    s_cselect_b32 s53, 1, 0
    s_waitcnt lgkmcnt(0)
    s_mov_b32 s4, s24
    s_and_b32 s5, s25, 0xffff
    s_mov_b32 s6, 0x200000
    s_mov_b32 s7, 0x00020000
    s_add_u32 m0, s52, 0
    s_mov_b32 s54, 0
    buffer_load_dwordx4 v4, s[4:7], s54 offen lds
    s_add_u32 m0, s52, 4096
    s_mov_b32 s54, 16384
    buffer_load_dwordx4 v4, s[4:7], s54 offen lds
    s_add_u32 m0, s52, 8192
    s_mov_b32 s54, 32768
    buffer_load_dwordx4 v4, s[4:7], s54 offen lds
    s_add_u32 m0, s52, 12288
    s_mov_b32 s54, 49152
    buffer_load_dwordx4 v4, s[4:7], s54 offen lds
    s_add_u32 m0, s52, 16384
    s_mov_b32 s54, 256
    buffer_load_dwordx4 v4, s[4:7], s54 offen lds
    s_add_u32 m0, s52, 20480
    s_mov_b32 s54, 16640
    buffer_load_dwordx4 v4, s[4:7], s54 offen lds
    s_add_u32 m0, s52, 24576
    s_mov_b32 s54, 33024
    buffer_load_dwordx4 v4, s[4:7], s54 offen lds
    s_add_u32 m0, s52, 28672
    s_mov_b32 s54, 49408
    buffer_load_dwordx4 v4, s[4:7], s54 offen lds
    s_add_u32 m0, s52, 32768
    s_mov_b32 s54, 512
    buffer_load_dwordx4 v4, s[4:7], s54 offen lds
    s_add_u32 m0, s52, 36864
    s_mov_b32 s54, 16896
    buffer_load_dwordx4 v4, s[4:7], s54 offen lds
    s_add_u32 m0, s52, 40960
    s_mov_b32 s54, 33280
    buffer_load_dwordx4 v4, s[4:7], s54 offen lds
    s_add_u32 m0, s52, 45056
    s_mov_b32 s54, 49664
    buffer_load_dwordx4 v4, s[4:7], s54 offen lds
    s_add_u32 m0, s52, 49152
    s_mov_b32 s54, 768
    buffer_load_dwordx4 v4, s[4:7], s54 offen lds
    s_add_u32 m0, s52, 53248
    s_mov_b32 s54, 17152
    buffer_load_dwordx4 v4, s[4:7], s54 offen lds
    s_add_u32 m0, s52, 57344
    s_mov_b32 s54, 33536
    buffer_load_dwordx4 v4, s[4:7], s54 offen lds
    s_add_u32 m0, s52, 61440
    s_mov_b32 s54, 49920
    buffer_load_dwordx4 v4, s[4:7], s54 offen lds
    s_mov_b32 s8, s26
    s_and_b32 s9, s27, 0xffff
    s_mov_b32 s10, 0x80000
    s_mov_b32 s11, 0x00020000
    s_mov_b32 s12, s28
    s_and_b32 s13, s29, 0xffff
    s_mov_b32 s14, 0x4000
    s_mov_b32 s15, 0x00020000
    s_mov_b32 s16, s30
    s_and_b32 s17, s31, 0xffff
    s_mov_b32 s18, 0x4000
    s_mov_b32 s19, 0x00020000
    s_mov_b32 s20, s32
    s_and_b32 s21, s33, 0xffff
    s_mov_b32 s22, 0x10000000
    s_mov_b32 s23, 0x00020000
    v_and_b32 v7, 31, v1
    s_lshl_b32 s58, s56, 5
    v_add_u32 v7, s58, v7
    v_lshrrev_b32 v8, 5, v1
    v_and_b32 v9, 15, v7
    v_xor_b32 v9, v9, v8
    v_lshlrev_b32 v9, 4, v9
    v_lshl_add_u32 v9, v7, 8, v9
    v_xor_b32 v16, 0, v9
    v_xor_b32 v17, 32, v9
    v_xor_b32 v18, 64, v9
    v_xor_b32 v19, 96, v9
    v_xor_b32 v20, 128, v9
    v_xor_b32 v21, 160, v9
    v_xor_b32 v22, 192, v9
    v_xor_b32 v23, 224, v9
    v_lshrrev_b32 v7, 5, v1
    v_lshlrev_b32 v7, 3, v7
    v_bfe_u32 v10, v1, 2, 2
    v_add_u32 v7, v7, v10
    v_bfe_u32 v10, v1, 4, 1
    v_lshlrev_b32 v10, 5, v10
    v_and_b32 v11, 3, v1
    v_lshl_add_u32 v10, v11, 3, v10
    s_lshl_b32 s58, s57, 6
    v_add_u32 v10, s58, v10
    v_bfe_u32 v11, v1, 3, 1
    v_lshlrev_b32 v11, 6, v11
    v_xor_b32 v10, v10, v11
    v_lshl_add_u32 v10, v7, 7, v10
    v_add_u32 v10, 0x10000, v10
    v_and_b32 v11, 3, v1
    v_lshlrev_b32 v11, 3, v11
    v_lshl_add_u32 v11, v7, 5, v11
    v_bfe_u32 v12, v1, 4, 1
    v_lshl_add_u32 v11, v12, 14, v11
    v_add_u32 v11, 0x20000, v11
    v_mov_b32 v24, 0x3f803f80
    v_mov_b32 v25, 0x3f803f80
    v_mov_b32 v26, 0x3f803f80
    v_mov_b32 v27, 0x3f803f80
    v_mov_b32 v28, 0
    v_mov_b32 v29, 0
    v_mov_b32 v30, 0
    v_mov_b32 v31, 0
    s_cmp_lg_u32 s53, 0
    s_cbranch_scc1 sequenti_kvp3
    s_waitcnt vmcnt(12)
    s_barrier
    ds_read_b128 v[96:99], v16 offset:0
    ds_read_b128 v[100:103], v17 offset:0
    ds_read_b128 v[104:107], v18 offset:0
    ds_read_b128 v[108:111], v19 offset:0
    ds_read_b128 v[112:115], v20 offset:0
    ds_read_b128 v[116:119], v21 offset:0
    ds_read_b128 v[120:123], v22 offset:0
    ds_read_b128 v[124:127], v23 offset:0
    s_add_u32 m0, s52, 65536
    s_mov_b32 s54, 0
    buffer_load_dwordx4 v5, s[8:11], s54 offen lds
    s_add_u32 m0, s52, 69632
    s_mov_b32 s54, 32768
    buffer_load_dwordx4 v5, s[8:11], s54 offen lds
    s_add_u32 m0, s52, 73728
    s_mov_b32 s54, 65536
    buffer_load_dwordx4 v5, s[8:11], s54 offen lds
    s_add_u32 m0, s52, 77824
    s_mov_b32 s54, 98304
    buffer_load_dwordx4 v5, s[8:11], s54 offen lds
    s_waitcnt lgkmcnt(7)
    v_dot2c_f32_bf16 v28, v96, v24
    v_dot2c_f32_bf16 v29, v96, v96
    v_dot2c_f32_bf16 v30, v97, v24
    v_dot2c_f32_bf16 v31, v97, v97
    v_dot2c_f32_bf16 v28, v98, v24
    v_dot2c_f32_bf16 v29, v98, v98
    v_dot2c_f32_bf16 v30, v99, v24
    v_dot2c_f32_bf16 v31, v99, v99
    s_waitcnt lgkmcnt(6)
    v_dot2c_f32_bf16 v28, v100, v24
    v_dot2c_f32_bf16 v29, v100, v100
    v_dot2c_f32_bf16 v30, v101, v24
    v_dot2c_f32_bf16 v31, v101, v101
    v_dot2c_f32_bf16 v28, v102, v24
    v_dot2c_f32_bf16 v29, v102, v102
    v_dot2c_f32_bf16 v30, v103, v24
    v_dot2c_f32_bf16 v31, v103, v103
    s_waitcnt lgkmcnt(5)
    v_dot2c_f32_bf16 v28, v104, v24
    v_dot2c_f32_bf16 v29, v104, v104
    v_dot2c_f32_bf16 v30, v105, v24
    v_dot2c_f32_bf16 v31, v105, v105
    v_dot2c_f32_bf16 v28, v106, v24
    v_dot2c_f32_bf16 v29, v106, v106
    v_dot2c_f32_bf16 v30, v107, v24
    v_dot2c_f32_bf16 v31, v107, v107
    s_waitcnt lgkmcnt(4)
    v_dot2c_f32_bf16 v28, v108, v24
    v_dot2c_f32_bf16 v29, v108, v108
    v_dot2c_f32_bf16 v30, v109, v24
    v_dot2c_f32_bf16 v31, v109, v109
    v_dot2c_f32_bf16 v28, v110, v24
    v_dot2c_f32_bf16 v29, v110, v110
    v_dot2c_f32_bf16 v30, v111, v24
    v_dot2c_f32_bf16 v31, v111, v111
    s_waitcnt lgkmcnt(3)
    v_dot2c_f32_bf16 v28, v112, v24
    v_dot2c_f32_bf16 v29, v112, v112
    v_dot2c_f32_bf16 v30, v113, v24
    v_dot2c_f32_bf16 v31, v113, v113
    v_dot2c_f32_bf16 v28, v114, v24
    v_dot2c_f32_bf16 v29, v114, v114
    v_dot2c_f32_bf16 v30, v115, v24
    v_dot2c_f32_bf16 v31, v115, v115
    s_waitcnt lgkmcnt(2)
    v_dot2c_f32_bf16 v28, v116, v24
    v_dot2c_f32_bf16 v29, v116, v116
    v_dot2c_f32_bf16 v30, v117, v24
    v_dot2c_f32_bf16 v31, v117, v117
    v_dot2c_f32_bf16 v28, v118, v24
    v_dot2c_f32_bf16 v29, v118, v118
    v_dot2c_f32_bf16 v30, v119, v24
    v_dot2c_f32_bf16 v31, v119, v119
    s_waitcnt lgkmcnt(1)
    v_dot2c_f32_bf16 v28, v120, v24
    v_dot2c_f32_bf16 v29, v120, v120
    v_dot2c_f32_bf16 v30, v121, v24
    v_dot2c_f32_bf16 v31, v121, v121
    v_dot2c_f32_bf16 v28, v122, v24
    v_dot2c_f32_bf16 v29, v122, v122
    v_dot2c_f32_bf16 v30, v123, v24
    v_dot2c_f32_bf16 v31, v123, v123
    s_waitcnt lgkmcnt(0)
    v_dot2c_f32_bf16 v28, v124, v24
    v_dot2c_f32_bf16 v29, v124, v124
    v_dot2c_f32_bf16 v30, v125, v24
    v_dot2c_f32_bf16 v31, v125, v125
    v_dot2c_f32_bf16 v28, v126, v24
    v_dot2c_f32_bf16 v29, v126, v126
    v_dot2c_f32_bf16 v30, v127, v24
    v_dot2c_f32_bf16 v31, v127, v127
    s_waitcnt vmcnt(12)
    s_barrier
    ds_read_b128 v[128:131], v16 offset:16384
    ds_read_b128 v[132:135], v17 offset:16384
    ds_read_b128 v[136:139], v18 offset:16384
    ds_read_b128 v[140:143], v19 offset:16384
    ds_read_b128 v[144:147], v20 offset:16384
    ds_read_b128 v[148:151], v21 offset:16384
    ds_read_b128 v[152:155], v22 offset:16384
    ds_read_b128 v[156:159], v23 offset:16384
    s_add_u32 m0, s52, 81920
    s_mov_b32 s54, 131072
    buffer_load_dwordx4 v5, s[8:11], s54 offen lds
    s_add_u32 m0, s52, 86016
    s_mov_b32 s54, 163840
    buffer_load_dwordx4 v5, s[8:11], s54 offen lds
    s_add_u32 m0, s52, 90112
    s_mov_b32 s54, 196608
    buffer_load_dwordx4 v5, s[8:11], s54 offen lds
    s_add_u32 m0, s52, 94208
    s_mov_b32 s54, 229376
    buffer_load_dwordx4 v5, s[8:11], s54 offen lds
    s_waitcnt lgkmcnt(7)
    v_dot2c_f32_bf16 v28, v128, v24
    v_dot2c_f32_bf16 v29, v128, v128
    v_dot2c_f32_bf16 v30, v129, v24
    v_dot2c_f32_bf16 v31, v129, v129
    v_dot2c_f32_bf16 v28, v130, v24
    v_dot2c_f32_bf16 v29, v130, v130
    v_dot2c_f32_bf16 v30, v131, v24
    v_dot2c_f32_bf16 v31, v131, v131
    s_waitcnt lgkmcnt(6)
    v_dot2c_f32_bf16 v28, v132, v24
    v_dot2c_f32_bf16 v29, v132, v132
    v_dot2c_f32_bf16 v30, v133, v24
    v_dot2c_f32_bf16 v31, v133, v133
    v_dot2c_f32_bf16 v28, v134, v24
    v_dot2c_f32_bf16 v29, v134, v134
    v_dot2c_f32_bf16 v30, v135, v24
    v_dot2c_f32_bf16 v31, v135, v135
    s_waitcnt lgkmcnt(5)
    v_dot2c_f32_bf16 v28, v136, v24
    v_dot2c_f32_bf16 v29, v136, v136
    v_dot2c_f32_bf16 v30, v137, v24
    v_dot2c_f32_bf16 v31, v137, v137
    v_dot2c_f32_bf16 v28, v138, v24
    v_dot2c_f32_bf16 v29, v138, v138
    v_dot2c_f32_bf16 v30, v139, v24
    v_dot2c_f32_bf16 v31, v139, v139
    s_waitcnt lgkmcnt(4)
    v_dot2c_f32_bf16 v28, v140, v24
    v_dot2c_f32_bf16 v29, v140, v140
    v_dot2c_f32_bf16 v30, v141, v24
    v_dot2c_f32_bf16 v31, v141, v141
    v_dot2c_f32_bf16 v28, v142, v24
    v_dot2c_f32_bf16 v29, v142, v142
    v_dot2c_f32_bf16 v30, v143, v24
    v_dot2c_f32_bf16 v31, v143, v143
    s_waitcnt lgkmcnt(3)
    v_dot2c_f32_bf16 v28, v144, v24
    v_dot2c_f32_bf16 v29, v144, v144
    v_dot2c_f32_bf16 v30, v145, v24
    v_dot2c_f32_bf16 v31, v145, v145
    v_dot2c_f32_bf16 v28, v146, v24
    v_dot2c_f32_bf16 v29, v146, v146
    v_dot2c_f32_bf16 v30, v147, v24
    v_dot2c_f32_bf16 v31, v147, v147
    s_waitcnt lgkmcnt(2)
    v_dot2c_f32_bf16 v28, v148, v24
    v_dot2c_f32_bf16 v29, v148, v148
    v_dot2c_f32_bf16 v30, v149, v24
    v_dot2c_f32_bf16 v31, v149, v149
    v_dot2c_f32_bf16 v28, v150, v24
    v_dot2c_f32_bf16 v29, v150, v150
    v_dot2c_f32_bf16 v30, v151, v24
    v_dot2c_f32_bf16 v31, v151, v151
    s_waitcnt lgkmcnt(1)
    v_dot2c_f32_bf16 v28, v152, v24
    v_dot2c_f32_bf16 v29, v152, v152
    v_dot2c_f32_bf16 v30, v153, v24
    v_dot2c_f32_bf16 v31, v153, v153
    v_dot2c_f32_bf16 v28, v154, v24
    v_dot2c_f32_bf16 v29, v154, v154
    v_dot2c_f32_bf16 v30, v155, v24
    v_dot2c_f32_bf16 v31, v155, v155
    s_waitcnt lgkmcnt(0)
    v_dot2c_f32_bf16 v28, v156, v24
    v_dot2c_f32_bf16 v29, v156, v156
    v_dot2c_f32_bf16 v30, v157, v24
    v_dot2c_f32_bf16 v31, v157, v157
    v_dot2c_f32_bf16 v28, v158, v24
    v_dot2c_f32_bf16 v29, v158, v158
    v_dot2c_f32_bf16 v30, v159, v24
    v_dot2c_f32_bf16 v31, v159, v159
    s_waitcnt vmcnt(12)
    s_barrier
    ds_read_b128 v[160:163], v16 offset:32768
    ds_read_b128 v[164:167], v17 offset:32768
    ds_read_b128 v[168:171], v18 offset:32768
    ds_read_b128 v[172:175], v19 offset:32768
    ds_read_b128 v[176:179], v20 offset:32768
    ds_read_b128 v[180:183], v21 offset:32768
    ds_read_b128 v[184:187], v22 offset:32768
    ds_read_b128 v[188:191], v23 offset:32768
    s_add_u32 m0, s52, 98304
    s_mov_b32 s54, 262144
    buffer_load_dwordx4 v5, s[8:11], s54 offen lds
    s_add_u32 m0, s52, 102400
    s_mov_b32 s54, 294912
    buffer_load_dwordx4 v5, s[8:11], s54 offen lds
    s_add_u32 m0, s52, 106496
    s_mov_b32 s54, 327680
    buffer_load_dwordx4 v5, s[8:11], s54 offen lds
    s_add_u32 m0, s52, 110592
    s_mov_b32 s54, 360448
    buffer_load_dwordx4 v5, s[8:11], s54 offen lds
    s_waitcnt lgkmcnt(7)
    v_dot2c_f32_bf16 v28, v160, v24
    v_dot2c_f32_bf16 v29, v160, v160
    v_dot2c_f32_bf16 v30, v161, v24
    v_dot2c_f32_bf16 v31, v161, v161
    v_dot2c_f32_bf16 v28, v162, v24
    v_dot2c_f32_bf16 v29, v162, v162
    v_dot2c_f32_bf16 v30, v163, v24
    v_dot2c_f32_bf16 v31, v163, v163
    s_waitcnt lgkmcnt(6)
    v_dot2c_f32_bf16 v28, v164, v24
    v_dot2c_f32_bf16 v29, v164, v164
    v_dot2c_f32_bf16 v30, v165, v24
    v_dot2c_f32_bf16 v31, v165, v165
    v_dot2c_f32_bf16 v28, v166, v24
    v_dot2c_f32_bf16 v29, v166, v166
    v_dot2c_f32_bf16 v30, v167, v24
    v_dot2c_f32_bf16 v31, v167, v167
    s_waitcnt lgkmcnt(5)
    v_dot2c_f32_bf16 v28, v168, v24
    v_dot2c_f32_bf16 v29, v168, v168
    v_dot2c_f32_bf16 v30, v169, v24
    v_dot2c_f32_bf16 v31, v169, v169
    v_dot2c_f32_bf16 v28, v170, v24
    v_dot2c_f32_bf16 v29, v170, v170
    v_dot2c_f32_bf16 v30, v171, v24
    v_dot2c_f32_bf16 v31, v171, v171
    s_waitcnt lgkmcnt(4)
    v_dot2c_f32_bf16 v28, v172, v24
    v_dot2c_f32_bf16 v29, v172, v172
    v_dot2c_f32_bf16 v30, v173, v24
    v_dot2c_f32_bf16 v31, v173, v173
    v_dot2c_f32_bf16 v28, v174, v24
    v_dot2c_f32_bf16 v29, v174, v174
    v_dot2c_f32_bf16 v30, v175, v24
    v_dot2c_f32_bf16 v31, v175, v175
    s_waitcnt lgkmcnt(3)
    v_dot2c_f32_bf16 v28, v176, v24
    v_dot2c_f32_bf16 v29, v176, v176
    v_dot2c_f32_bf16 v30, v177, v24
    v_dot2c_f32_bf16 v31, v177, v177
    v_dot2c_f32_bf16 v28, v178, v24
    v_dot2c_f32_bf16 v29, v178, v178
    v_dot2c_f32_bf16 v30, v179, v24
    v_dot2c_f32_bf16 v31, v179, v179
    s_waitcnt lgkmcnt(2)
    v_dot2c_f32_bf16 v28, v180, v24
    v_dot2c_f32_bf16 v29, v180, v180
    v_dot2c_f32_bf16 v30, v181, v24
    v_dot2c_f32_bf16 v31, v181, v181
    v_dot2c_f32_bf16 v28, v182, v24
    v_dot2c_f32_bf16 v29, v182, v182
    v_dot2c_f32_bf16 v30, v183, v24
    v_dot2c_f32_bf16 v31, v183, v183
    s_waitcnt lgkmcnt(1)
    v_dot2c_f32_bf16 v28, v184, v24
    v_dot2c_f32_bf16 v29, v184, v184
    v_dot2c_f32_bf16 v30, v185, v24
    v_dot2c_f32_bf16 v31, v185, v185
    v_dot2c_f32_bf16 v28, v186, v24
    v_dot2c_f32_bf16 v29, v186, v186
    v_dot2c_f32_bf16 v30, v187, v24
    v_dot2c_f32_bf16 v31, v187, v187
    s_waitcnt lgkmcnt(0)
    v_dot2c_f32_bf16 v28, v188, v24
    v_dot2c_f32_bf16 v29, v188, v188
    v_dot2c_f32_bf16 v30, v189, v24
    v_dot2c_f32_bf16 v31, v189, v189
    v_dot2c_f32_bf16 v28, v190, v24
    v_dot2c_f32_bf16 v29, v190, v190
    v_dot2c_f32_bf16 v30, v191, v24
    v_dot2c_f32_bf16 v31, v191, v191
    s_waitcnt vmcnt(12)
    s_barrier
    ds_read_b128 v[192:195], v16 offset:49152
    ds_read_b128 v[196:199], v17 offset:49152
    ds_read_b128 v[200:203], v18 offset:49152
    ds_read_b128 v[204:207], v19 offset:49152
    ds_read_b128 v[208:211], v20 offset:49152
    ds_read_b128 v[212:215], v21 offset:49152
    ds_read_b128 v[216:219], v22 offset:49152
    ds_read_b128 v[220:223], v23 offset:49152
    s_add_u32 m0, s52, 114688
    s_mov_b32 s54, 393216
    buffer_load_dwordx4 v5, s[8:11], s54 offen lds
    s_add_u32 m0, s52, 118784
    s_mov_b32 s54, 425984
    buffer_load_dwordx4 v5, s[8:11], s54 offen lds
    s_add_u32 m0, s52, 122880
    s_mov_b32 s54, 458752
    buffer_load_dwordx4 v5, s[8:11], s54 offen lds
    s_add_u32 m0, s52, 126976
    s_mov_b32 s54, 491520
    buffer_load_dwordx4 v5, s[8:11], s54 offen lds
    s_waitcnt lgkmcnt(7)
    v_dot2c_f32_bf16 v28, v192, v24
    v_dot2c_f32_bf16 v29, v192, v192
    v_dot2c_f32_bf16 v30, v193, v24
    v_dot2c_f32_bf16 v31, v193, v193
    v_dot2c_f32_bf16 v28, v194, v24
    v_dot2c_f32_bf16 v29, v194, v194
    v_dot2c_f32_bf16 v30, v195, v24
    v_dot2c_f32_bf16 v31, v195, v195
    s_waitcnt lgkmcnt(6)
    v_dot2c_f32_bf16 v28, v196, v24
    v_dot2c_f32_bf16 v29, v196, v196
    v_dot2c_f32_bf16 v30, v197, v24
    v_dot2c_f32_bf16 v31, v197, v197
    v_dot2c_f32_bf16 v28, v198, v24
    v_dot2c_f32_bf16 v29, v198, v198
    v_dot2c_f32_bf16 v30, v199, v24
    v_dot2c_f32_bf16 v31, v199, v199
    s_waitcnt lgkmcnt(5)
    v_dot2c_f32_bf16 v28, v200, v24
    v_dot2c_f32_bf16 v29, v200, v200
    v_dot2c_f32_bf16 v30, v201, v24
    v_dot2c_f32_bf16 v31, v201, v201
    v_dot2c_f32_bf16 v28, v202, v24
    v_dot2c_f32_bf16 v29, v202, v202
    v_dot2c_f32_bf16 v30, v203, v24
    v_dot2c_f32_bf16 v31, v203, v203
    s_waitcnt lgkmcnt(4)
    v_dot2c_f32_bf16 v28, v204, v24
    v_dot2c_f32_bf16 v29, v204, v204
    v_dot2c_f32_bf16 v30, v205, v24
    v_dot2c_f32_bf16 v31, v205, v205
    v_dot2c_f32_bf16 v28, v206, v24
    v_dot2c_f32_bf16 v29, v206, v206
    v_dot2c_f32_bf16 v30, v207, v24
    v_dot2c_f32_bf16 v31, v207, v207
    s_waitcnt lgkmcnt(3)
    v_dot2c_f32_bf16 v28, v208, v24
    v_dot2c_f32_bf16 v29, v208, v208
    v_dot2c_f32_bf16 v30, v209, v24
    v_dot2c_f32_bf16 v31, v209, v209
    v_dot2c_f32_bf16 v28, v210, v24
    v_dot2c_f32_bf16 v29, v210, v210
    v_dot2c_f32_bf16 v30, v211, v24
    v_dot2c_f32_bf16 v31, v211, v211
    s_waitcnt lgkmcnt(2)
    v_dot2c_f32_bf16 v28, v212, v24
    v_dot2c_f32_bf16 v29, v212, v212
    v_dot2c_f32_bf16 v30, v213, v24
    v_dot2c_f32_bf16 v31, v213, v213
    v_dot2c_f32_bf16 v28, v214, v24
    v_dot2c_f32_bf16 v29, v214, v214
    v_dot2c_f32_bf16 v30, v215, v24
    v_dot2c_f32_bf16 v31, v215, v215
    s_waitcnt lgkmcnt(1)
    v_dot2c_f32_bf16 v28, v216, v24
    v_dot2c_f32_bf16 v29, v216, v216
    v_dot2c_f32_bf16 v30, v217, v24
    v_dot2c_f32_bf16 v31, v217, v217
    v_dot2c_f32_bf16 v28, v218, v24
    v_dot2c_f32_bf16 v29, v218, v218
    v_dot2c_f32_bf16 v30, v219, v24
    v_dot2c_f32_bf16 v31, v219, v219
    s_waitcnt lgkmcnt(0)
    v_dot2c_f32_bf16 v28, v220, v24
    v_dot2c_f32_bf16 v29, v220, v220
    v_dot2c_f32_bf16 v30, v221, v24
    v_dot2c_f32_bf16 v31, v221, v221
    v_dot2c_f32_bf16 v28, v222, v24
    v_dot2c_f32_bf16 v29, v222, v222
    v_dot2c_f32_bf16 v30, v223, v24
    v_dot2c_f32_bf16 v31, v223, v223
    s_waitcnt vmcnt(12)
    s_barrier
    ds_read_b64_tr_b16 v[224:225], v10 offset:0
    ds_read_b64_tr_b16 v[226:227], v10 offset:512
    ds_read_b64_tr_b16 v[228:229], v10 offset:2048
    ds_read_b64_tr_b16 v[230:231], v10 offset:2560
    ds_read_b64_tr_b16 v[232:233], v10 offset:4096
    ds_read_b64_tr_b16 v[234:235], v10 offset:4608
    v_add_f32 v28, v28, v30
    v_add_f32 v29, v29, v31
    v_mov_b32 v30, v28
    v_mov_b32 v31, v29
    s_nop 1
    v_permlane32_swap_b32 v28, v30
    v_permlane32_swap_b32 v29, v31
    s_nop 1
    v_add_f32 v28, v28, v30
    v_add_f32 v29, v29, v31
    v_mul_f32 v28, 0x3b000000, v28
    v_mul_f32 v29, 0x3b000000, v29
    v_fma_f32 v29, -v28, v28, v29
    v_add_f32 v29, 0x3727c5ac, v29
    v_rsq_f32 v29, v29
    s_nop 1
    v_mul_f32 v30, 0x3eb8aa3b, v29
    s_waitcnt lgkmcnt(4)
    v_mfma_f32_32x32x16_bf16 v[32:47], v[224:227], v[96:99], 0
    ds_read_b64_tr_b16 v[236:237], v10 offset:6144
    ds_read_b64_tr_b16 v[238:239], v10 offset:6656
    v_mfma_f32_32x32x16_bf16 v[48:63], v[224:227], v[24:27], 0
    s_waitcnt lgkmcnt(4)
    v_mfma_f32_32x32x16_bf16 v[32:47], v[228:231], v[100:103], v[32:47]
    ds_read_b64_tr_b16 v[224:225], v10 offset:8192
    ds_read_b64_tr_b16 v[226:227], v10 offset:8704
    v_mfma_f32_32x32x16_bf16 v[48:63], v[228:231], v[24:27], v[48:63]
    s_waitcnt lgkmcnt(4)
    v_mfma_f32_32x32x16_bf16 v[32:47], v[232:235], v[104:107], v[32:47]
    ds_read_b64_tr_b16 v[228:229], v10 offset:10240
    ds_read_b64_tr_b16 v[230:231], v10 offset:10752
    v_mfma_f32_32x32x16_bf16 v[48:63], v[232:235], v[24:27], v[48:63]
    s_waitcnt lgkmcnt(4)
    v_mfma_f32_32x32x16_bf16 v[32:47], v[236:239], v[108:111], v[32:47]
    ds_read_b64_tr_b16 v[232:233], v10 offset:12288
    ds_read_b64_tr_b16 v[234:235], v10 offset:12800
    v_mfma_f32_32x32x16_bf16 v[48:63], v[236:239], v[24:27], v[48:63]
    s_waitcnt lgkmcnt(4)
    v_mfma_f32_32x32x16_bf16 v[32:47], v[224:227], v[112:115], v[32:47]
    ds_read_b64_tr_b16 v[236:237], v10 offset:14336
    ds_read_b64_tr_b16 v[238:239], v10 offset:14848
    v_mfma_f32_32x32x16_bf16 v[48:63], v[224:227], v[24:27], v[48:63]
    s_waitcnt lgkmcnt(4)
    v_mfma_f32_32x32x16_bf16 v[32:47], v[228:231], v[116:119], v[32:47]
    v_mfma_f32_32x32x16_bf16 v[48:63], v[228:231], v[24:27], v[48:63]
    s_waitcnt lgkmcnt(2)
    v_mfma_f32_32x32x16_bf16 v[32:47], v[232:235], v[120:123], v[32:47]
    v_mfma_f32_32x32x16_bf16 v[48:63], v[232:235], v[24:27], v[48:63]
    s_waitcnt lgkmcnt(0)
    v_mfma_f32_32x32x16_bf16 v[32:47], v[236:239], v[124:127], v[32:47]
    v_mfma_f32_32x32x16_bf16 v[48:63], v[236:239], v[24:27], v[48:63]
    s_waitcnt vmcnt(8)
    s_barrier
    ds_read_b64_tr_b16 v[224:225], v10 offset:16384
    ds_read_b64_tr_b16 v[226:227], v10 offset:16896
    ds_read_b64_tr_b16 v[228:229], v10 offset:18432
    ds_read_b64_tr_b16 v[230:231], v10 offset:18944
    ds_read_b64_tr_b16 v[232:233], v10 offset:20480
    ds_read_b64_tr_b16 v[234:235], v10 offset:20992
    s_waitcnt lgkmcnt(4)
    v_mfma_f32_32x32x16_bf16 v[32:47], v[224:227], v[128:131], v[32:47]
    ds_read_b64_tr_b16 v[236:237], v10 offset:22528
    ds_read_b64_tr_b16 v[238:239], v10 offset:23040
    v_mfma_f32_32x32x16_bf16 v[48:63], v[224:227], v[24:27], v[48:63]
    s_waitcnt lgkmcnt(4)
    v_mfma_f32_32x32x16_bf16 v[32:47], v[228:231], v[132:135], v[32:47]
    ds_read_b64_tr_b16 v[224:225], v10 offset:24576
    ds_read_b64_tr_b16 v[226:227], v10 offset:25088
    v_mfma_f32_32x32x16_bf16 v[48:63], v[228:231], v[24:27], v[48:63]
    s_waitcnt lgkmcnt(4)
    v_mfma_f32_32x32x16_bf16 v[32:47], v[232:235], v[136:139], v[32:47]
    ds_read_b64_tr_b16 v[228:229], v10 offset:26624
    ds_read_b64_tr_b16 v[230:231], v10 offset:27136
    v_mfma_f32_32x32x16_bf16 v[48:63], v[232:235], v[24:27], v[48:63]
    s_waitcnt lgkmcnt(4)
    v_mfma_f32_32x32x16_bf16 v[32:47], v[236:239], v[140:143], v[32:47]
    ds_read_b64_tr_b16 v[232:233], v10 offset:28672
    ds_read_b64_tr_b16 v[234:235], v10 offset:29184
    v_mfma_f32_32x32x16_bf16 v[48:63], v[236:239], v[24:27], v[48:63]
    s_waitcnt lgkmcnt(4)
    v_mfma_f32_32x32x16_bf16 v[32:47], v[224:227], v[144:147], v[32:47]
    ds_read_b64_tr_b16 v[236:237], v10 offset:30720
    ds_read_b64_tr_b16 v[238:239], v10 offset:31232
    v_mfma_f32_32x32x16_bf16 v[48:63], v[224:227], v[24:27], v[48:63]
    s_waitcnt lgkmcnt(4)
    v_mfma_f32_32x32x16_bf16 v[32:47], v[228:231], v[148:151], v[32:47]
    v_mfma_f32_32x32x16_bf16 v[48:63], v[228:231], v[24:27], v[48:63]
    s_waitcnt lgkmcnt(2)
    v_mfma_f32_32x32x16_bf16 v[32:47], v[232:235], v[152:155], v[32:47]
    v_mfma_f32_32x32x16_bf16 v[48:63], v[232:235], v[24:27], v[48:63]
    s_waitcnt lgkmcnt(0)
    v_mfma_f32_32x32x16_bf16 v[32:47], v[236:239], v[156:159], v[32:47]
    v_mfma_f32_32x32x16_bf16 v[48:63], v[236:239], v[24:27], v[48:63]
    s_waitcnt vmcnt(4)
    s_barrier
    ds_read_b64_tr_b16 v[224:225], v10 offset:32768
    ds_read_b64_tr_b16 v[226:227], v10 offset:33280
    ds_read_b64_tr_b16 v[228:229], v10 offset:34816
    ds_read_b64_tr_b16 v[230:231], v10 offset:35328
    ds_read_b64_tr_b16 v[232:233], v10 offset:36864
    ds_read_b64_tr_b16 v[234:235], v10 offset:37376
    s_waitcnt lgkmcnt(4)
    v_mfma_f32_32x32x16_bf16 v[32:47], v[224:227], v[160:163], v[32:47]
    ds_read_b64_tr_b16 v[236:237], v10 offset:38912
    ds_read_b64_tr_b16 v[238:239], v10 offset:39424
    v_mfma_f32_32x32x16_bf16 v[48:63], v[224:227], v[24:27], v[48:63]
    s_waitcnt lgkmcnt(4)
    v_mfma_f32_32x32x16_bf16 v[32:47], v[228:231], v[164:167], v[32:47]
    ds_read_b64_tr_b16 v[224:225], v10 offset:40960
    ds_read_b64_tr_b16 v[226:227], v10 offset:41472
    v_mfma_f32_32x32x16_bf16 v[48:63], v[228:231], v[24:27], v[48:63]
    s_waitcnt lgkmcnt(4)
    v_mfma_f32_32x32x16_bf16 v[32:47], v[232:235], v[168:171], v[32:47]
    ds_read_b64_tr_b16 v[228:229], v10 offset:43008
    ds_read_b64_tr_b16 v[230:231], v10 offset:43520
    v_mfma_f32_32x32x16_bf16 v[48:63], v[232:235], v[24:27], v[48:63]
    s_waitcnt lgkmcnt(4)
    v_mfma_f32_32x32x16_bf16 v[32:47], v[236:239], v[172:175], v[32:47]
    ds_read_b64_tr_b16 v[232:233], v10 offset:45056
    ds_read_b64_tr_b16 v[234:235], v10 offset:45568
    v_mfma_f32_32x32x16_bf16 v[48:63], v[236:239], v[24:27], v[48:63]
    s_waitcnt lgkmcnt(4)
    v_mfma_f32_32x32x16_bf16 v[32:47], v[224:227], v[176:179], v[32:47]
    ds_read_b64_tr_b16 v[236:237], v10 offset:47104
    ds_read_b64_tr_b16 v[238:239], v10 offset:47616
    v_mfma_f32_32x32x16_bf16 v[48:63], v[224:227], v[24:27], v[48:63]
    s_waitcnt lgkmcnt(4)
    v_mfma_f32_32x32x16_bf16 v[32:47], v[228:231], v[180:183], v[32:47]
    v_mfma_f32_32x32x16_bf16 v[48:63], v[228:231], v[24:27], v[48:63]
    s_waitcnt lgkmcnt(2)
    v_mfma_f32_32x32x16_bf16 v[32:47], v[232:235], v[184:187], v[32:47]
    v_mfma_f32_32x32x16_bf16 v[48:63], v[232:235], v[24:27], v[48:63]
    s_waitcnt lgkmcnt(0)
    v_mfma_f32_32x32x16_bf16 v[32:47], v[236:239], v[188:191], v[32:47]
    v_mfma_f32_32x32x16_bf16 v[48:63], v[236:239], v[24:27], v[48:63]
    s_waitcnt vmcnt(0)
    s_barrier
    ds_read_b64_tr_b16 v[224:225], v10 offset:49152
    ds_read_b64_tr_b16 v[226:227], v10 offset:49664
    ds_read_b64_tr_b16 v[228:229], v10 offset:51200
    ds_read_b64_tr_b16 v[230:231], v10 offset:51712
    ds_read_b64_tr_b16 v[232:233], v10 offset:53248
    ds_read_b64_tr_b16 v[234:235], v10 offset:53760
    s_waitcnt lgkmcnt(4)
    v_mfma_f32_32x32x16_bf16 v[32:47], v[224:227], v[192:195], v[32:47]
    ds_read_b64_tr_b16 v[236:237], v10 offset:55296
    ds_read_b64_tr_b16 v[238:239], v10 offset:55808
    v_mfma_f32_32x32x16_bf16 v[48:63], v[224:227], v[24:27], v[48:63]
    s_waitcnt lgkmcnt(4)
    v_mfma_f32_32x32x16_bf16 v[32:47], v[228:231], v[196:199], v[32:47]
    ds_read_b64_tr_b16 v[224:225], v10 offset:57344
    ds_read_b64_tr_b16 v[226:227], v10 offset:57856
    v_mfma_f32_32x32x16_bf16 v[48:63], v[228:231], v[24:27], v[48:63]
    s_waitcnt lgkmcnt(4)
    v_mfma_f32_32x32x16_bf16 v[32:47], v[232:235], v[200:203], v[32:47]
    ds_read_b64_tr_b16 v[228:229], v10 offset:59392
    ds_read_b64_tr_b16 v[230:231], v10 offset:59904
    v_mfma_f32_32x32x16_bf16 v[48:63], v[232:235], v[24:27], v[48:63]
    s_waitcnt lgkmcnt(4)
    v_mfma_f32_32x32x16_bf16 v[32:47], v[236:239], v[204:207], v[32:47]
    ds_read_b64_tr_b16 v[232:233], v10 offset:61440
    ds_read_b64_tr_b16 v[234:235], v10 offset:61952
    v_mfma_f32_32x32x16_bf16 v[48:63], v[236:239], v[24:27], v[48:63]
    s_waitcnt lgkmcnt(4)
    v_mfma_f32_32x32x16_bf16 v[32:47], v[224:227], v[208:211], v[32:47]
    ds_read_b64_tr_b16 v[236:237], v10 offset:63488
    ds_read_b64_tr_b16 v[238:239], v10 offset:64000
    v_mfma_f32_32x32x16_bf16 v[48:63], v[224:227], v[24:27], v[48:63]
    s_waitcnt lgkmcnt(4)
    v_mfma_f32_32x32x16_bf16 v[32:47], v[228:231], v[212:215], v[32:47]
    v_mfma_f32_32x32x16_bf16 v[48:63], v[228:231], v[24:27], v[48:63]
    s_waitcnt lgkmcnt(2)
    v_mfma_f32_32x32x16_bf16 v[32:47], v[232:235], v[216:219], v[32:47]
    v_mfma_f32_32x32x16_bf16 v[48:63], v[232:235], v[24:27], v[48:63]
    s_waitcnt lgkmcnt(0)
    v_mfma_f32_32x32x16_bf16 v[32:47], v[236:239], v[220:223], v[32:47]
    v_mfma_f32_32x32x16_bf16 v[48:63], v[236:239], v[24:27], v[48:63]
    s_branch sequenti_done2
sequenti_kvp3:
    s_waitcnt vmcnt(12)
    s_barrier
    ds_read_b128 v[96:99], v16 offset:0
    ds_read_b128 v[100:103], v17 offset:0
    ds_read_b128 v[104:107], v18 offset:0
    ds_read_b128 v[108:111], v19 offset:0
    ds_read_b128 v[112:115], v20 offset:0
    ds_read_b128 v[116:119], v21 offset:0
    ds_read_b128 v[120:123], v22 offset:0
    ds_read_b128 v[124:127], v23 offset:0
    s_add_u32 m0, s52, 65536
    s_mov_b32 s54, 0
    buffer_load_dwordx4 v5, s[8:11], s54 offen lds
    s_add_u32 m0, s52, 69632
    s_mov_b32 s54, 32768
    buffer_load_dwordx4 v5, s[8:11], s54 offen lds
    s_add_u32 m0, s52, 73728
    s_mov_b32 s54, 65536
    buffer_load_dwordx4 v5, s[8:11], s54 offen lds
    s_add_u32 m0, s52, 77824
    s_mov_b32 s54, 98304
    buffer_load_dwordx4 v5, s[8:11], s54 offen lds
    s_add_u32 s54, s62, 0
    s_add_u32 m0, s54, 131072
    buffer_load_dwordx4 v6, s[12:15], s54 offen lds
    s_add_u32 s54, s62, 1024
    s_add_u32 m0, s54, 131072
    buffer_load_dwordx4 v6, s[12:15], s54 offen lds
    s_add_u32 s54, s62, 0
    s_add_u32 m0, s54, 147456
    buffer_load_dwordx4 v6, s[16:19], s54 offen lds
    s_add_u32 s54, s62, 1024
    s_add_u32 m0, s54, 147456
    buffer_load_dwordx4 v6, s[16:19], s54 offen lds
    s_waitcnt lgkmcnt(7)
    v_dot2c_f32_bf16 v28, v96, v24
    v_dot2c_f32_bf16 v29, v96, v96
    v_dot2c_f32_bf16 v30, v97, v24
    v_dot2c_f32_bf16 v31, v97, v97
    v_dot2c_f32_bf16 v28, v98, v24
    v_dot2c_f32_bf16 v29, v98, v98
    v_dot2c_f32_bf16 v30, v99, v24
    v_dot2c_f32_bf16 v31, v99, v99
    s_waitcnt lgkmcnt(6)
    v_dot2c_f32_bf16 v28, v100, v24
    v_dot2c_f32_bf16 v29, v100, v100
    v_dot2c_f32_bf16 v30, v101, v24
    v_dot2c_f32_bf16 v31, v101, v101
    v_dot2c_f32_bf16 v28, v102, v24
    v_dot2c_f32_bf16 v29, v102, v102
    v_dot2c_f32_bf16 v30, v103, v24
    v_dot2c_f32_bf16 v31, v103, v103
    s_waitcnt lgkmcnt(5)
    v_dot2c_f32_bf16 v28, v104, v24
    v_dot2c_f32_bf16 v29, v104, v104
    v_dot2c_f32_bf16 v30, v105, v24
    v_dot2c_f32_bf16 v31, v105, v105
    v_dot2c_f32_bf16 v28, v106, v24
    v_dot2c_f32_bf16 v29, v106, v106
    v_dot2c_f32_bf16 v30, v107, v24
    v_dot2c_f32_bf16 v31, v107, v107
    s_waitcnt lgkmcnt(4)
    v_dot2c_f32_bf16 v28, v108, v24
    v_dot2c_f32_bf16 v29, v108, v108
    v_dot2c_f32_bf16 v30, v109, v24
    v_dot2c_f32_bf16 v31, v109, v109
    v_dot2c_f32_bf16 v28, v110, v24
    v_dot2c_f32_bf16 v29, v110, v110
    v_dot2c_f32_bf16 v30, v111, v24
    v_dot2c_f32_bf16 v31, v111, v111
    s_waitcnt lgkmcnt(3)
    v_dot2c_f32_bf16 v28, v112, v24
    v_dot2c_f32_bf16 v29, v112, v112
    v_dot2c_f32_bf16 v30, v113, v24
    v_dot2c_f32_bf16 v31, v113, v113
    v_dot2c_f32_bf16 v28, v114, v24
    v_dot2c_f32_bf16 v29, v114, v114
    v_dot2c_f32_bf16 v30, v115, v24
    v_dot2c_f32_bf16 v31, v115, v115
    s_waitcnt lgkmcnt(2)
    v_dot2c_f32_bf16 v28, v116, v24
    v_dot2c_f32_bf16 v29, v116, v116
    v_dot2c_f32_bf16 v30, v117, v24
    v_dot2c_f32_bf16 v31, v117, v117
    v_dot2c_f32_bf16 v28, v118, v24
    v_dot2c_f32_bf16 v29, v118, v118
    v_dot2c_f32_bf16 v30, v119, v24
    v_dot2c_f32_bf16 v31, v119, v119
    s_waitcnt lgkmcnt(1)
    v_dot2c_f32_bf16 v28, v120, v24
    v_dot2c_f32_bf16 v29, v120, v120
    v_dot2c_f32_bf16 v30, v121, v24
    v_dot2c_f32_bf16 v31, v121, v121
    v_dot2c_f32_bf16 v28, v122, v24
    v_dot2c_f32_bf16 v29, v122, v122
    v_dot2c_f32_bf16 v30, v123, v24
    v_dot2c_f32_bf16 v31, v123, v123
    s_waitcnt lgkmcnt(0)
    v_dot2c_f32_bf16 v28, v124, v24
    v_dot2c_f32_bf16 v29, v124, v124
    v_dot2c_f32_bf16 v30, v125, v24
    v_dot2c_f32_bf16 v31, v125, v125
    v_dot2c_f32_bf16 v28, v126, v24
    v_dot2c_f32_bf16 v29, v126, v126
    v_dot2c_f32_bf16 v30, v127, v24
    v_dot2c_f32_bf16 v31, v127, v127
    s_waitcnt vmcnt(16)
    s_barrier
    ds_read_b128 v[128:131], v16 offset:16384
    ds_read_b128 v[132:135], v17 offset:16384
    ds_read_b128 v[136:139], v18 offset:16384
    ds_read_b128 v[140:143], v19 offset:16384
    ds_read_b128 v[144:147], v20 offset:16384
    ds_read_b128 v[148:151], v21 offset:16384
    ds_read_b128 v[152:155], v22 offset:16384
    ds_read_b128 v[156:159], v23 offset:16384
    s_add_u32 m0, s52, 81920
    s_mov_b32 s54, 131072
    buffer_load_dwordx4 v5, s[8:11], s54 offen lds
    s_add_u32 m0, s52, 86016
    s_mov_b32 s54, 163840
    buffer_load_dwordx4 v5, s[8:11], s54 offen lds
    s_add_u32 m0, s52, 90112
    s_mov_b32 s54, 196608
    buffer_load_dwordx4 v5, s[8:11], s54 offen lds
    s_add_u32 m0, s52, 94208
    s_mov_b32 s54, 229376
    buffer_load_dwordx4 v5, s[8:11], s54 offen lds
    s_add_u32 s54, s62, 4096
    s_add_u32 m0, s54, 131072
    buffer_load_dwordx4 v6, s[12:15], s54 offen lds
    s_add_u32 s54, s62, 5120
    s_add_u32 m0, s54, 131072
    buffer_load_dwordx4 v6, s[12:15], s54 offen lds
    s_add_u32 s54, s62, 4096
    s_add_u32 m0, s54, 147456
    buffer_load_dwordx4 v6, s[16:19], s54 offen lds
    s_add_u32 s54, s62, 5120
    s_add_u32 m0, s54, 147456
    buffer_load_dwordx4 v6, s[16:19], s54 offen lds
    s_waitcnt lgkmcnt(7)
    v_dot2c_f32_bf16 v28, v128, v24
    v_dot2c_f32_bf16 v29, v128, v128
    v_dot2c_f32_bf16 v30, v129, v24
    v_dot2c_f32_bf16 v31, v129, v129
    v_dot2c_f32_bf16 v28, v130, v24
    v_dot2c_f32_bf16 v29, v130, v130
    v_dot2c_f32_bf16 v30, v131, v24
    v_dot2c_f32_bf16 v31, v131, v131
    s_waitcnt lgkmcnt(6)
    v_dot2c_f32_bf16 v28, v132, v24
    v_dot2c_f32_bf16 v29, v132, v132
    v_dot2c_f32_bf16 v30, v133, v24
    v_dot2c_f32_bf16 v31, v133, v133
    v_dot2c_f32_bf16 v28, v134, v24
    v_dot2c_f32_bf16 v29, v134, v134
    v_dot2c_f32_bf16 v30, v135, v24
    v_dot2c_f32_bf16 v31, v135, v135
    s_waitcnt lgkmcnt(5)
    v_dot2c_f32_bf16 v28, v136, v24
    v_dot2c_f32_bf16 v29, v136, v136
    v_dot2c_f32_bf16 v30, v137, v24
    v_dot2c_f32_bf16 v31, v137, v137
    v_dot2c_f32_bf16 v28, v138, v24
    v_dot2c_f32_bf16 v29, v138, v138
    v_dot2c_f32_bf16 v30, v139, v24
    v_dot2c_f32_bf16 v31, v139, v139
    s_waitcnt lgkmcnt(4)
    v_dot2c_f32_bf16 v28, v140, v24
    v_dot2c_f32_bf16 v29, v140, v140
    v_dot2c_f32_bf16 v30, v141, v24
    v_dot2c_f32_bf16 v31, v141, v141
    v_dot2c_f32_bf16 v28, v142, v24
    v_dot2c_f32_bf16 v29, v142, v142
    v_dot2c_f32_bf16 v30, v143, v24
    v_dot2c_f32_bf16 v31, v143, v143
    s_waitcnt lgkmcnt(3)
    v_dot2c_f32_bf16 v28, v144, v24
    v_dot2c_f32_bf16 v29, v144, v144
    v_dot2c_f32_bf16 v30, v145, v24
    v_dot2c_f32_bf16 v31, v145, v145
    v_dot2c_f32_bf16 v28, v146, v24
    v_dot2c_f32_bf16 v29, v146, v146
    v_dot2c_f32_bf16 v30, v147, v24
    v_dot2c_f32_bf16 v31, v147, v147
    s_waitcnt lgkmcnt(2)
    v_dot2c_f32_bf16 v28, v148, v24
    v_dot2c_f32_bf16 v29, v148, v148
    v_dot2c_f32_bf16 v30, v149, v24
    v_dot2c_f32_bf16 v31, v149, v149
    v_dot2c_f32_bf16 v28, v150, v24
    v_dot2c_f32_bf16 v29, v150, v150
    v_dot2c_f32_bf16 v30, v151, v24
    v_dot2c_f32_bf16 v31, v151, v151
    s_waitcnt lgkmcnt(1)
    v_dot2c_f32_bf16 v28, v152, v24
    v_dot2c_f32_bf16 v29, v152, v152
    v_dot2c_f32_bf16 v30, v153, v24
    v_dot2c_f32_bf16 v31, v153, v153
    v_dot2c_f32_bf16 v28, v154, v24
    v_dot2c_f32_bf16 v29, v154, v154
    v_dot2c_f32_bf16 v30, v155, v24
    v_dot2c_f32_bf16 v31, v155, v155
    s_waitcnt lgkmcnt(0)
    v_dot2c_f32_bf16 v28, v156, v24
    v_dot2c_f32_bf16 v29, v156, v156
    v_dot2c_f32_bf16 v30, v157, v24
    v_dot2c_f32_bf16 v31, v157, v157
    v_dot2c_f32_bf16 v28, v158, v24
    v_dot2c_f32_bf16 v29, v158, v158
    v_dot2c_f32_bf16 v30, v159, v24
    v_dot2c_f32_bf16 v31, v159, v159
    s_waitcnt vmcnt(20)
    s_barrier
    ds_read_b128 v[160:163], v16 offset:32768
    ds_read_b128 v[164:167], v17 offset:32768
    ds_read_b128 v[168:171], v18 offset:32768
    ds_read_b128 v[172:175], v19 offset:32768
    ds_read_b128 v[176:179], v20 offset:32768
    ds_read_b128 v[180:183], v21 offset:32768
    ds_read_b128 v[184:187], v22 offset:32768
    ds_read_b128 v[188:191], v23 offset:32768
    s_add_u32 m0, s52, 98304
    s_mov_b32 s54, 262144
    buffer_load_dwordx4 v5, s[8:11], s54 offen lds
    s_add_u32 m0, s52, 102400
    s_mov_b32 s54, 294912
    buffer_load_dwordx4 v5, s[8:11], s54 offen lds
    s_add_u32 m0, s52, 106496
    s_mov_b32 s54, 327680
    buffer_load_dwordx4 v5, s[8:11], s54 offen lds
    s_add_u32 m0, s52, 110592
    s_mov_b32 s54, 360448
    buffer_load_dwordx4 v5, s[8:11], s54 offen lds
    s_add_u32 s54, s62, 8192
    s_add_u32 m0, s54, 131072
    buffer_load_dwordx4 v6, s[12:15], s54 offen lds
    s_add_u32 s54, s62, 9216
    s_add_u32 m0, s54, 131072
    buffer_load_dwordx4 v6, s[12:15], s54 offen lds
    s_add_u32 s54, s62, 8192
    s_add_u32 m0, s54, 147456
    buffer_load_dwordx4 v6, s[16:19], s54 offen lds
    s_add_u32 s54, s62, 9216
    s_add_u32 m0, s54, 147456
    buffer_load_dwordx4 v6, s[16:19], s54 offen lds
    s_waitcnt lgkmcnt(7)
    v_dot2c_f32_bf16 v28, v160, v24
    v_dot2c_f32_bf16 v29, v160, v160
    v_dot2c_f32_bf16 v30, v161, v24
    v_dot2c_f32_bf16 v31, v161, v161
    v_dot2c_f32_bf16 v28, v162, v24
    v_dot2c_f32_bf16 v29, v162, v162
    v_dot2c_f32_bf16 v30, v163, v24
    v_dot2c_f32_bf16 v31, v163, v163
    s_waitcnt lgkmcnt(6)
    v_dot2c_f32_bf16 v28, v164, v24
    v_dot2c_f32_bf16 v29, v164, v164
    v_dot2c_f32_bf16 v30, v165, v24
    v_dot2c_f32_bf16 v31, v165, v165
    v_dot2c_f32_bf16 v28, v166, v24
    v_dot2c_f32_bf16 v29, v166, v166
    v_dot2c_f32_bf16 v30, v167, v24
    v_dot2c_f32_bf16 v31, v167, v167
    s_waitcnt lgkmcnt(5)
    v_dot2c_f32_bf16 v28, v168, v24
    v_dot2c_f32_bf16 v29, v168, v168
    v_dot2c_f32_bf16 v30, v169, v24
    v_dot2c_f32_bf16 v31, v169, v169
    v_dot2c_f32_bf16 v28, v170, v24
    v_dot2c_f32_bf16 v29, v170, v170
    v_dot2c_f32_bf16 v30, v171, v24
    v_dot2c_f32_bf16 v31, v171, v171
    s_waitcnt lgkmcnt(4)
    v_dot2c_f32_bf16 v28, v172, v24
    v_dot2c_f32_bf16 v29, v172, v172
    v_dot2c_f32_bf16 v30, v173, v24
    v_dot2c_f32_bf16 v31, v173, v173
    v_dot2c_f32_bf16 v28, v174, v24
    v_dot2c_f32_bf16 v29, v174, v174
    v_dot2c_f32_bf16 v30, v175, v24
    v_dot2c_f32_bf16 v31, v175, v175
    s_waitcnt lgkmcnt(3)
    v_dot2c_f32_bf16 v28, v176, v24
    v_dot2c_f32_bf16 v29, v176, v176
    v_dot2c_f32_bf16 v30, v177, v24
    v_dot2c_f32_bf16 v31, v177, v177
    v_dot2c_f32_bf16 v28, v178, v24
    v_dot2c_f32_bf16 v29, v178, v178
    v_dot2c_f32_bf16 v30, v179, v24
    v_dot2c_f32_bf16 v31, v179, v179
    s_waitcnt lgkmcnt(2)
    v_dot2c_f32_bf16 v28, v180, v24
    v_dot2c_f32_bf16 v29, v180, v180
    v_dot2c_f32_bf16 v30, v181, v24
    v_dot2c_f32_bf16 v31, v181, v181
    v_dot2c_f32_bf16 v28, v182, v24
    v_dot2c_f32_bf16 v29, v182, v182
    v_dot2c_f32_bf16 v30, v183, v24
    v_dot2c_f32_bf16 v31, v183, v183
    s_waitcnt lgkmcnt(1)
    v_dot2c_f32_bf16 v28, v184, v24
    v_dot2c_f32_bf16 v29, v184, v184
    v_dot2c_f32_bf16 v30, v185, v24
    v_dot2c_f32_bf16 v31, v185, v185
    v_dot2c_f32_bf16 v28, v186, v24
    v_dot2c_f32_bf16 v29, v186, v186
    v_dot2c_f32_bf16 v30, v187, v24
    v_dot2c_f32_bf16 v31, v187, v187
    s_waitcnt lgkmcnt(0)
    v_dot2c_f32_bf16 v28, v188, v24
    v_dot2c_f32_bf16 v29, v188, v188
    v_dot2c_f32_bf16 v30, v189, v24
    v_dot2c_f32_bf16 v31, v189, v189
    v_dot2c_f32_bf16 v28, v190, v24
    v_dot2c_f32_bf16 v29, v190, v190
    v_dot2c_f32_bf16 v30, v191, v24
    v_dot2c_f32_bf16 v31, v191, v191
    s_waitcnt vmcnt(24)
    s_barrier
    ds_read_b128 v[192:195], v16 offset:49152
    ds_read_b128 v[196:199], v17 offset:49152
    ds_read_b128 v[200:203], v18 offset:49152
    ds_read_b128 v[204:207], v19 offset:49152
    ds_read_b128 v[208:211], v20 offset:49152
    ds_read_b128 v[212:215], v21 offset:49152
    ds_read_b128 v[216:219], v22 offset:49152
    ds_read_b128 v[220:223], v23 offset:49152
    s_add_u32 m0, s52, 114688
    s_mov_b32 s54, 393216
    buffer_load_dwordx4 v5, s[8:11], s54 offen lds
    s_add_u32 m0, s52, 118784
    s_mov_b32 s54, 425984
    buffer_load_dwordx4 v5, s[8:11], s54 offen lds
    s_add_u32 m0, s52, 122880
    s_mov_b32 s54, 458752
    buffer_load_dwordx4 v5, s[8:11], s54 offen lds
    s_add_u32 m0, s52, 126976
    s_mov_b32 s54, 491520
    buffer_load_dwordx4 v5, s[8:11], s54 offen lds
    s_add_u32 s54, s62, 12288
    s_add_u32 m0, s54, 131072
    buffer_load_dwordx4 v6, s[12:15], s54 offen lds
    s_add_u32 s54, s62, 13312
    s_add_u32 m0, s54, 131072
    buffer_load_dwordx4 v6, s[12:15], s54 offen lds
    s_add_u32 s54, s62, 12288
    s_add_u32 m0, s54, 147456
    buffer_load_dwordx4 v6, s[16:19], s54 offen lds
    s_add_u32 s54, s62, 13312
    s_add_u32 m0, s54, 147456
    buffer_load_dwordx4 v6, s[16:19], s54 offen lds
    s_waitcnt lgkmcnt(7)
    v_dot2c_f32_bf16 v28, v192, v24
    v_dot2c_f32_bf16 v29, v192, v192
    v_dot2c_f32_bf16 v30, v193, v24
    v_dot2c_f32_bf16 v31, v193, v193
    v_dot2c_f32_bf16 v28, v194, v24
    v_dot2c_f32_bf16 v29, v194, v194
    v_dot2c_f32_bf16 v30, v195, v24
    v_dot2c_f32_bf16 v31, v195, v195
    s_waitcnt lgkmcnt(6)
    v_dot2c_f32_bf16 v28, v196, v24
    v_dot2c_f32_bf16 v29, v196, v196
    v_dot2c_f32_bf16 v30, v197, v24
    v_dot2c_f32_bf16 v31, v197, v197
    v_dot2c_f32_bf16 v28, v198, v24
    v_dot2c_f32_bf16 v29, v198, v198
    v_dot2c_f32_bf16 v30, v199, v24
    v_dot2c_f32_bf16 v31, v199, v199
    s_waitcnt lgkmcnt(5)
    v_dot2c_f32_bf16 v28, v200, v24
    v_dot2c_f32_bf16 v29, v200, v200
    v_dot2c_f32_bf16 v30, v201, v24
    v_dot2c_f32_bf16 v31, v201, v201
    v_dot2c_f32_bf16 v28, v202, v24
    v_dot2c_f32_bf16 v29, v202, v202
    v_dot2c_f32_bf16 v30, v203, v24
    v_dot2c_f32_bf16 v31, v203, v203
    s_waitcnt lgkmcnt(4)
    v_dot2c_f32_bf16 v28, v204, v24
    v_dot2c_f32_bf16 v29, v204, v204
    v_dot2c_f32_bf16 v30, v205, v24
    v_dot2c_f32_bf16 v31, v205, v205
    v_dot2c_f32_bf16 v28, v206, v24
    v_dot2c_f32_bf16 v29, v206, v206
    v_dot2c_f32_bf16 v30, v207, v24
    v_dot2c_f32_bf16 v31, v207, v207
    s_waitcnt lgkmcnt(3)
    v_dot2c_f32_bf16 v28, v208, v24
    v_dot2c_f32_bf16 v29, v208, v208
    v_dot2c_f32_bf16 v30, v209, v24
    v_dot2c_f32_bf16 v31, v209, v209
    v_dot2c_f32_bf16 v28, v210, v24
    v_dot2c_f32_bf16 v29, v210, v210
    v_dot2c_f32_bf16 v30, v211, v24
    v_dot2c_f32_bf16 v31, v211, v211
    s_waitcnt lgkmcnt(2)
    v_dot2c_f32_bf16 v28, v212, v24
    v_dot2c_f32_bf16 v29, v212, v212
    v_dot2c_f32_bf16 v30, v213, v24
    v_dot2c_f32_bf16 v31, v213, v213
    v_dot2c_f32_bf16 v28, v214, v24
    v_dot2c_f32_bf16 v29, v214, v214
    v_dot2c_f32_bf16 v30, v215, v24
    v_dot2c_f32_bf16 v31, v215, v215
    s_waitcnt lgkmcnt(1)
    v_dot2c_f32_bf16 v28, v216, v24
    v_dot2c_f32_bf16 v29, v216, v216
    v_dot2c_f32_bf16 v30, v217, v24
    v_dot2c_f32_bf16 v31, v217, v217
    v_dot2c_f32_bf16 v28, v218, v24
    v_dot2c_f32_bf16 v29, v218, v218
    v_dot2c_f32_bf16 v30, v219, v24
    v_dot2c_f32_bf16 v31, v219, v219
    s_waitcnt lgkmcnt(0)
    v_dot2c_f32_bf16 v28, v220, v24
    v_dot2c_f32_bf16 v29, v220, v220
    v_dot2c_f32_bf16 v30, v221, v24
    v_dot2c_f32_bf16 v31, v221, v221
    v_dot2c_f32_bf16 v28, v222, v24
    v_dot2c_f32_bf16 v29, v222, v222
    v_dot2c_f32_bf16 v30, v223, v24
    v_dot2c_f32_bf16 v31, v223, v223
    s_waitcnt vmcnt(24)
    s_barrier
    ds_read_b64_tr_b16 v[224:225], v10 offset:0
    ds_read_b64_tr_b16 v[226:227], v10 offset:512
    ds_read_b64_tr_b16 v[240:241], v11 offset:0
    ds_read_b64_tr_b16 v[242:243], v11 offset:128
    ds_read_b64_tr_b16 v[228:229], v10 offset:2048
    ds_read_b64_tr_b16 v[230:231], v10 offset:2560
    ds_read_b64_tr_b16 v[244:245], v11 offset:512
    ds_read_b64_tr_b16 v[246:247], v11 offset:640
    ds_read_b64_tr_b16 v[232:233], v10 offset:4096
    ds_read_b64_tr_b16 v[234:235], v10 offset:4608
    ds_read_b64_tr_b16 v[248:249], v11 offset:1024
    ds_read_b64_tr_b16 v[250:251], v11 offset:1152
    v_add_f32 v28, v28, v30
    v_add_f32 v29, v29, v31
    v_mov_b32 v30, v28
    v_mov_b32 v31, v29
    s_nop 1
    v_permlane32_swap_b32 v28, v30
    v_permlane32_swap_b32 v29, v31
    s_nop 1
    v_add_f32 v28, v28, v30
    v_add_f32 v29, v29, v31
    v_mul_f32 v28, 0x3b000000, v28
    v_mul_f32 v29, 0x3b000000, v29
    v_fma_f32 v29, -v28, v28, v29
    v_add_f32 v29, 0x3727c5ac, v29
    v_rsq_f32 v29, v29
    s_nop 1
    v_mul_f32 v30, 0x3eb8aa3b, v29
    s_waitcnt lgkmcnt(8)
    v_mfma_f32_32x32x16_bf16 v[32:47], v[224:227], v[96:99], 0
    ds_read_b64_tr_b16 v[236:237], v10 offset:6144
    ds_read_b64_tr_b16 v[238:239], v10 offset:6656
    ds_read_b64_tr_b16 v[252:253], v11 offset:1536
    ds_read_b64_tr_b16 v[254:255], v11 offset:1664
    v_mfma_f32_32x32x16_bf16 v[48:63], v[224:227], v[24:27], 0
    v_mfma_f32_32x32x16_bf16 v[64:79], v[240:243], v[96:99], 0
    v_mfma_f32_32x32x16_bf16 v[80:95], v[240:243], v[24:27], 0
    s_waitcnt lgkmcnt(8)
    v_mfma_f32_32x32x16_bf16 v[32:47], v[228:231], v[100:103], v[32:47]
    ds_read_b64_tr_b16 v[224:225], v10 offset:8192
    ds_read_b64_tr_b16 v[226:227], v10 offset:8704
    ds_read_b64_tr_b16 v[240:241], v11 offset:2048
    ds_read_b64_tr_b16 v[242:243], v11 offset:2176
    v_mfma_f32_32x32x16_bf16 v[48:63], v[228:231], v[24:27], v[48:63]
    v_mfma_f32_32x32x16_bf16 v[64:79], v[244:247], v[100:103], v[64:79]
    v_mfma_f32_32x32x16_bf16 v[80:95], v[244:247], v[24:27], v[80:95]
    s_waitcnt lgkmcnt(8)
    v_mfma_f32_32x32x16_bf16 v[32:47], v[232:235], v[104:107], v[32:47]
    ds_read_b64_tr_b16 v[228:229], v10 offset:10240
    ds_read_b64_tr_b16 v[230:231], v10 offset:10752
    ds_read_b64_tr_b16 v[244:245], v11 offset:2560
    ds_read_b64_tr_b16 v[246:247], v11 offset:2688
    v_mfma_f32_32x32x16_bf16 v[48:63], v[232:235], v[24:27], v[48:63]
    v_mfma_f32_32x32x16_bf16 v[64:79], v[248:251], v[104:107], v[64:79]
    v_mfma_f32_32x32x16_bf16 v[80:95], v[248:251], v[24:27], v[80:95]
    s_waitcnt lgkmcnt(8)
    v_mfma_f32_32x32x16_bf16 v[32:47], v[236:239], v[108:111], v[32:47]
    ds_read_b64_tr_b16 v[232:233], v10 offset:12288
    ds_read_b64_tr_b16 v[234:235], v10 offset:12800
    ds_read_b64_tr_b16 v[248:249], v11 offset:3072
    ds_read_b64_tr_b16 v[250:251], v11 offset:3200
    v_mfma_f32_32x32x16_bf16 v[48:63], v[236:239], v[24:27], v[48:63]
    v_mfma_f32_32x32x16_bf16 v[64:79], v[252:255], v[108:111], v[64:79]
    v_mfma_f32_32x32x16_bf16 v[80:95], v[252:255], v[24:27], v[80:95]
    s_waitcnt lgkmcnt(8)
    v_mfma_f32_32x32x16_bf16 v[32:47], v[224:227], v[112:115], v[32:47]
    ds_read_b64_tr_b16 v[236:237], v10 offset:14336
    ds_read_b64_tr_b16 v[238:239], v10 offset:14848
    ds_read_b64_tr_b16 v[252:253], v11 offset:3584
    ds_read_b64_tr_b16 v[254:255], v11 offset:3712
    v_mfma_f32_32x32x16_bf16 v[48:63], v[224:227], v[24:27], v[48:63]
    v_mfma_f32_32x32x16_bf16 v[64:79], v[240:243], v[112:115], v[64:79]
    v_mfma_f32_32x32x16_bf16 v[80:95], v[240:243], v[24:27], v[80:95]
    s_waitcnt lgkmcnt(8)
    v_mfma_f32_32x32x16_bf16 v[32:47], v[228:231], v[116:119], v[32:47]
    v_mfma_f32_32x32x16_bf16 v[48:63], v[228:231], v[24:27], v[48:63]
    v_mfma_f32_32x32x16_bf16 v[64:79], v[244:247], v[116:119], v[64:79]
    v_mfma_f32_32x32x16_bf16 v[80:95], v[244:247], v[24:27], v[80:95]
    s_waitcnt lgkmcnt(4)
    v_mfma_f32_32x32x16_bf16 v[32:47], v[232:235], v[120:123], v[32:47]
    v_mfma_f32_32x32x16_bf16 v[48:63], v[232:235], v[24:27], v[48:63]
    v_mfma_f32_32x32x16_bf16 v[64:79], v[248:251], v[120:123], v[64:79]
    v_mfma_f32_32x32x16_bf16 v[80:95], v[248:251], v[24:27], v[80:95]
    s_waitcnt lgkmcnt(0)
    v_mfma_f32_32x32x16_bf16 v[32:47], v[236:239], v[124:127], v[32:47]
    v_mfma_f32_32x32x16_bf16 v[48:63], v[236:239], v[24:27], v[48:63]
    v_mfma_f32_32x32x16_bf16 v[64:79], v[252:255], v[124:127], v[64:79]
    v_mfma_f32_32x32x16_bf16 v[80:95], v[252:255], v[24:27], v[80:95]
    s_waitcnt vmcnt(16)
    s_barrier
    ds_read_b64_tr_b16 v[224:225], v10 offset:16384
    ds_read_b64_tr_b16 v[226:227], v10 offset:16896
    ds_read_b64_tr_b16 v[240:241], v11 offset:4096
    ds_read_b64_tr_b16 v[242:243], v11 offset:4224
    ds_read_b64_tr_b16 v[228:229], v10 offset:18432
    ds_read_b64_tr_b16 v[230:231], v10 offset:18944
    ds_read_b64_tr_b16 v[244:245], v11 offset:4608
    ds_read_b64_tr_b16 v[246:247], v11 offset:4736
    ds_read_b64_tr_b16 v[232:233], v10 offset:20480
    ds_read_b64_tr_b16 v[234:235], v10 offset:20992
    ds_read_b64_tr_b16 v[248:249], v11 offset:5120
    ds_read_b64_tr_b16 v[250:251], v11 offset:5248
    s_waitcnt lgkmcnt(8)
    v_mfma_f32_32x32x16_bf16 v[32:47], v[224:227], v[128:131], v[32:47]
    ds_read_b64_tr_b16 v[236:237], v10 offset:22528
    ds_read_b64_tr_b16 v[238:239], v10 offset:23040
    ds_read_b64_tr_b16 v[252:253], v11 offset:5632
    ds_read_b64_tr_b16 v[254:255], v11 offset:5760
    v_mfma_f32_32x32x16_bf16 v[48:63], v[224:227], v[24:27], v[48:63]
    v_mfma_f32_32x32x16_bf16 v[64:79], v[240:243], v[128:131], v[64:79]
    v_mfma_f32_32x32x16_bf16 v[80:95], v[240:243], v[24:27], v[80:95]
    s_waitcnt lgkmcnt(8)
    v_mfma_f32_32x32x16_bf16 v[32:47], v[228:231], v[132:135], v[32:47]
    ds_read_b64_tr_b16 v[224:225], v10 offset:24576
    ds_read_b64_tr_b16 v[226:227], v10 offset:25088
    ds_read_b64_tr_b16 v[240:241], v11 offset:6144
    ds_read_b64_tr_b16 v[242:243], v11 offset:6272
    v_mfma_f32_32x32x16_bf16 v[48:63], v[228:231], v[24:27], v[48:63]
    v_mfma_f32_32x32x16_bf16 v[64:79], v[244:247], v[132:135], v[64:79]
    v_mfma_f32_32x32x16_bf16 v[80:95], v[244:247], v[24:27], v[80:95]
    s_waitcnt lgkmcnt(8)
    v_mfma_f32_32x32x16_bf16 v[32:47], v[232:235], v[136:139], v[32:47]
    ds_read_b64_tr_b16 v[228:229], v10 offset:26624
    ds_read_b64_tr_b16 v[230:231], v10 offset:27136
    ds_read_b64_tr_b16 v[244:245], v11 offset:6656
    ds_read_b64_tr_b16 v[246:247], v11 offset:6784
    v_mfma_f32_32x32x16_bf16 v[48:63], v[232:235], v[24:27], v[48:63]
    v_mfma_f32_32x32x16_bf16 v[64:79], v[248:251], v[136:139], v[64:79]
    v_mfma_f32_32x32x16_bf16 v[80:95], v[248:251], v[24:27], v[80:95]
    s_waitcnt lgkmcnt(8)
    v_mfma_f32_32x32x16_bf16 v[32:47], v[236:239], v[140:143], v[32:47]
    ds_read_b64_tr_b16 v[232:233], v10 offset:28672
    ds_read_b64_tr_b16 v[234:235], v10 offset:29184
    ds_read_b64_tr_b16 v[248:249], v11 offset:7168
    ds_read_b64_tr_b16 v[250:251], v11 offset:7296
    v_mfma_f32_32x32x16_bf16 v[48:63], v[236:239], v[24:27], v[48:63]
    v_mfma_f32_32x32x16_bf16 v[64:79], v[252:255], v[140:143], v[64:79]
    v_mfma_f32_32x32x16_bf16 v[80:95], v[252:255], v[24:27], v[80:95]
    s_waitcnt lgkmcnt(8)
    v_mfma_f32_32x32x16_bf16 v[32:47], v[224:227], v[144:147], v[32:47]
    ds_read_b64_tr_b16 v[236:237], v10 offset:30720
    ds_read_b64_tr_b16 v[238:239], v10 offset:31232
    ds_read_b64_tr_b16 v[252:253], v11 offset:7680
    ds_read_b64_tr_b16 v[254:255], v11 offset:7808
    v_mfma_f32_32x32x16_bf16 v[48:63], v[224:227], v[24:27], v[48:63]
    v_mfma_f32_32x32x16_bf16 v[64:79], v[240:243], v[144:147], v[64:79]
    v_mfma_f32_32x32x16_bf16 v[80:95], v[240:243], v[24:27], v[80:95]
    s_waitcnt lgkmcnt(8)
    v_mfma_f32_32x32x16_bf16 v[32:47], v[228:231], v[148:151], v[32:47]
    v_mfma_f32_32x32x16_bf16 v[48:63], v[228:231], v[24:27], v[48:63]
    v_mfma_f32_32x32x16_bf16 v[64:79], v[244:247], v[148:151], v[64:79]
    v_mfma_f32_32x32x16_bf16 v[80:95], v[244:247], v[24:27], v[80:95]
    s_waitcnt lgkmcnt(4)
    v_mfma_f32_32x32x16_bf16 v[32:47], v[232:235], v[152:155], v[32:47]
    v_mfma_f32_32x32x16_bf16 v[48:63], v[232:235], v[24:27], v[48:63]
    v_mfma_f32_32x32x16_bf16 v[64:79], v[248:251], v[152:155], v[64:79]
    v_mfma_f32_32x32x16_bf16 v[80:95], v[248:251], v[24:27], v[80:95]
    s_waitcnt lgkmcnt(0)
    v_mfma_f32_32x32x16_bf16 v[32:47], v[236:239], v[156:159], v[32:47]
    v_mfma_f32_32x32x16_bf16 v[48:63], v[236:239], v[24:27], v[48:63]
    v_mfma_f32_32x32x16_bf16 v[64:79], v[252:255], v[156:159], v[64:79]
    v_mfma_f32_32x32x16_bf16 v[80:95], v[252:255], v[24:27], v[80:95]
    s_waitcnt vmcnt(8)
    s_barrier
    ds_read_b64_tr_b16 v[224:225], v10 offset:32768
    ds_read_b64_tr_b16 v[226:227], v10 offset:33280
    ds_read_b64_tr_b16 v[240:241], v11 offset:8192
    ds_read_b64_tr_b16 v[242:243], v11 offset:8320
    ds_read_b64_tr_b16 v[228:229], v10 offset:34816
    ds_read_b64_tr_b16 v[230:231], v10 offset:35328
    ds_read_b64_tr_b16 v[244:245], v11 offset:8704
    ds_read_b64_tr_b16 v[246:247], v11 offset:8832
    ds_read_b64_tr_b16 v[232:233], v10 offset:36864
    ds_read_b64_tr_b16 v[234:235], v10 offset:37376
    ds_read_b64_tr_b16 v[248:249], v11 offset:9216
    ds_read_b64_tr_b16 v[250:251], v11 offset:9344
    s_waitcnt lgkmcnt(8)
    v_mfma_f32_32x32x16_bf16 v[32:47], v[224:227], v[160:163], v[32:47]
    ds_read_b64_tr_b16 v[236:237], v10 offset:38912
    ds_read_b64_tr_b16 v[238:239], v10 offset:39424
    ds_read_b64_tr_b16 v[252:253], v11 offset:9728
    ds_read_b64_tr_b16 v[254:255], v11 offset:9856
    v_mfma_f32_32x32x16_bf16 v[48:63], v[224:227], v[24:27], v[48:63]
    v_mfma_f32_32x32x16_bf16 v[64:79], v[240:243], v[160:163], v[64:79]
    v_mfma_f32_32x32x16_bf16 v[80:95], v[240:243], v[24:27], v[80:95]
    s_waitcnt lgkmcnt(8)
    v_mfma_f32_32x32x16_bf16 v[32:47], v[228:231], v[164:167], v[32:47]
    ds_read_b64_tr_b16 v[224:225], v10 offset:40960
    ds_read_b64_tr_b16 v[226:227], v10 offset:41472
    ds_read_b64_tr_b16 v[240:241], v11 offset:10240
    ds_read_b64_tr_b16 v[242:243], v11 offset:10368
    v_mfma_f32_32x32x16_bf16 v[48:63], v[228:231], v[24:27], v[48:63]
    v_mfma_f32_32x32x16_bf16 v[64:79], v[244:247], v[164:167], v[64:79]
    v_mfma_f32_32x32x16_bf16 v[80:95], v[244:247], v[24:27], v[80:95]
    s_waitcnt lgkmcnt(8)
    v_mfma_f32_32x32x16_bf16 v[32:47], v[232:235], v[168:171], v[32:47]
    ds_read_b64_tr_b16 v[228:229], v10 offset:43008
    ds_read_b64_tr_b16 v[230:231], v10 offset:43520
    ds_read_b64_tr_b16 v[244:245], v11 offset:10752
    ds_read_b64_tr_b16 v[246:247], v11 offset:10880
    v_mfma_f32_32x32x16_bf16 v[48:63], v[232:235], v[24:27], v[48:63]
    v_mfma_f32_32x32x16_bf16 v[64:79], v[248:251], v[168:171], v[64:79]
    v_mfma_f32_32x32x16_bf16 v[80:95], v[248:251], v[24:27], v[80:95]
    s_waitcnt lgkmcnt(8)
    v_mfma_f32_32x32x16_bf16 v[32:47], v[236:239], v[172:175], v[32:47]
    ds_read_b64_tr_b16 v[232:233], v10 offset:45056
    ds_read_b64_tr_b16 v[234:235], v10 offset:45568
    ds_read_b64_tr_b16 v[248:249], v11 offset:11264
    ds_read_b64_tr_b16 v[250:251], v11 offset:11392
    v_mfma_f32_32x32x16_bf16 v[48:63], v[236:239], v[24:27], v[48:63]
    v_mfma_f32_32x32x16_bf16 v[64:79], v[252:255], v[172:175], v[64:79]
    v_mfma_f32_32x32x16_bf16 v[80:95], v[252:255], v[24:27], v[80:95]
    s_waitcnt lgkmcnt(8)
    v_mfma_f32_32x32x16_bf16 v[32:47], v[224:227], v[176:179], v[32:47]
    ds_read_b64_tr_b16 v[236:237], v10 offset:47104
    ds_read_b64_tr_b16 v[238:239], v10 offset:47616
    ds_read_b64_tr_b16 v[252:253], v11 offset:11776
    ds_read_b64_tr_b16 v[254:255], v11 offset:11904
    v_mfma_f32_32x32x16_bf16 v[48:63], v[224:227], v[24:27], v[48:63]
    v_mfma_f32_32x32x16_bf16 v[64:79], v[240:243], v[176:179], v[64:79]
    v_mfma_f32_32x32x16_bf16 v[80:95], v[240:243], v[24:27], v[80:95]
    s_waitcnt lgkmcnt(8)
    v_mfma_f32_32x32x16_bf16 v[32:47], v[228:231], v[180:183], v[32:47]
    v_mfma_f32_32x32x16_bf16 v[48:63], v[228:231], v[24:27], v[48:63]
    v_mfma_f32_32x32x16_bf16 v[64:79], v[244:247], v[180:183], v[64:79]
    v_mfma_f32_32x32x16_bf16 v[80:95], v[244:247], v[24:27], v[80:95]
    s_waitcnt lgkmcnt(4)
    v_mfma_f32_32x32x16_bf16 v[32:47], v[232:235], v[184:187], v[32:47]
    v_mfma_f32_32x32x16_bf16 v[48:63], v[232:235], v[24:27], v[48:63]
    v_mfma_f32_32x32x16_bf16 v[64:79], v[248:251], v[184:187], v[64:79]
    v_mfma_f32_32x32x16_bf16 v[80:95], v[248:251], v[24:27], v[80:95]
    s_waitcnt lgkmcnt(0)
    v_mfma_f32_32x32x16_bf16 v[32:47], v[236:239], v[188:191], v[32:47]
    v_mfma_f32_32x32x16_bf16 v[48:63], v[236:239], v[24:27], v[48:63]
    v_mfma_f32_32x32x16_bf16 v[64:79], v[252:255], v[188:191], v[64:79]
    v_mfma_f32_32x32x16_bf16 v[80:95], v[252:255], v[24:27], v[80:95]
    s_waitcnt vmcnt(0)
    s_barrier
    ds_read_b64_tr_b16 v[224:225], v10 offset:49152
    ds_read_b64_tr_b16 v[226:227], v10 offset:49664
    ds_read_b64_tr_b16 v[240:241], v11 offset:12288
    ds_read_b64_tr_b16 v[242:243], v11 offset:12416
    ds_read_b64_tr_b16 v[228:229], v10 offset:51200
    ds_read_b64_tr_b16 v[230:231], v10 offset:51712
    ds_read_b64_tr_b16 v[244:245], v11 offset:12800
    ds_read_b64_tr_b16 v[246:247], v11 offset:12928
    ds_read_b64_tr_b16 v[232:233], v10 offset:53248
    ds_read_b64_tr_b16 v[234:235], v10 offset:53760
    ds_read_b64_tr_b16 v[248:249], v11 offset:13312
    ds_read_b64_tr_b16 v[250:251], v11 offset:13440
    s_waitcnt lgkmcnt(8)
    v_mfma_f32_32x32x16_bf16 v[32:47], v[224:227], v[192:195], v[32:47]
    ds_read_b64_tr_b16 v[236:237], v10 offset:55296
    ds_read_b64_tr_b16 v[238:239], v10 offset:55808
    ds_read_b64_tr_b16 v[252:253], v11 offset:13824
    ds_read_b64_tr_b16 v[254:255], v11 offset:13952
    v_mfma_f32_32x32x16_bf16 v[48:63], v[224:227], v[24:27], v[48:63]
    v_mfma_f32_32x32x16_bf16 v[64:79], v[240:243], v[192:195], v[64:79]
    v_mfma_f32_32x32x16_bf16 v[80:95], v[240:243], v[24:27], v[80:95]
    s_waitcnt lgkmcnt(8)
    v_mfma_f32_32x32x16_bf16 v[32:47], v[228:231], v[196:199], v[32:47]
    ds_read_b64_tr_b16 v[224:225], v10 offset:57344
    ds_read_b64_tr_b16 v[226:227], v10 offset:57856
    ds_read_b64_tr_b16 v[240:241], v11 offset:14336
    ds_read_b64_tr_b16 v[242:243], v11 offset:14464
    v_mfma_f32_32x32x16_bf16 v[48:63], v[228:231], v[24:27], v[48:63]
    v_mfma_f32_32x32x16_bf16 v[64:79], v[244:247], v[196:199], v[64:79]
    v_mfma_f32_32x32x16_bf16 v[80:95], v[244:247], v[24:27], v[80:95]
    s_waitcnt lgkmcnt(8)
    v_mfma_f32_32x32x16_bf16 v[32:47], v[232:235], v[200:203], v[32:47]
    ds_read_b64_tr_b16 v[228:229], v10 offset:59392
    ds_read_b64_tr_b16 v[230:231], v10 offset:59904
    ds_read_b64_tr_b16 v[244:245], v11 offset:14848
    ds_read_b64_tr_b16 v[246:247], v11 offset:14976
    v_mfma_f32_32x32x16_bf16 v[48:63], v[232:235], v[24:27], v[48:63]
    v_mfma_f32_32x32x16_bf16 v[64:79], v[248:251], v[200:203], v[64:79]
    v_mfma_f32_32x32x16_bf16 v[80:95], v[248:251], v[24:27], v[80:95]
    s_waitcnt lgkmcnt(8)
    v_mfma_f32_32x32x16_bf16 v[32:47], v[236:239], v[204:207], v[32:47]
    ds_read_b64_tr_b16 v[232:233], v10 offset:61440
    ds_read_b64_tr_b16 v[234:235], v10 offset:61952
    ds_read_b64_tr_b16 v[248:249], v11 offset:15360
    ds_read_b64_tr_b16 v[250:251], v11 offset:15488
    v_mfma_f32_32x32x16_bf16 v[48:63], v[236:239], v[24:27], v[48:63]
    v_mfma_f32_32x32x16_bf16 v[64:79], v[252:255], v[204:207], v[64:79]
    v_mfma_f32_32x32x16_bf16 v[80:95], v[252:255], v[24:27], v[80:95]
    s_waitcnt lgkmcnt(8)
    v_mfma_f32_32x32x16_bf16 v[32:47], v[224:227], v[208:211], v[32:47]
    ds_read_b64_tr_b16 v[236:237], v10 offset:63488
    ds_read_b64_tr_b16 v[238:239], v10 offset:64000
    ds_read_b64_tr_b16 v[252:253], v11 offset:15872
    ds_read_b64_tr_b16 v[254:255], v11 offset:16000
    v_mfma_f32_32x32x16_bf16 v[48:63], v[224:227], v[24:27], v[48:63]
    v_mfma_f32_32x32x16_bf16 v[64:79], v[240:243], v[208:211], v[64:79]
    v_mfma_f32_32x32x16_bf16 v[80:95], v[240:243], v[24:27], v[80:95]
    s_waitcnt lgkmcnt(8)
    v_mfma_f32_32x32x16_bf16 v[32:47], v[228:231], v[212:215], v[32:47]
    v_mfma_f32_32x32x16_bf16 v[48:63], v[228:231], v[24:27], v[48:63]
    v_mfma_f32_32x32x16_bf16 v[64:79], v[244:247], v[212:215], v[64:79]
    v_mfma_f32_32x32x16_bf16 v[80:95], v[244:247], v[24:27], v[80:95]
    s_waitcnt lgkmcnt(4)
    v_mfma_f32_32x32x16_bf16 v[32:47], v[232:235], v[216:219], v[32:47]
    v_mfma_f32_32x32x16_bf16 v[48:63], v[232:235], v[24:27], v[48:63]
    v_mfma_f32_32x32x16_bf16 v[64:79], v[248:251], v[216:219], v[64:79]
    v_mfma_f32_32x32x16_bf16 v[80:95], v[248:251], v[24:27], v[80:95]
    s_waitcnt lgkmcnt(0)
    v_mfma_f32_32x32x16_bf16 v[32:47], v[236:239], v[220:223], v[32:47]
    v_mfma_f32_32x32x16_bf16 v[48:63], v[236:239], v[24:27], v[48:63]
    v_mfma_f32_32x32x16_bf16 v[64:79], v[252:255], v[220:223], v[64:79]
    v_mfma_f32_32x32x16_bf16 v[80:95], v[252:255], v[24:27], v[80:95]
sequenti_done2:
    v_and_b32 v7, 31, v1
    s_lshl_b32 s58, s56, 5
    s_add_u32 s58, s58, s51
    v_add_u32 v7, s58, v7
    v_lshrrev_b32 v8, 5, v1
    v_lshlrev_b32 v9, 3, v8
    v_lshl_add_u32 v12, v7, 10, v9
    s_lshl_b32 s59, s49, 7
    s_lshl_b32 s60, s57, 6
    s_add_u32 s59, s59, s60
    s_add_u32 s59, s59, 0x0
    s_nop 15
    v_fma_f32 v32, -v28, v48, v32
    v_fma_f32 v33, -v28, v49, v33
    v_fma_f32 v34, -v28, v50, v34
    v_fma_f32 v35, -v28, v51, v35
    v_fma_f32 v36, -v28, v52, v36
    v_fma_f32 v37, -v28, v53, v37
    v_fma_f32 v38, -v28, v54, v38
    v_fma_f32 v39, -v28, v55, v39
    v_fma_f32 v40, -v28, v56, v40
    v_fma_f32 v41, -v28, v57, v41
    v_fma_f32 v42, -v28, v58, v42
    v_fma_f32 v43, -v28, v59, v43
    v_fma_f32 v44, -v28, v60, v44
    v_fma_f32 v45, -v28, v61, v45
    v_fma_f32 v46, -v28, v62, v46
    v_fma_f32 v47, -v28, v63, v47
    v_mul_f32 v32, v30, v32
    v_mul_f32 v33, v30, v33
    v_mul_f32 v34, v30, v34
    v_mul_f32 v35, v30, v35
    v_mul_f32 v36, v30, v36
    v_mul_f32 v37, v30, v37
    v_mul_f32 v38, v30, v38
    v_mul_f32 v39, v30, v39
    v_mul_f32 v40, v30, v40
    v_mul_f32 v41, v30, v41
    v_mul_f32 v42, v30, v42
    v_mul_f32 v43, v30, v43
    v_mul_f32 v44, v30, v44
    v_mul_f32 v45, v30, v45
    v_mul_f32 v46, v30, v46
    v_mul_f32 v47, v30, v47
    v_cvt_pk_bf16_f32 v224, v32, v33
    v_cvt_pk_bf16_f32 v225, v34, v35
    v_cvt_pk_bf16_f32 v226, v36, v37
    v_cvt_pk_bf16_f32 v227, v38, v39
    v_cvt_pk_bf16_f32 v228, v40, v41
    v_cvt_pk_bf16_f32 v229, v42, v43
    v_cvt_pk_bf16_f32 v230, v44, v45
    v_cvt_pk_bf16_f32 v231, v46, v47
    buffer_store_dwordx2 v[224:225], v12, s[20:23], s59 offen offset:0
    buffer_store_dwordx2 v[226:227], v12, s[20:23], s59 offen offset:16
    buffer_store_dwordx2 v[228:229], v12, s[20:23], s59 offen offset:32
    buffer_store_dwordx2 v[230:231], v12, s[20:23], s59 offen offset:48
    s_cmp_eq_u32 s53, 0
    s_cbranch_scc1 sequenti_end1
    v_fma_f32 v64, -v28, v80, v64
    v_fma_f32 v65, -v28, v81, v65
    v_fma_f32 v66, -v28, v82, v66
    v_fma_f32 v67, -v28, v83, v67
    v_fma_f32 v68, -v28, v84, v68
    v_fma_f32 v69, -v28, v85, v69
    v_fma_f32 v70, -v28, v86, v70
    v_fma_f32 v71, -v28, v87, v71
    v_fma_f32 v72, -v28, v88, v72
    v_fma_f32 v73, -v28, v89, v73
    v_fma_f32 v74, -v28, v90, v74
    v_fma_f32 v75, -v28, v91, v75
    v_fma_f32 v76, -v28, v92, v76
    v_fma_f32 v77, -v28, v93, v77
    v_fma_f32 v78, -v28, v94, v78
    v_fma_f32 v79, -v28, v95, v79
    v_mul_f32 v64, v29, v64
    v_mul_f32 v65, v29, v65
    v_mul_f32 v66, v29, v66
    v_mul_f32 v67, v29, v67
    v_mul_f32 v68, v29, v68
    v_mul_f32 v69, v29, v69
    v_mul_f32 v70, v29, v70
    v_mul_f32 v71, v29, v71
    v_mul_f32 v72, v29, v72
    v_mul_f32 v73, v29, v73
    v_mul_f32 v74, v29, v74
    v_mul_f32 v75, v29, v75
    v_mul_f32 v76, v29, v76
    v_mul_f32 v77, v29, v77
    v_mul_f32 v78, v29, v78
    v_mul_f32 v79, v29, v79
    v_cvt_pk_bf16_f32 v80, v64, v65
    v_cvt_pk_bf16_f32 v81, v66, v67
    v_cvt_pk_bf16_f32 v82, v68, v69
    v_cvt_pk_bf16_f32 v83, v70, v71
    v_cvt_pk_bf16_f32 v84, v72, v73
    v_cvt_pk_bf16_f32 v85, v74, v75
    v_cvt_pk_bf16_f32 v86, v76, v77
    v_cvt_pk_bf16_f32 v87, v78, v79
    v_mov_b32 v14, 0
    v_dot2c_f32_bf16 v14, v80, v80
    v_dot2c_f32_bf16 v14, v81, v81
    v_dot2c_f32_bf16 v14, v82, v82
    v_dot2c_f32_bf16 v14, v83, v83
    s_nop 4
    v_mov_b32 v15, v14
    s_nop 1
    v_permlane32_swap_b32 v14, v15
    s_nop 1
    v_add_f32 v14, v14, v15
    s_nop 1
    v_max_f32_dpp v14, v14, v14 row_ror:8 row_mask:0xf bank_mask:0xf
    s_nop 1
    v_max_f32_dpp v14, v14, v14 row_ror:4 row_mask:0xf bank_mask:0xf
    s_nop 1
    v_max_f32_dpp v14, v14, v14 row_ror:2 row_mask:0xf bank_mask:0xf
    s_nop 1
    v_max_f32_dpp v14, v14, v14 row_ror:1 row_mask:0xf bank_mask:0xf
    s_nop 1
    v_readlane_b32 s60, v14, 0
    v_readlane_b32 s61, v14, 16
    s_nop 3
    s_max_u32 s60, s60, s61
    v_mov_b32 v14, s60
    v_mov_b32 v15, 0
    s_lshl_b32 s61, s48, 1
    s_add_u32 s61, s61, s56
    s_lshl_b32 s61, s61, 2
    s_add_u32 s61, s61, 0x228000
    s_mov_b64 exec, 1
    buffer_store_dword v14, v15, s[20:23], s61 offen
    s_mov_b64 exec, -1
    v_and_b32 v13, 31, v1
    v_lshlrev_b32 v13, 4, v13
    v_lshl_add_u32 v13, v8, 3, v13
    s_lshl_b32 s59, s48, 1
    s_add_u32 s59, s59, s56
    s_lshl_b32 s59, s59, 10
    s_add_u32 s59, s59, 0x200000
    buffer_store_dwordx2 v[80:81], v13, s[20:23], s59 offen
    buffer_store_dwordx2 v[82:83], v13, s[20:23], s59 offen offset:512
    v_lshrrev_b32 v13, 4, v7
    v_lshlrev_b32 v13, 9, v13
    v_bfe_u32 v14, v7, 2, 1
    v_lshl_add_u32 v13, v14, 8, v13
    v_bfe_u32 v14, v7, 3, 1
    v_lshl_add_u32 v13, v14, 3, v13
    v_and_b32 v14, 3, v7
    v_lshl_add_u32 v13, v14, 1, v13
    v_lshl_add_u32 v13, v8, 6, v13
    s_mov_b32 s59, 0x210000
    buffer_store_short v84, v13, s[20:23], s59 offen offset:0
    buffer_store_short_d16_hi v84, v13, s[20:23], s59 offen offset:16
    buffer_store_short v85, v13, s[20:23], s59 offen offset:32
    buffer_store_short_d16_hi v85, v13, s[20:23], s59 offen offset:48
    buffer_store_short v86, v13, s[20:23], s59 offen offset:128
    buffer_store_short_d16_hi v86, v13, s[20:23], s59 offen offset:144
    buffer_store_short v87, v13, s[20:23], s59 offen offset:160
    buffer_store_short_d16_hi v87, v13, s[20:23], s59 offen offset:176
sequenti_end1:
    s_endpgm
.globl attn_kernel
.p2align 8
.type attn_kernel,@function
attn_kernel:
    s_cmp_ge_u32 s2, 256
    s_cbranch_scc1 attn_end1
    s_load_dwordx2 s[32:33], s[0:1], 88
    s_load_dwordx4 s[36:39], s[0:1], 48
    s_load_dwordx2 s[40:41], s[0:1], 64
    s_load_dwordx2 s[42:43], s[0:1], 32
    v_and_b32 v1, 63, v0
    v_lshrrev_b32 v2, 6, v0
    s_nop 1
    v_readfirstlane_b32 s3, v2
    v_and_b32 v2, 31, v1
    v_lshlrev_b32 v2, 5, v2
    v_lshrrev_b32 v3, 5, v1
    v_lshl_add_u32 v2, v3, 4, v2
    v_lshlrev_b32 v8, 4, v1
    s_and_b32 s48, s3, 7
    s_lshr_b32 s49, s3, 3
    s_lshl_b32 s50, s2, 3
    s_add_u32 s50, s50, s48
    s_lshl_b32 s51, s50, 10
    s_add_u32 s51, s51, 0x0
    s_lshr_b32 s52, s3, 3
    s_lshl_b32 s52, s52, 15
    s_and_b32 s53, s3, 7
    s_lshl_b32 s53, s53, 10
    s_add_u32 s52, s52, s53
    s_waitcnt lgkmcnt(0)
    s_mov_b32 s20, s32
    s_and_b32 s21, s33, 0xffff
    s_mov_b32 s22, 0x10000000
    s_mov_b32 s23, 0x00020000
    buffer_load_dwordx4 v[4:7], v2, s[20:23], s51 offen
    s_lshr_b32 s60, s3, 3
    s_lshl_b32 s60, s60, 8
    s_add_u32 s60, s60, s2
    s_cmp_ge_u32 s60, 16
    s_cbranch_scc1 attn_zf2
    s_lshl_b32 s60, s2, 13
    s_lshl_b32 s61, s3, 10
    s_add_u32 s60, s60, s61
    s_add_u32 s60, s60, 0x280000
    v_mov_b32 v12, 0
    v_mov_b32 v13, 0
    v_mov_b32 v14, 0
    v_mov_b32 v15, 0
    buffer_store_dwordx4 v[12:15], v8, s[20:23], s60 offen
attn_zf2:
    s_lshl_b32 s54, s49, 7
    s_add_u32 s54, s54, 0x228000
    s_add_u32 s56, s32, s54
    s_addc_u32 s57, s33, 0
    s_load_dwordx16 s[64:79], s[56:57], 0
    s_load_dwordx16 s[80:95], s[56:57], 64
    s_add_u32 m0, s52, 0
    s_add_u32 s53, s52, 0x200000
    buffer_load_dwordx4 v8, s[20:23], s53 offen lds
    s_add_u32 m0, s52, 65536
    s_add_u32 s53, s52, 0x210000
    buffer_load_dwordx4 v8, s[20:23], s53 offen lds
    s_add_u32 m0, s52, 8192
    s_add_u32 s53, s52, 0x202000
    buffer_load_dwordx4 v8, s[20:23], s53 offen lds
    s_add_u32 m0, s52, 73728
    s_add_u32 s53, s52, 0x212000
    buffer_load_dwordx4 v8, s[20:23], s53 offen lds
    s_add_u32 m0, s52, 16384
    s_add_u32 s53, s52, 0x204000
    buffer_load_dwordx4 v8, s[20:23], s53 offen lds
    s_add_u32 m0, s52, 81920
    s_add_u32 s53, s52, 0x214000
    buffer_load_dwordx4 v8, s[20:23], s53 offen lds
    s_add_u32 m0, s52, 24576
    s_add_u32 s53, s52, 0x206000
    buffer_load_dwordx4 v8, s[20:23], s53 offen lds
    s_add_u32 m0, s52, 90112
    s_add_u32 s53, s52, 0x216000
    buffer_load_dwordx4 v8, s[20:23], s53 offen lds
    s_lshl_b32 s54, s49, 15
    v_add_u32 v9, s54, v8
    v_and_b32 v10, 15, v1
    v_lshlrev_b32 v10, 4, v10
    v_lshl_add_u32 v10, v3, 8, v10
    v_add_u32 v10, s54, v10
    v_add_u32 v10, 0x10000, v10
    v_mov_b32 v100, 0x3f803f80
    v_mov_b32 v101, 0x3f803f80
    v_mov_b32 v102, 0x3f803f80
    v_mov_b32 v103, 0x3f803f80
    v_mov_b32 v104, 0x3f803f80
    v_mov_b32 v105, 0x3f803f80
    v_mov_b32 v106, 0x3f803f80
    v_mov_b32 v107, 0x3f803f80
    v_mov_b32 v108, 0x3f803f80
    v_mov_b32 v109, 0x3f803f80
    v_mov_b32 v110, 0x3f803f80
    v_mov_b32 v111, 0x3f803f80
    v_mov_b32 v112, 0x3f803f80
    v_mov_b32 v113, 0x3f803f80
    v_mov_b32 v114, 0x3f803f80
    v_mov_b32 v115, 0x3f803f80
    s_mov_b32 s58, 0xffff
    s_mov_b32 s59, 0xffff
    s_waitcnt lgkmcnt(0)
    s_max_u32 s64, s64, s65
    s_max_u32 s64, s64, s66
    s_max_u32 s64, s64, s67
    s_max_u32 s64, s64, s68
    s_max_u32 s64, s64, s69
    s_max_u32 s64, s64, s70
    s_max_u32 s64, s64, s71
    s_max_u32 s64, s64, s72
    s_max_u32 s64, s64, s73
    s_max_u32 s64, s64, s74
    s_max_u32 s64, s64, s75
    s_max_u32 s64, s64, s76
    s_max_u32 s64, s64, s77
    s_max_u32 s64, s64, s78
    s_max_u32 s64, s64, s79
    s_max_u32 s64, s64, s80
    s_max_u32 s64, s64, s81
    s_max_u32 s64, s64, s82
    s_max_u32 s64, s64, s83
    s_max_u32 s64, s64, s84
    s_max_u32 s64, s64, s85
    s_max_u32 s64, s64, s86
    s_max_u32 s64, s64, s87
    s_max_u32 s64, s64, s88
    s_max_u32 s64, s64, s89
    s_max_u32 s64, s64, s90
    s_max_u32 s64, s64, s91
    s_max_u32 s64, s64, s92
    s_max_u32 s64, s64, s93
    s_max_u32 s64, s64, s94
    s_max_u32 s64, s64, s95
    v_mov_b32 v12, 0
    s_waitcnt vmcnt(8)
    v_dot2c_f32_bf16 v12, v4, v4
    v_dot2c_f32_bf16 v12, v5, v5
    v_dot2c_f32_bf16 v12, v6, v6
    v_dot2c_f32_bf16 v12, v7, v7
    s_nop 4
    v_mov_b32 v13, v12
    s_nop 1
    v_permlane32_swap_b32 v12, v13
    s_nop 1
    v_add_f32 v12, v12, v13
    v_mul_f32 v12, s64, v12
    v_sqrt_f32 v11, v12
    s_nop 1
    v_xor_b32 v16, 0x80000000, v11
    v_xor_b32 v17, 0x80000000, v11
    v_xor_b32 v18, 0x80000000, v11
    v_xor_b32 v19, 0x80000000, v11
    v_xor_b32 v20, 0x80000000, v11
    v_xor_b32 v21, 0x80000000, v11
    v_xor_b32 v22, 0x80000000, v11
    v_xor_b32 v23, 0x80000000, v11
    v_xor_b32 v24, 0x80000000, v11
    v_xor_b32 v25, 0x80000000, v11
    v_xor_b32 v26, 0x80000000, v11
    v_xor_b32 v27, 0x80000000, v11
    v_xor_b32 v28, 0x80000000, v11
    v_xor_b32 v29, 0x80000000, v11
    v_xor_b32 v30, 0x80000000, v11
    v_xor_b32 v31, 0x80000000, v11
    s_waitcnt vmcnt(6)
    s_barrier
    ds_read_b128 v[88:91], v9 offset:0
    ds_read_b128 v[92:95], v9 offset:1024
    s_mov_b64 exec, s[58:59]
    ds_read_b128 v[100:103], v10 offset:0
    ds_read_b128 v[104:107], v10 offset:512
    s_mov_b64 exec, -1
    s_waitcnt lgkmcnt(3)
    v_mfma_f32_32x32x16_bf16 v[32:47], v[88:91], v[4:7], v[16:31]
    s_setprio 2
    ds_read_b128 v[96:99], v9 offset:2048
    s_waitcnt lgkmcnt(3)
    v_mfma_f32_32x32x16_bf16 v[48:63], v[92:95], v[4:7], v[16:31]
    s_nop 10
    v_exp_f32 v32, v32
    v_exp_f32 v33, v33
    v_exp_f32 v34, v34
    v_exp_f32 v35, v35
    v_exp_f32 v36, v36
    v_exp_f32 v37, v37
    v_exp_f32 v38, v38
    v_exp_f32 v39, v39
    v_exp_f32 v40, v40
    v_exp_f32 v41, v41
    v_exp_f32 v42, v42
    v_exp_f32 v43, v43
    v_exp_f32 v44, v44
    v_exp_f32 v45, v45
    v_exp_f32 v46, v46
    v_exp_f32 v47, v47
    v_cvt_pk_bf16_f32 v80, v32, v33
    v_cvt_pk_bf16_f32 v81, v34, v35
    v_cvt_pk_bf16_f32 v82, v36, v37
    v_cvt_pk_bf16_f32 v83, v38, v39
    v_cvt_pk_bf16_f32 v84, v40, v41
    v_cvt_pk_bf16_f32 v85, v42, v43
    v_cvt_pk_bf16_f32 v86, v44, v45
    v_cvt_pk_bf16_f32 v87, v46, v47
    s_waitcnt lgkmcnt(1)
    v_mfma_f32_32x32x16_bf16 v[64:79], v[100:103], v[80:83], 0
    v_mfma_f32_32x32x16_bf16 v[64:79], v[104:107], v[84:87], v[64:79]
    s_mov_b64 exec, s[58:59]
    ds_read_b128 v[108:111], v10 offset:1024
    ds_read_b128 v[112:115], v10 offset:1536
    s_mov_b64 exec, -1
    s_lshl_b32 s64, s2, 4
    s_add_u32 s64, s64, s3
    s_cmp_ge_u32 s64, 2752
    s_cbranch_scc1 attn_rdn3
    s_lshr_b32 s65, s64, 5
    s_and_b32 s66, s64, 31
    s_cmp_ge_u32 s65, 43
    s_cselect_b32 s67, 1, 0
    s_cselect_b32 s84, s38, s36
    s_cselect_b32 s85, s39, s37
    s_mul_i32 s68, s67, 43
    s_sub_u32 s65, s65, s68
    s_mul_i32 s68, s65, 171
    s_lshr_b32 s68, s68, 9
    s_mul_i32 s69, s68, 3
    s_sub_u32 s69, s65, s69
    s_mul_i32 s70, s66, 6
    s_mul_i32 s71, s67, 3
    s_add_u32 s70, s70, s71
    s_add_u32 s70, s70, s69
    s_mul_i32 s71, s69, 32
    s_lshl_b32 s72, s66, 1
    s_add_u32 s71, s71, s72
    s_add_u32 s71, s71, s67
    s_add_u32 s71, s71, 64
    s_cmp_lt_u32 s66, 16
    s_cselect_b32 s70, s70, s71
    s_lshl_b32 s70, s70, 10
    s_mul_i32 s90, s68, 196608
    s_add_u32 s90, s90, s70
    s_add_u32 s90, s90, 0x1000000
    s_mov_b32 s86, 1409024
    s_mov_b32 s89, 2752
    s_branch attn_rgo4
attn_rdn3:
    s_sub_u32 s64, s64, 2752
    s_cmp_ge_u32 s64, 1376
    s_cselect_b32 s84, s42, s40
    s_cselect_b32 s85, s43, s41
    s_mov_b32 s86, 1409024
    s_mov_b32 s68, 176128
    s_mov_b32 s90, 0x1400000
    s_cselect_b32 s86, 524288, s86
    s_cselect_b32 s67, 1376, 0
    s_cselect_b32 s68, 65536, s68
    s_cselect_b32 s90, 0x1600000, s90
    s_sub_u32 s64, s64, s67
    s_lshr_b32 s66, s64, 4
    s_and_b32 s65, s64, 15
    s_lshr_b32 s69, s65, 1
    s_mul_i32 s69, s69, s68
    s_add_u32 s90, s90, s69
    s_lshl_b32 s69, s66, 11
    s_add_u32 s90, s90, s69
    s_and_b32 s69, s65, 1
    s_lshl_b32 s69, s69, 10
    s_add_u32 s90, s90, s69
    s_mov_b32 s89, 1024
attn_rgo4:
    s_and_b32 s85, s85, 0xffff
    s_mov_b32 s87, 0x00020000
    s_mul_i32 s88, s66, s89
    s_lshl_b32 s88, s88, 4
    s_lshl_b32 s69, s65, 6
    s_add_u32 s88, s88, s69
    s_lshl_b32 s69, s89, 3
    v_mul_u32_u24 v14, s69, v3
    v_and_b32 v15, 31, v1
    v_lshl_add_u32 v14, v15, 1, v14
    buffer_load_ushort v116, v14, s[84:87], s88 offen
    s_add_u32 s88, s88, s89
    buffer_load_ushort v117, v14, s[84:87], s88 offen
    s_add_u32 s88, s88, s89
    buffer_load_ushort v118, v14, s[84:87], s88 offen
    s_add_u32 s88, s88, s89
    buffer_load_ushort v119, v14, s[84:87], s88 offen
    s_add_u32 s88, s88, s89
    buffer_load_ushort v120, v14, s[84:87], s88 offen
    s_add_u32 s88, s88, s89
    buffer_load_ushort v121, v14, s[84:87], s88 offen
    s_add_u32 s88, s88, s89
    buffer_load_ushort v122, v14, s[84:87], s88 offen
    s_add_u32 s88, s88, s89
    buffer_load_ushort v123, v14, s[84:87], s88 offen
    ds_read_b128 v[88:91], v9 offset:3072
    s_waitcnt lgkmcnt(3)
    v_mfma_f32_32x32x16_bf16 v[32:47], v[96:99], v[4:7], v[16:31]
    v_exp_f32 v48, v48
    v_exp_f32 v49, v49
    v_exp_f32 v50, v50
    v_exp_f32 v51, v51
    v_exp_f32 v52, v52
    v_exp_f32 v53, v53
    v_exp_f32 v54, v54
    v_exp_f32 v55, v55
    v_exp_f32 v56, v56
    v_exp_f32 v57, v57
    v_exp_f32 v58, v58
    v_exp_f32 v59, v59
    v_exp_f32 v60, v60
    v_exp_f32 v61, v61
    v_exp_f32 v62, v62
    v_exp_f32 v63, v63
    v_cvt_pk_bf16_f32 v80, v48, v49
    v_cvt_pk_bf16_f32 v81, v50, v51
    v_cvt_pk_bf16_f32 v82, v52, v53
    v_cvt_pk_bf16_f32 v83, v54, v55
    v_cvt_pk_bf16_f32 v84, v56, v57
    v_cvt_pk_bf16_f32 v85, v58, v59
    v_cvt_pk_bf16_f32 v86, v60, v61
    v_cvt_pk_bf16_f32 v87, v62, v63
    s_waitcnt lgkmcnt(1)
    v_mfma_f32_32x32x16_bf16 v[64:79], v[108:111], v[80:83], v[64:79]
    v_mfma_f32_32x32x16_bf16 v[64:79], v[112:115], v[84:87], v[64:79]
    s_mov_b64 exec, s[58:59]
    ds_read_b128 v[100:103], v10 offset:2048
    ds_read_b128 v[104:107], v10 offset:2560
    s_mov_b64 exec, -1
    s_setprio 1
    ds_read_b128 v[92:95], v9 offset:4096
    s_waitcnt lgkmcnt(3)
    v_mfma_f32_32x32x16_bf16 v[48:63], v[88:91], v[4:7], v[16:31]
    v_exp_f32 v32, v32
    v_exp_f32 v33, v33
    v_exp_f32 v34, v34
    v_exp_f32 v35, v35
    v_exp_f32 v36, v36
    v_exp_f32 v37, v37
    v_exp_f32 v38, v38
    v_exp_f32 v39, v39
    v_exp_f32 v40, v40
    v_exp_f32 v41, v41
    v_exp_f32 v42, v42
    v_exp_f32 v43, v43
    v_exp_f32 v44, v44
    v_exp_f32 v45, v45
    v_exp_f32 v46, v46
    v_exp_f32 v47, v47
    v_cvt_pk_bf16_f32 v80, v32, v33
    v_cvt_pk_bf16_f32 v81, v34, v35
    v_cvt_pk_bf16_f32 v82, v36, v37
    v_cvt_pk_bf16_f32 v83, v38, v39
    v_cvt_pk_bf16_f32 v84, v40, v41
    v_cvt_pk_bf16_f32 v85, v42, v43
    v_cvt_pk_bf16_f32 v86, v44, v45
    v_cvt_pk_bf16_f32 v87, v46, v47
    s_waitcnt lgkmcnt(1)
    v_mfma_f32_32x32x16_bf16 v[64:79], v[100:103], v[80:83], v[64:79]
    v_mfma_f32_32x32x16_bf16 v[64:79], v[104:107], v[84:87], v[64:79]
    s_mov_b64 exec, s[58:59]
    ds_read_b128 v[108:111], v10 offset:3072
    ds_read_b128 v[112:115], v10 offset:3584
    s_mov_b64 exec, -1
    ds_read_b128 v[96:99], v9 offset:5120
    s_waitcnt lgkmcnt(3)
    v_mfma_f32_32x32x16_bf16 v[32:47], v[92:95], v[4:7], v[16:31]
    v_exp_f32 v48, v48
    v_exp_f32 v49, v49
    v_exp_f32 v50, v50
    v_exp_f32 v51, v51
    v_exp_f32 v52, v52
    v_exp_f32 v53, v53
    v_exp_f32 v54, v54
    v_exp_f32 v55, v55
    v_exp_f32 v56, v56
    v_exp_f32 v57, v57
    v_exp_f32 v58, v58
    v_exp_f32 v59, v59
    v_exp_f32 v60, v60
    v_exp_f32 v61, v61
    v_exp_f32 v62, v62
    v_exp_f32 v63, v63
    v_cvt_pk_bf16_f32 v80, v48, v49
    v_cvt_pk_bf16_f32 v81, v50, v51
    v_cvt_pk_bf16_f32 v82, v52, v53
    v_cvt_pk_bf16_f32 v83, v54, v55
    v_cvt_pk_bf16_f32 v84, v56, v57
    v_cvt_pk_bf16_f32 v85, v58, v59
    v_cvt_pk_bf16_f32 v86, v60, v61
    v_cvt_pk_bf16_f32 v87, v62, v63
    s_waitcnt lgkmcnt(1)
    v_mfma_f32_32x32x16_bf16 v[64:79], v[108:111], v[80:83], v[64:79]
    v_mfma_f32_32x32x16_bf16 v[64:79], v[112:115], v[84:87], v[64:79]
    s_mov_b64 exec, s[58:59]
    ds_read_b128 v[100:103], v10 offset:4096
    ds_read_b128 v[104:107], v10 offset:4608
    s_mov_b64 exec, -1
    s_setprio 0
    ds_read_b128 v[88:91], v9 offset:6144
    s_waitcnt lgkmcnt(3)
    v_mfma_f32_32x32x16_bf16 v[48:63], v[96:99], v[4:7], v[16:31]
    v_exp_f32 v32, v32
    v_exp_f32 v33, v33
    v_exp_f32 v34, v34
    v_exp_f32 v35, v35
    v_exp_f32 v36, v36
    v_exp_f32 v37, v37
    v_exp_f32 v38, v38
    v_exp_f32 v39, v39
    v_exp_f32 v40, v40
    v_exp_f32 v41, v41
    v_exp_f32 v42, v42
    v_exp_f32 v43, v43
    v_exp_f32 v44, v44
    v_exp_f32 v45, v45
    v_exp_f32 v46, v46
    v_exp_f32 v47, v47
    v_cvt_pk_bf16_f32 v80, v32, v33
    v_cvt_pk_bf16_f32 v81, v34, v35
    v_cvt_pk_bf16_f32 v82, v36, v37
    v_cvt_pk_bf16_f32 v83, v38, v39
    v_cvt_pk_bf16_f32 v84, v40, v41
    v_cvt_pk_bf16_f32 v85, v42, v43
    v_cvt_pk_bf16_f32 v86, v44, v45
    v_cvt_pk_bf16_f32 v87, v46, v47
    s_waitcnt lgkmcnt(1)
    v_mfma_f32_32x32x16_bf16 v[64:79], v[100:103], v[80:83], v[64:79]
    v_mfma_f32_32x32x16_bf16 v[64:79], v[104:107], v[84:87], v[64:79]
    s_mov_b64 exec, s[58:59]
    ds_read_b128 v[108:111], v10 offset:5120
    ds_read_b128 v[112:115], v10 offset:5632
    s_mov_b64 exec, -1
    ds_read_b128 v[92:95], v9 offset:7168
    s_waitcnt lgkmcnt(3)
    v_mfma_f32_32x32x16_bf16 v[32:47], v[88:91], v[4:7], v[16:31]
    v_exp_f32 v48, v48
    v_exp_f32 v49, v49
    v_exp_f32 v50, v50
    v_exp_f32 v51, v51
    v_exp_f32 v52, v52
    v_exp_f32 v53, v53
    v_exp_f32 v54, v54
    v_exp_f32 v55, v55
    v_exp_f32 v56, v56
    v_exp_f32 v57, v57
    v_exp_f32 v58, v58
    v_exp_f32 v59, v59
    v_exp_f32 v60, v60
    v_exp_f32 v61, v61
    v_exp_f32 v62, v62
    v_exp_f32 v63, v63
    v_cvt_pk_bf16_f32 v80, v48, v49
    v_cvt_pk_bf16_f32 v81, v50, v51
    v_cvt_pk_bf16_f32 v82, v52, v53
    v_cvt_pk_bf16_f32 v83, v54, v55
    v_cvt_pk_bf16_f32 v84, v56, v57
    v_cvt_pk_bf16_f32 v85, v58, v59
    v_cvt_pk_bf16_f32 v86, v60, v61
    v_cvt_pk_bf16_f32 v87, v62, v63
    s_waitcnt lgkmcnt(1)
    v_mfma_f32_32x32x16_bf16 v[64:79], v[108:111], v[80:83], v[64:79]
    v_mfma_f32_32x32x16_bf16 v[64:79], v[112:115], v[84:87], v[64:79]
    s_mov_b64 exec, s[58:59]
    ds_read_b128 v[100:103], v10 offset:6144
    ds_read_b128 v[104:107], v10 offset:6656
    s_mov_b64 exec, -1
    s_setprio 3
    s_waitcnt vmcnt(12)
    s_barrier
    ds_read_b128 v[96:99], v9 offset:8192
    s_waitcnt lgkmcnt(3)
    v_mfma_f32_32x32x16_bf16 v[48:63], v[92:95], v[4:7], v[16:31]
    v_exp_f32 v32, v32
    v_exp_f32 v33, v33
    v_exp_f32 v34, v34
    v_exp_f32 v35, v35
    v_exp_f32 v36, v36
    v_exp_f32 v37, v37
    v_exp_f32 v38, v38
    v_exp_f32 v39, v39
    v_exp_f32 v40, v40
    v_exp_f32 v41, v41
    v_exp_f32 v42, v42
    v_exp_f32 v43, v43
    v_exp_f32 v44, v44
    v_exp_f32 v45, v45
    v_exp_f32 v46, v46
    v_exp_f32 v47, v47
    v_cvt_pk_bf16_f32 v80, v32, v33
    v_cvt_pk_bf16_f32 v81, v34, v35
    v_cvt_pk_bf16_f32 v82, v36, v37
    v_cvt_pk_bf16_f32 v83, v38, v39
    v_cvt_pk_bf16_f32 v84, v40, v41
    v_cvt_pk_bf16_f32 v85, v42, v43
    v_cvt_pk_bf16_f32 v86, v44, v45
    v_cvt_pk_bf16_f32 v87, v46, v47
    s_waitcnt lgkmcnt(1)
    v_mfma_f32_32x32x16_bf16 v[64:79], v[100:103], v[80:83], v[64:79]
    v_mfma_f32_32x32x16_bf16 v[64:79], v[104:107], v[84:87], v[64:79]
    s_mov_b64 exec, s[58:59]
    ds_read_b128 v[108:111], v10 offset:7168
    ds_read_b128 v[112:115], v10 offset:7680
    s_mov_b64 exec, -1
    ds_read_b128 v[88:91], v9 offset:9216
    s_waitcnt lgkmcnt(3)
    v_mfma_f32_32x32x16_bf16 v[32:47], v[96:99], v[4:7], v[16:31]
    v_exp_f32 v48, v48
    v_exp_f32 v49, v49
    v_exp_f32 v50, v50
    v_exp_f32 v51, v51
    v_exp_f32 v52, v52
    v_exp_f32 v53, v53
    v_exp_f32 v54, v54
    v_exp_f32 v55, v55
    v_exp_f32 v56, v56
    v_exp_f32 v57, v57
    v_exp_f32 v58, v58
    v_exp_f32 v59, v59
    v_exp_f32 v60, v60
    v_exp_f32 v61, v61
    v_exp_f32 v62, v62
    v_exp_f32 v63, v63
    v_cvt_pk_bf16_f32 v80, v48, v49
    v_cvt_pk_bf16_f32 v81, v50, v51
    v_cvt_pk_bf16_f32 v82, v52, v53
    v_cvt_pk_bf16_f32 v83, v54, v55
    v_cvt_pk_bf16_f32 v84, v56, v57
    v_cvt_pk_bf16_f32 v85, v58, v59
    v_cvt_pk_bf16_f32 v86, v60, v61
    v_cvt_pk_bf16_f32 v87, v62, v63
    s_waitcnt lgkmcnt(1)
    v_mfma_f32_32x32x16_bf16 v[64:79], v[108:111], v[80:83], v[64:79]
    v_mfma_f32_32x32x16_bf16 v[64:79], v[112:115], v[84:87], v[64:79]
    s_mov_b64 exec, s[58:59]
    ds_read_b128 v[100:103], v10 offset:8192
    ds_read_b128 v[104:107], v10 offset:8704
    s_mov_b64 exec, -1
    s_setprio 2
    ds_read_b128 v[92:95], v9 offset:10240
    s_waitcnt lgkmcnt(3)
    v_mfma_f32_32x32x16_bf16 v[48:63], v[88:91], v[4:7], v[16:31]
    v_exp_f32 v32, v32
    v_exp_f32 v33, v33
    v_exp_f32 v34, v34
    v_exp_f32 v35, v35
    v_exp_f32 v36, v36
    v_exp_f32 v37, v37
    v_exp_f32 v38, v38
    v_exp_f32 v39, v39
    v_exp_f32 v40, v40
    v_exp_f32 v41, v41
    v_exp_f32 v42, v42
    v_exp_f32 v43, v43
    v_exp_f32 v44, v44
    v_exp_f32 v45, v45
    v_exp_f32 v46, v46
    v_exp_f32 v47, v47
    v_cvt_pk_bf16_f32 v80, v32, v33
    v_cvt_pk_bf16_f32 v81, v34, v35
    v_cvt_pk_bf16_f32 v82, v36, v37
    v_cvt_pk_bf16_f32 v83, v38, v39
    v_cvt_pk_bf16_f32 v84, v40, v41
    v_cvt_pk_bf16_f32 v85, v42, v43
    v_cvt_pk_bf16_f32 v86, v44, v45
    v_cvt_pk_bf16_f32 v87, v46, v47
    s_waitcnt lgkmcnt(1)
    v_mfma_f32_32x32x16_bf16 v[64:79], v[100:103], v[80:83], v[64:79]
    v_mfma_f32_32x32x16_bf16 v[64:79], v[104:107], v[84:87], v[64:79]
    s_mov_b64 exec, s[58:59]
    ds_read_b128 v[108:111], v10 offset:9216
    ds_read_b128 v[112:115], v10 offset:9728
    s_mov_b64 exec, -1
    ds_read_b128 v[96:99], v9 offset:11264
    s_waitcnt lgkmcnt(3)
    v_mfma_f32_32x32x16_bf16 v[32:47], v[92:95], v[4:7], v[16:31]
    v_exp_f32 v48, v48
    v_exp_f32 v49, v49
    v_exp_f32 v50, v50
    v_exp_f32 v51, v51
    v_exp_f32 v52, v52
    v_exp_f32 v53, v53
    v_exp_f32 v54, v54
    v_exp_f32 v55, v55
    v_exp_f32 v56, v56
    v_exp_f32 v57, v57
    v_exp_f32 v58, v58
    v_exp_f32 v59, v59
    v_exp_f32 v60, v60
    v_exp_f32 v61, v61
    v_exp_f32 v62, v62
    v_exp_f32 v63, v63
    v_cvt_pk_bf16_f32 v80, v48, v49
    v_cvt_pk_bf16_f32 v81, v50, v51
    v_cvt_pk_bf16_f32 v82, v52, v53
    v_cvt_pk_bf16_f32 v83, v54, v55
    v_cvt_pk_bf16_f32 v84, v56, v57
    v_cvt_pk_bf16_f32 v85, v58, v59
    v_cvt_pk_bf16_f32 v86, v60, v61
    v_cvt_pk_bf16_f32 v87, v62, v63
    s_waitcnt lgkmcnt(1)
    v_mfma_f32_32x32x16_bf16 v[64:79], v[108:111], v[80:83], v[64:79]
    v_mfma_f32_32x32x16_bf16 v[64:79], v[112:115], v[84:87], v[64:79]
    s_mov_b64 exec, s[58:59]
    ds_read_b128 v[100:103], v10 offset:10240
    ds_read_b128 v[104:107], v10 offset:10752
    s_mov_b64 exec, -1
    s_setprio 1
    ds_read_b128 v[88:91], v9 offset:12288
    s_waitcnt lgkmcnt(3)
    v_mfma_f32_32x32x16_bf16 v[48:63], v[96:99], v[4:7], v[16:31]
    v_exp_f32 v32, v32
    v_exp_f32 v33, v33
    v_exp_f32 v34, v34
    v_exp_f32 v35, v35
    v_exp_f32 v36, v36
    v_exp_f32 v37, v37
    v_exp_f32 v38, v38
    v_exp_f32 v39, v39
    v_exp_f32 v40, v40
    v_exp_f32 v41, v41
    v_exp_f32 v42, v42
    v_exp_f32 v43, v43
    v_exp_f32 v44, v44
    v_exp_f32 v45, v45
    v_exp_f32 v46, v46
    v_exp_f32 v47, v47
    v_cvt_pk_bf16_f32 v80, v32, v33
    v_cvt_pk_bf16_f32 v81, v34, v35
    v_cvt_pk_bf16_f32 v82, v36, v37
    v_cvt_pk_bf16_f32 v83, v38, v39
    v_cvt_pk_bf16_f32 v84, v40, v41
    v_cvt_pk_bf16_f32 v85, v42, v43
    v_cvt_pk_bf16_f32 v86, v44, v45
    v_cvt_pk_bf16_f32 v87, v46, v47
    s_waitcnt lgkmcnt(1)
    v_mfma_f32_32x32x16_bf16 v[64:79], v[100:103], v[80:83], v[64:79]
    v_mfma_f32_32x32x16_bf16 v[64:79], v[104:107], v[84:87], v[64:79]
    s_mov_b64 exec, s[58:59]
    ds_read_b128 v[108:111], v10 offset:11264
    ds_read_b128 v[112:115], v10 offset:11776
    s_mov_b64 exec, -1
    ds_read_b128 v[92:95], v9 offset:13312
    s_waitcnt lgkmcnt(3)
    v_mfma_f32_32x32x16_bf16 v[32:47], v[88:91], v[4:7], v[16:31]
    v_exp_f32 v48, v48
    v_exp_f32 v49, v49
    v_exp_f32 v50, v50
    v_exp_f32 v51, v51
    v_exp_f32 v52, v52
    v_exp_f32 v53, v53
    v_exp_f32 v54, v54
    v_exp_f32 v55, v55
    v_exp_f32 v56, v56
    v_exp_f32 v57, v57
    v_exp_f32 v58, v58
    v_exp_f32 v59, v59
    v_exp_f32 v60, v60
    v_exp_f32 v61, v61
    v_exp_f32 v62, v62
    v_exp_f32 v63, v63
    v_cvt_pk_bf16_f32 v80, v48, v49
    v_cvt_pk_bf16_f32 v81, v50, v51
    v_cvt_pk_bf16_f32 v82, v52, v53
    v_cvt_pk_bf16_f32 v83, v54, v55
    v_cvt_pk_bf16_f32 v84, v56, v57
    v_cvt_pk_bf16_f32 v85, v58, v59
    v_cvt_pk_bf16_f32 v86, v60, v61
    v_cvt_pk_bf16_f32 v87, v62, v63
    s_waitcnt lgkmcnt(1)
    v_mfma_f32_32x32x16_bf16 v[64:79], v[108:111], v[80:83], v[64:79]
    v_mfma_f32_32x32x16_bf16 v[64:79], v[112:115], v[84:87], v[64:79]
    s_mov_b64 exec, s[58:59]
    ds_read_b128 v[100:103], v10 offset:12288
    ds_read_b128 v[104:107], v10 offset:12800
    s_mov_b64 exec, -1
    s_setprio 0
    s_waitcnt vmcnt(0)
    v_lshl_or_b32 v124, v117, 16, v116
    v_lshl_or_b32 v125, v119, 16, v118
    v_lshl_or_b32 v126, v121, 16, v120
    v_lshl_or_b32 v127, v123, 16, v122
    buffer_store_dwordx4 v[124:127], v8, s[20:23], s90 offen
    s_lshl_b32 s64, s3, 8
    s_add_u32 s64, s64, s2
    s_cmp_ge_u32 s64, 544
    s_cbranch_scc1 attn_nr25
    s_add_u32 s64, s64, 4096
    s_cmp_ge_u32 s64, 2752
    s_cbranch_scc1 attn_rdn6
    s_lshr_b32 s65, s64, 5
    s_and_b32 s66, s64, 31
    s_cmp_ge_u32 s65, 43
    s_cselect_b32 s67, 1, 0
    s_cselect_b32 s84, s38, s36
    s_cselect_b32 s85, s39, s37
    s_mul_i32 s68, s67, 43
    s_sub_u32 s65, s65, s68
    s_mul_i32 s68, s65, 171
    s_lshr_b32 s68, s68, 9
    s_mul_i32 s69, s68, 3
    s_sub_u32 s69, s65, s69
    s_mul_i32 s70, s66, 6
    s_mul_i32 s71, s67, 3
    s_add_u32 s70, s70, s71
    s_add_u32 s70, s70, s69
    s_mul_i32 s71, s69, 32
    s_lshl_b32 s72, s66, 1
    s_add_u32 s71, s71, s72
    s_add_u32 s71, s71, s67
    s_add_u32 s71, s71, 64
    s_cmp_lt_u32 s66, 16
    s_cselect_b32 s70, s70, s71
    s_lshl_b32 s70, s70, 10
    s_mul_i32 s90, s68, 196608
    s_add_u32 s90, s90, s70
    s_add_u32 s90, s90, 0x1000000
    s_mov_b32 s86, 1409024
    s_mov_b32 s89, 2752
    s_branch attn_rgo7
attn_rdn6:
    s_sub_u32 s64, s64, 2752
    s_cmp_ge_u32 s64, 1376
    s_cselect_b32 s84, s42, s40
    s_cselect_b32 s85, s43, s41
    s_mov_b32 s86, 1409024
    s_mov_b32 s68, 176128
    s_mov_b32 s90, 0x1400000
    s_cselect_b32 s86, 524288, s86
    s_cselect_b32 s67, 1376, 0
    s_cselect_b32 s68, 65536, s68
    s_cselect_b32 s90, 0x1600000, s90
    s_sub_u32 s64, s64, s67
    s_lshr_b32 s66, s64, 4
    s_and_b32 s65, s64, 15
    s_lshr_b32 s69, s65, 1
    s_mul_i32 s69, s69, s68
    s_add_u32 s90, s90, s69
    s_lshl_b32 s69, s66, 11
    s_add_u32 s90, s90, s69
    s_and_b32 s69, s65, 1
    s_lshl_b32 s69, s69, 10
    s_add_u32 s90, s90, s69
    s_mov_b32 s89, 1024
attn_rgo7:
    s_and_b32 s85, s85, 0xffff
    s_mov_b32 s87, 0x00020000
    s_mul_i32 s88, s66, s89
    s_lshl_b32 s88, s88, 4
    s_lshl_b32 s69, s65, 6
    s_add_u32 s88, s88, s69
    s_lshl_b32 s69, s89, 3
    v_mul_u32_u24 v14, s69, v3
    v_and_b32 v15, 31, v1
    v_lshl_add_u32 v14, v15, 1, v14
    buffer_load_ushort v116, v14, s[84:87], s88 offen
    s_add_u32 s88, s88, s89
    buffer_load_ushort v117, v14, s[84:87], s88 offen
    s_add_u32 s88, s88, s89
    buffer_load_ushort v118, v14, s[84:87], s88 offen
    s_add_u32 s88, s88, s89
    buffer_load_ushort v119, v14, s[84:87], s88 offen
    s_add_u32 s88, s88, s89
    buffer_load_ushort v120, v14, s[84:87], s88 offen
    s_add_u32 s88, s88, s89
    buffer_load_ushort v121, v14, s[84:87], s88 offen
    s_add_u32 s88, s88, s89
    buffer_load_ushort v122, v14, s[84:87], s88 offen
    s_add_u32 s88, s88, s89
    buffer_load_ushort v123, v14, s[84:87], s88 offen
attn_nr25:
    ds_read_b128 v[96:99], v9 offset:14336
    s_waitcnt lgkmcnt(3)
    v_mfma_f32_32x32x16_bf16 v[48:63], v[92:95], v[4:7], v[16:31]
    v_exp_f32 v32, v32
    v_exp_f32 v33, v33
    v_exp_f32 v34, v34
    v_exp_f32 v35, v35
    v_exp_f32 v36, v36
    v_exp_f32 v37, v37
    v_exp_f32 v38, v38
    v_exp_f32 v39, v39
    v_exp_f32 v40, v40
    v_exp_f32 v41, v41
    v_exp_f32 v42, v42
    v_exp_f32 v43, v43
    v_exp_f32 v44, v44
    v_exp_f32 v45, v45
    v_exp_f32 v46, v46
    v_exp_f32 v47, v47
    v_cvt_pk_bf16_f32 v80, v32, v33
    v_cvt_pk_bf16_f32 v81, v34, v35
    v_cvt_pk_bf16_f32 v82, v36, v37
    v_cvt_pk_bf16_f32 v83, v38, v39
    v_cvt_pk_bf16_f32 v84, v40, v41
    v_cvt_pk_bf16_f32 v85, v42, v43
    v_cvt_pk_bf16_f32 v86, v44, v45
    v_cvt_pk_bf16_f32 v87, v46, v47
    s_waitcnt lgkmcnt(1)
    v_mfma_f32_32x32x16_bf16 v[64:79], v[100:103], v[80:83], v[64:79]
    v_mfma_f32_32x32x16_bf16 v[64:79], v[104:107], v[84:87], v[64:79]
    s_mov_b64 exec, s[58:59]
    ds_read_b128 v[108:111], v10 offset:13312
    ds_read_b128 v[112:115], v10 offset:13824
    s_mov_b64 exec, -1
    ds_read_b128 v[88:91], v9 offset:15360
    s_waitcnt lgkmcnt(3)
    v_mfma_f32_32x32x16_bf16 v[32:47], v[96:99], v[4:7], v[16:31]
    v_exp_f32 v48, v48
    v_exp_f32 v49, v49
    v_exp_f32 v50, v50
    v_exp_f32 v51, v51
    v_exp_f32 v52, v52
    v_exp_f32 v53, v53
    v_exp_f32 v54, v54
    v_exp_f32 v55, v55
    v_exp_f32 v56, v56
    v_exp_f32 v57, v57
    v_exp_f32 v58, v58
    v_exp_f32 v59, v59
    v_exp_f32 v60, v60
    v_exp_f32 v61, v61
    v_exp_f32 v62, v62
    v_exp_f32 v63, v63
    v_cvt_pk_bf16_f32 v80, v48, v49
    v_cvt_pk_bf16_f32 v81, v50, v51
    v_cvt_pk_bf16_f32 v82, v52, v53
    v_cvt_pk_bf16_f32 v83, v54, v55
    v_cvt_pk_bf16_f32 v84, v56, v57
    v_cvt_pk_bf16_f32 v85, v58, v59
    v_cvt_pk_bf16_f32 v86, v60, v61
    v_cvt_pk_bf16_f32 v87, v62, v63
    s_waitcnt lgkmcnt(1)
    v_mfma_f32_32x32x16_bf16 v[64:79], v[108:111], v[80:83], v[64:79]
    v_mfma_f32_32x32x16_bf16 v[64:79], v[112:115], v[84:87], v[64:79]
    s_mov_b64 exec, s[58:59]
    ds_read_b128 v[100:103], v10 offset:14336
    ds_read_b128 v[104:107], v10 offset:14848
    s_mov_b64 exec, -1
    s_setprio 3
    s_barrier
    ds_read_b128 v[92:95], v9 offset:16384
    s_waitcnt lgkmcnt(3)
    v_mfma_f32_32x32x16_bf16 v[48:63], v[88:91], v[4:7], v[16:31]
    v_exp_f32 v32, v32
    v_exp_f32 v33, v33
    v_exp_f32 v34, v34
    v_exp_f32 v35, v35
    v_exp_f32 v36, v36
    v_exp_f32 v37, v37
    v_exp_f32 v38, v38
    v_exp_f32 v39, v39
    v_exp_f32 v40, v40
    v_exp_f32 v41, v41
    v_exp_f32 v42, v42
    v_exp_f32 v43, v43
    v_exp_f32 v44, v44
    v_exp_f32 v45, v45
    v_exp_f32 v46, v46
    v_exp_f32 v47, v47
    v_cvt_pk_bf16_f32 v80, v32, v33
    v_cvt_pk_bf16_f32 v81, v34, v35
    v_cvt_pk_bf16_f32 v82, v36, v37
    v_cvt_pk_bf16_f32 v83, v38, v39
    v_cvt_pk_bf16_f32 v84, v40, v41
    v_cvt_pk_bf16_f32 v85, v42, v43
    v_cvt_pk_bf16_f32 v86, v44, v45
    v_cvt_pk_bf16_f32 v87, v46, v47
    s_waitcnt lgkmcnt(1)
    v_mfma_f32_32x32x16_bf16 v[64:79], v[100:103], v[80:83], v[64:79]
    v_mfma_f32_32x32x16_bf16 v[64:79], v[104:107], v[84:87], v[64:79]
    s_mov_b64 exec, s[58:59]
    ds_read_b128 v[108:111], v10 offset:15360
    ds_read_b128 v[112:115], v10 offset:15872
    s_mov_b64 exec, -1
    ds_read_b128 v[96:99], v9 offset:17408
    s_waitcnt lgkmcnt(3)
    v_mfma_f32_32x32x16_bf16 v[32:47], v[92:95], v[4:7], v[16:31]
    v_exp_f32 v48, v48
    v_exp_f32 v49, v49
    v_exp_f32 v50, v50
    v_exp_f32 v51, v51
    v_exp_f32 v52, v52
    v_exp_f32 v53, v53
    v_exp_f32 v54, v54
    v_exp_f32 v55, v55
    v_exp_f32 v56, v56
    v_exp_f32 v57, v57
    v_exp_f32 v58, v58
    v_exp_f32 v59, v59
    v_exp_f32 v60, v60
    v_exp_f32 v61, v61
    v_exp_f32 v62, v62
    v_exp_f32 v63, v63
    v_cvt_pk_bf16_f32 v80, v48, v49
    v_cvt_pk_bf16_f32 v81, v50, v51
    v_cvt_pk_bf16_f32 v82, v52, v53
    v_cvt_pk_bf16_f32 v83, v54, v55
    v_cvt_pk_bf16_f32 v84, v56, v57
    v_cvt_pk_bf16_f32 v85, v58, v59
    v_cvt_pk_bf16_f32 v86, v60, v61
    v_cvt_pk_bf16_f32 v87, v62, v63
    s_waitcnt lgkmcnt(1)
    v_mfma_f32_32x32x16_bf16 v[64:79], v[108:111], v[80:83], v[64:79]
    v_mfma_f32_32x32x16_bf16 v[64:79], v[112:115], v[84:87], v[64:79]
    s_mov_b64 exec, s[58:59]
    ds_read_b128 v[100:103], v10 offset:16384
    ds_read_b128 v[104:107], v10 offset:16896
    s_mov_b64 exec, -1
    s_setprio 2
    ds_read_b128 v[88:91], v9 offset:18432
    s_waitcnt lgkmcnt(3)
    v_mfma_f32_32x32x16_bf16 v[48:63], v[96:99], v[4:7], v[16:31]
    v_exp_f32 v32, v32
    v_exp_f32 v33, v33
    v_exp_f32 v34, v34
    v_exp_f32 v35, v35
    v_exp_f32 v36, v36
    v_exp_f32 v37, v37
    v_exp_f32 v38, v38
    v_exp_f32 v39, v39
    v_exp_f32 v40, v40
    v_exp_f32 v41, v41
    v_exp_f32 v42, v42
    v_exp_f32 v43, v43
    v_exp_f32 v44, v44
    v_exp_f32 v45, v45
    v_exp_f32 v46, v46
    v_exp_f32 v47, v47
    v_cvt_pk_bf16_f32 v80, v32, v33
    v_cvt_pk_bf16_f32 v81, v34, v35
    v_cvt_pk_bf16_f32 v82, v36, v37
    v_cvt_pk_bf16_f32 v83, v38, v39
    v_cvt_pk_bf16_f32 v84, v40, v41
    v_cvt_pk_bf16_f32 v85, v42, v43
    v_cvt_pk_bf16_f32 v86, v44, v45
    v_cvt_pk_bf16_f32 v87, v46, v47
    s_waitcnt lgkmcnt(1)
    v_mfma_f32_32x32x16_bf16 v[64:79], v[100:103], v[80:83], v[64:79]
    v_mfma_f32_32x32x16_bf16 v[64:79], v[104:107], v[84:87], v[64:79]
    s_mov_b64 exec, s[58:59]
    ds_read_b128 v[108:111], v10 offset:17408
    ds_read_b128 v[112:115], v10 offset:17920
    s_mov_b64 exec, -1
    ds_read_b128 v[92:95], v9 offset:19456
    s_waitcnt lgkmcnt(3)
    v_mfma_f32_32x32x16_bf16 v[32:47], v[88:91], v[4:7], v[16:31]
    v_exp_f32 v48, v48
    v_exp_f32 v49, v49
    v_exp_f32 v50, v50
    v_exp_f32 v51, v51
    v_exp_f32 v52, v52
    v_exp_f32 v53, v53
    v_exp_f32 v54, v54
    v_exp_f32 v55, v55
    v_exp_f32 v56, v56
    v_exp_f32 v57, v57
    v_exp_f32 v58, v58
    v_exp_f32 v59, v59
    v_exp_f32 v60, v60
    v_exp_f32 v61, v61
    v_exp_f32 v62, v62
    v_exp_f32 v63, v63
    v_cvt_pk_bf16_f32 v80, v48, v49
    v_cvt_pk_bf16_f32 v81, v50, v51
    v_cvt_pk_bf16_f32 v82, v52, v53
    v_cvt_pk_bf16_f32 v83, v54, v55
    v_cvt_pk_bf16_f32 v84, v56, v57
    v_cvt_pk_bf16_f32 v85, v58, v59
    v_cvt_pk_bf16_f32 v86, v60, v61
    v_cvt_pk_bf16_f32 v87, v62, v63
    s_waitcnt lgkmcnt(1)
    v_mfma_f32_32x32x16_bf16 v[64:79], v[108:111], v[80:83], v[64:79]
    v_mfma_f32_32x32x16_bf16 v[64:79], v[112:115], v[84:87], v[64:79]
    s_mov_b64 exec, s[58:59]
    ds_read_b128 v[100:103], v10 offset:18432
    ds_read_b128 v[104:107], v10 offset:18944
    s_mov_b64 exec, -1
    s_setprio 1
    ds_read_b128 v[96:99], v9 offset:20480
    s_waitcnt lgkmcnt(3)
    v_mfma_f32_32x32x16_bf16 v[48:63], v[92:95], v[4:7], v[16:31]
    v_exp_f32 v32, v32
    v_exp_f32 v33, v33
    v_exp_f32 v34, v34
    v_exp_f32 v35, v35
    v_exp_f32 v36, v36
    v_exp_f32 v37, v37
    v_exp_f32 v38, v38
    v_exp_f32 v39, v39
    v_exp_f32 v40, v40
    v_exp_f32 v41, v41
    v_exp_f32 v42, v42
    v_exp_f32 v43, v43
    v_exp_f32 v44, v44
    v_exp_f32 v45, v45
    v_exp_f32 v46, v46
    v_exp_f32 v47, v47
    v_cvt_pk_bf16_f32 v80, v32, v33
    v_cvt_pk_bf16_f32 v81, v34, v35
    v_cvt_pk_bf16_f32 v82, v36, v37
    v_cvt_pk_bf16_f32 v83, v38, v39
    v_cvt_pk_bf16_f32 v84, v40, v41
    v_cvt_pk_bf16_f32 v85, v42, v43
    v_cvt_pk_bf16_f32 v86, v44, v45
    v_cvt_pk_bf16_f32 v87, v46, v47
    s_waitcnt lgkmcnt(1)
    v_mfma_f32_32x32x16_bf16 v[64:79], v[100:103], v[80:83], v[64:79]
    v_mfma_f32_32x32x16_bf16 v[64:79], v[104:107], v[84:87], v[64:79]
    s_mov_b64 exec, s[58:59]
    ds_read_b128 v[108:111], v10 offset:19456
    ds_read_b128 v[112:115], v10 offset:19968
    s_mov_b64 exec, -1
    ds_read_b128 v[88:91], v9 offset:21504
    s_waitcnt lgkmcnt(3)
    v_mfma_f32_32x32x16_bf16 v[32:47], v[96:99], v[4:7], v[16:31]
    v_exp_f32 v48, v48
    v_exp_f32 v49, v49
    v_exp_f32 v50, v50
    v_exp_f32 v51, v51
    v_exp_f32 v52, v52
    v_exp_f32 v53, v53
    v_exp_f32 v54, v54
    v_exp_f32 v55, v55
    v_exp_f32 v56, v56
    v_exp_f32 v57, v57
    v_exp_f32 v58, v58
    v_exp_f32 v59, v59
    v_exp_f32 v60, v60
    v_exp_f32 v61, v61
    v_exp_f32 v62, v62
    v_exp_f32 v63, v63
    v_cvt_pk_bf16_f32 v80, v48, v49
    v_cvt_pk_bf16_f32 v81, v50, v51
    v_cvt_pk_bf16_f32 v82, v52, v53
    v_cvt_pk_bf16_f32 v83, v54, v55
    v_cvt_pk_bf16_f32 v84, v56, v57
    v_cvt_pk_bf16_f32 v85, v58, v59
    v_cvt_pk_bf16_f32 v86, v60, v61
    v_cvt_pk_bf16_f32 v87, v62, v63
    s_waitcnt lgkmcnt(1)
    v_mfma_f32_32x32x16_bf16 v[64:79], v[108:111], v[80:83], v[64:79]
    v_mfma_f32_32x32x16_bf16 v[64:79], v[112:115], v[84:87], v[64:79]
    s_mov_b64 exec, s[58:59]
    ds_read_b128 v[100:103], v10 offset:20480
    ds_read_b128 v[104:107], v10 offset:20992
    s_mov_b64 exec, -1
    s_setprio 0
    ds_read_b128 v[92:95], v9 offset:22528
    s_waitcnt lgkmcnt(3)
    v_mfma_f32_32x32x16_bf16 v[48:63], v[88:91], v[4:7], v[16:31]
    v_exp_f32 v32, v32
    v_exp_f32 v33, v33
    v_exp_f32 v34, v34
    v_exp_f32 v35, v35
    v_exp_f32 v36, v36
    v_exp_f32 v37, v37
    v_exp_f32 v38, v38
    v_exp_f32 v39, v39
    v_exp_f32 v40, v40
    v_exp_f32 v41, v41
    v_exp_f32 v42, v42
    v_exp_f32 v43, v43
    v_exp_f32 v44, v44
    v_exp_f32 v45, v45
    v_exp_f32 v46, v46
    v_exp_f32 v47, v47
    v_cvt_pk_bf16_f32 v80, v32, v33
    v_cvt_pk_bf16_f32 v81, v34, v35
    v_cvt_pk_bf16_f32 v82, v36, v37
    v_cvt_pk_bf16_f32 v83, v38, v39
    v_cvt_pk_bf16_f32 v84, v40, v41
    v_cvt_pk_bf16_f32 v85, v42, v43
    v_cvt_pk_bf16_f32 v86, v44, v45
    v_cvt_pk_bf16_f32 v87, v46, v47
    s_waitcnt lgkmcnt(1)
    v_mfma_f32_32x32x16_bf16 v[64:79], v[100:103], v[80:83], v[64:79]
    v_mfma_f32_32x32x16_bf16 v[64:79], v[104:107], v[84:87], v[64:79]
    s_mov_b64 exec, s[58:59]
    ds_read_b128 v[108:111], v10 offset:21504
    ds_read_b128 v[112:115], v10 offset:22016
    s_mov_b64 exec, -1
    ds_read_b128 v[96:99], v9 offset:23552
    s_waitcnt lgkmcnt(3)
    v_mfma_f32_32x32x16_bf16 v[32:47], v[92:95], v[4:7], v[16:31]
    v_exp_f32 v48, v48
    v_exp_f32 v49, v49
    v_exp_f32 v50, v50
    v_exp_f32 v51, v51
    v_exp_f32 v52, v52
    v_exp_f32 v53, v53
    v_exp_f32 v54, v54
    v_exp_f32 v55, v55
    v_exp_f32 v56, v56
    v_exp_f32 v57, v57
    v_exp_f32 v58, v58
    v_exp_f32 v59, v59
    v_exp_f32 v60, v60
    v_exp_f32 v61, v61
    v_exp_f32 v62, v62
    v_exp_f32 v63, v63
    v_cvt_pk_bf16_f32 v80, v48, v49
    v_cvt_pk_bf16_f32 v81, v50, v51
    v_cvt_pk_bf16_f32 v82, v52, v53
    v_cvt_pk_bf16_f32 v83, v54, v55
    v_cvt_pk_bf16_f32 v84, v56, v57
    v_cvt_pk_bf16_f32 v85, v58, v59
    v_cvt_pk_bf16_f32 v86, v60, v61
    v_cvt_pk_bf16_f32 v87, v62, v63
    s_waitcnt lgkmcnt(1)
    v_mfma_f32_32x32x16_bf16 v[64:79], v[108:111], v[80:83], v[64:79]
    v_mfma_f32_32x32x16_bf16 v[64:79], v[112:115], v[84:87], v[64:79]
    s_mov_b64 exec, s[58:59]
    ds_read_b128 v[100:103], v10 offset:22528
    ds_read_b128 v[104:107], v10 offset:23040
    s_mov_b64 exec, -1
    s_setprio 3
    s_barrier
    ds_read_b128 v[88:91], v9 offset:24576
    s_waitcnt lgkmcnt(3)
    v_mfma_f32_32x32x16_bf16 v[48:63], v[96:99], v[4:7], v[16:31]
    v_exp_f32 v32, v32
    v_exp_f32 v33, v33
    v_exp_f32 v34, v34
    v_exp_f32 v35, v35
    v_exp_f32 v36, v36
    v_exp_f32 v37, v37
    v_exp_f32 v38, v38
    v_exp_f32 v39, v39
    v_exp_f32 v40, v40
    v_exp_f32 v41, v41
    v_exp_f32 v42, v42
    v_exp_f32 v43, v43
    v_exp_f32 v44, v44
    v_exp_f32 v45, v45
    v_exp_f32 v46, v46
    v_exp_f32 v47, v47
    v_cvt_pk_bf16_f32 v80, v32, v33
    v_cvt_pk_bf16_f32 v81, v34, v35
    v_cvt_pk_bf16_f32 v82, v36, v37
    v_cvt_pk_bf16_f32 v83, v38, v39
    v_cvt_pk_bf16_f32 v84, v40, v41
    v_cvt_pk_bf16_f32 v85, v42, v43
    v_cvt_pk_bf16_f32 v86, v44, v45
    v_cvt_pk_bf16_f32 v87, v46, v47
    s_waitcnt lgkmcnt(1)
    v_mfma_f32_32x32x16_bf16 v[64:79], v[100:103], v[80:83], v[64:79]
    v_mfma_f32_32x32x16_bf16 v[64:79], v[104:107], v[84:87], v[64:79]
    s_mov_b64 exec, s[58:59]
    ds_read_b128 v[108:111], v10 offset:23552
    ds_read_b128 v[112:115], v10 offset:24064
    s_mov_b64 exec, -1
    ds_read_b128 v[92:95], v9 offset:25600
    s_waitcnt lgkmcnt(3)
    v_mfma_f32_32x32x16_bf16 v[32:47], v[88:91], v[4:7], v[16:31]
    v_exp_f32 v48, v48
    v_exp_f32 v49, v49
    v_exp_f32 v50, v50
    v_exp_f32 v51, v51
    v_exp_f32 v52, v52
    v_exp_f32 v53, v53
    v_exp_f32 v54, v54
    v_exp_f32 v55, v55
    v_exp_f32 v56, v56
    v_exp_f32 v57, v57
    v_exp_f32 v58, v58
    v_exp_f32 v59, v59
    v_exp_f32 v60, v60
    v_exp_f32 v61, v61
    v_exp_f32 v62, v62
    v_exp_f32 v63, v63
    v_cvt_pk_bf16_f32 v80, v48, v49
    v_cvt_pk_bf16_f32 v81, v50, v51
    v_cvt_pk_bf16_f32 v82, v52, v53
    v_cvt_pk_bf16_f32 v83, v54, v55
    v_cvt_pk_bf16_f32 v84, v56, v57
    v_cvt_pk_bf16_f32 v85, v58, v59
    v_cvt_pk_bf16_f32 v86, v60, v61
    v_cvt_pk_bf16_f32 v87, v62, v63
    s_waitcnt lgkmcnt(1)
    v_mfma_f32_32x32x16_bf16 v[64:79], v[108:111], v[80:83], v[64:79]
    v_mfma_f32_32x32x16_bf16 v[64:79], v[112:115], v[84:87], v[64:79]
    s_mov_b64 exec, s[58:59]
    ds_read_b128 v[100:103], v10 offset:24576
    ds_read_b128 v[104:107], v10 offset:25088
    s_mov_b64 exec, -1
    s_setprio 2
    s_lshl_b32 s64, s3, 8
    s_add_u32 s64, s64, s2
    s_cmp_ge_u32 s64, 544
    s_cbranch_scc1 attn_nr38
    s_waitcnt vmcnt(0)
    v_lshl_or_b32 v124, v117, 16, v116
    v_lshl_or_b32 v125, v119, 16, v118
    v_lshl_or_b32 v126, v121, 16, v120
    v_lshl_or_b32 v127, v123, 16, v122
    buffer_store_dwordx4 v[124:127], v8, s[20:23], s90 offen
attn_nr38:
    ds_read_b128 v[96:99], v9 offset:26624
    s_waitcnt lgkmcnt(3)
    v_mfma_f32_32x32x16_bf16 v[48:63], v[92:95], v[4:7], v[16:31]
    v_exp_f32 v32, v32
    v_exp_f32 v33, v33
    v_exp_f32 v34, v34
    v_exp_f32 v35, v35
    v_exp_f32 v36, v36
    v_exp_f32 v37, v37
    v_exp_f32 v38, v38
    v_exp_f32 v39, v39
    v_exp_f32 v40, v40
    v_exp_f32 v41, v41
    v_exp_f32 v42, v42
    v_exp_f32 v43, v43
    v_exp_f32 v44, v44
    v_exp_f32 v45, v45
    v_exp_f32 v46, v46
    v_exp_f32 v47, v47
    v_cvt_pk_bf16_f32 v80, v32, v33
    v_cvt_pk_bf16_f32 v81, v34, v35
    v_cvt_pk_bf16_f32 v82, v36, v37
    v_cvt_pk_bf16_f32 v83, v38, v39
    v_cvt_pk_bf16_f32 v84, v40, v41
    v_cvt_pk_bf16_f32 v85, v42, v43
    v_cvt_pk_bf16_f32 v86, v44, v45
    v_cvt_pk_bf16_f32 v87, v46, v47
    s_waitcnt lgkmcnt(1)
    v_mfma_f32_32x32x16_bf16 v[64:79], v[100:103], v[80:83], v[64:79]
    v_mfma_f32_32x32x16_bf16 v[64:79], v[104:107], v[84:87], v[64:79]
    s_mov_b64 exec, s[58:59]
    ds_read_b128 v[108:111], v10 offset:25600
    ds_read_b128 v[112:115], v10 offset:26112
    s_mov_b64 exec, -1
    ds_read_b128 v[88:91], v9 offset:27648
    s_waitcnt lgkmcnt(3)
    v_mfma_f32_32x32x16_bf16 v[32:47], v[96:99], v[4:7], v[16:31]
    v_exp_f32 v48, v48
    v_exp_f32 v49, v49
    v_exp_f32 v50, v50
    v_exp_f32 v51, v51
    v_exp_f32 v52, v52
    v_exp_f32 v53, v53
    v_exp_f32 v54, v54
    v_exp_f32 v55, v55
    v_exp_f32 v56, v56
    v_exp_f32 v57, v57
    v_exp_f32 v58, v58
    v_exp_f32 v59, v59
    v_exp_f32 v60, v60
    v_exp_f32 v61, v61
    v_exp_f32 v62, v62
    v_exp_f32 v63, v63
    v_cvt_pk_bf16_f32 v80, v48, v49
    v_cvt_pk_bf16_f32 v81, v50, v51
    v_cvt_pk_bf16_f32 v82, v52, v53
    v_cvt_pk_bf16_f32 v83, v54, v55
    v_cvt_pk_bf16_f32 v84, v56, v57
    v_cvt_pk_bf16_f32 v85, v58, v59
    v_cvt_pk_bf16_f32 v86, v60, v61
    v_cvt_pk_bf16_f32 v87, v62, v63
    s_waitcnt lgkmcnt(1)
    v_mfma_f32_32x32x16_bf16 v[64:79], v[108:111], v[80:83], v[64:79]
    v_mfma_f32_32x32x16_bf16 v[64:79], v[112:115], v[84:87], v[64:79]
    s_mov_b64 exec, s[58:59]
    ds_read_b128 v[100:103], v10 offset:26624
    ds_read_b128 v[104:107], v10 offset:27136
    s_mov_b64 exec, -1
    s_setprio 1
    ds_read_b128 v[92:95], v9 offset:28672
    s_waitcnt lgkmcnt(3)
    v_mfma_f32_32x32x16_bf16 v[48:63], v[88:91], v[4:7], v[16:31]
    v_exp_f32 v32, v32
    v_exp_f32 v33, v33
    v_exp_f32 v34, v34
    v_exp_f32 v35, v35
    v_exp_f32 v36, v36
    v_exp_f32 v37, v37
    v_exp_f32 v38, v38
    v_exp_f32 v39, v39
    v_exp_f32 v40, v40
    v_exp_f32 v41, v41
    v_exp_f32 v42, v42
    v_exp_f32 v43, v43
    v_exp_f32 v44, v44
    v_exp_f32 v45, v45
    v_exp_f32 v46, v46
    v_exp_f32 v47, v47
    v_cvt_pk_bf16_f32 v80, v32, v33
    v_cvt_pk_bf16_f32 v81, v34, v35
    v_cvt_pk_bf16_f32 v82, v36, v37
    v_cvt_pk_bf16_f32 v83, v38, v39
    v_cvt_pk_bf16_f32 v84, v40, v41
    v_cvt_pk_bf16_f32 v85, v42, v43
    v_cvt_pk_bf16_f32 v86, v44, v45
    v_cvt_pk_bf16_f32 v87, v46, v47
    s_waitcnt lgkmcnt(1)
    v_mfma_f32_32x32x16_bf16 v[64:79], v[100:103], v[80:83], v[64:79]
    v_mfma_f32_32x32x16_bf16 v[64:79], v[104:107], v[84:87], v[64:79]
    s_mov_b64 exec, s[58:59]
    ds_read_b128 v[108:111], v10 offset:27648
    ds_read_b128 v[112:115], v10 offset:28160
    s_mov_b64 exec, -1
    s_lshl_b32 s64, s3, 8
    s_add_u32 s64, s64, s2
    s_cmp_ge_u32 s64, 8
    s_cbranch_scc1 attn_nwb9
    buffer_wbl2 sc1
attn_nwb9:
    ds_read_b128 v[96:99], v9 offset:29696
    s_waitcnt lgkmcnt(3)
    v_mfma_f32_32x32x16_bf16 v[32:47], v[92:95], v[4:7], v[16:31]
    v_exp_f32 v48, v48
    v_exp_f32 v49, v49
    v_exp_f32 v50, v50
    v_exp_f32 v51, v51
    v_exp_f32 v52, v52
    v_exp_f32 v53, v53
    v_exp_f32 v54, v54
    v_exp_f32 v55, v55
    v_exp_f32 v56, v56
    v_exp_f32 v57, v57
    v_exp_f32 v58, v58
    v_exp_f32 v59, v59
    v_exp_f32 v60, v60
    v_exp_f32 v61, v61
    v_exp_f32 v62, v62
    v_exp_f32 v63, v63
    v_cvt_pk_bf16_f32 v80, v48, v49
    v_cvt_pk_bf16_f32 v81, v50, v51
    v_cvt_pk_bf16_f32 v82, v52, v53
    v_cvt_pk_bf16_f32 v83, v54, v55
    v_cvt_pk_bf16_f32 v84, v56, v57
    v_cvt_pk_bf16_f32 v85, v58, v59
    v_cvt_pk_bf16_f32 v86, v60, v61
    v_cvt_pk_bf16_f32 v87, v62, v63
    s_waitcnt lgkmcnt(1)
    v_mfma_f32_32x32x16_bf16 v[64:79], v[108:111], v[80:83], v[64:79]
    v_mfma_f32_32x32x16_bf16 v[64:79], v[112:115], v[84:87], v[64:79]
    s_mov_b64 exec, s[58:59]
    ds_read_b128 v[100:103], v10 offset:28672
    ds_read_b128 v[104:107], v10 offset:29184
    s_mov_b64 exec, -1
    s_setprio 0
    ds_read_b128 v[88:91], v9 offset:30720
    s_waitcnt lgkmcnt(3)
    v_mfma_f32_32x32x16_bf16 v[48:63], v[96:99], v[4:7], v[16:31]
    v_exp_f32 v32, v32
    v_exp_f32 v33, v33
    v_exp_f32 v34, v34
    v_exp_f32 v35, v35
    v_exp_f32 v36, v36
    v_exp_f32 v37, v37
    v_exp_f32 v38, v38
    v_exp_f32 v39, v39
    v_exp_f32 v40, v40
    v_exp_f32 v41, v41
    v_exp_f32 v42, v42
    v_exp_f32 v43, v43
    v_exp_f32 v44, v44
    v_exp_f32 v45, v45
    v_exp_f32 v46, v46
    v_exp_f32 v47, v47
    v_cvt_pk_bf16_f32 v80, v32, v33
    v_cvt_pk_bf16_f32 v81, v34, v35
    v_cvt_pk_bf16_f32 v82, v36, v37
    v_cvt_pk_bf16_f32 v83, v38, v39
    v_cvt_pk_bf16_f32 v84, v40, v41
    v_cvt_pk_bf16_f32 v85, v42, v43
    v_cvt_pk_bf16_f32 v86, v44, v45
    v_cvt_pk_bf16_f32 v87, v46, v47
    s_waitcnt lgkmcnt(1)
    v_mfma_f32_32x32x16_bf16 v[64:79], v[100:103], v[80:83], v[64:79]
    v_mfma_f32_32x32x16_bf16 v[64:79], v[104:107], v[84:87], v[64:79]
    s_mov_b64 exec, s[58:59]
    ds_read_b128 v[108:111], v10 offset:29696
    ds_read_b128 v[112:115], v10 offset:30208
    s_mov_b64 exec, -1
    ds_read_b128 v[92:95], v9 offset:31744
    s_waitcnt lgkmcnt(3)
    v_mfma_f32_32x32x16_bf16 v[32:47], v[88:91], v[4:7], v[16:31]
    v_exp_f32 v48, v48
    v_exp_f32 v49, v49
    v_exp_f32 v50, v50
    v_exp_f32 v51, v51
    v_exp_f32 v52, v52
    v_exp_f32 v53, v53
    v_exp_f32 v54, v54
    v_exp_f32 v55, v55
    v_exp_f32 v56, v56
    v_exp_f32 v57, v57
    v_exp_f32 v58, v58
    v_exp_f32 v59, v59
    v_exp_f32 v60, v60
    v_exp_f32 v61, v61
    v_exp_f32 v62, v62
    v_exp_f32 v63, v63
    v_cvt_pk_bf16_f32 v80, v48, v49
    v_cvt_pk_bf16_f32 v81, v50, v51
    v_cvt_pk_bf16_f32 v82, v52, v53
    v_cvt_pk_bf16_f32 v83, v54, v55
    v_cvt_pk_bf16_f32 v84, v56, v57
    v_cvt_pk_bf16_f32 v85, v58, v59
    v_cvt_pk_bf16_f32 v86, v60, v61
    v_cvt_pk_bf16_f32 v87, v62, v63
    s_waitcnt lgkmcnt(1)
    v_mfma_f32_32x32x16_bf16 v[64:79], v[108:111], v[80:83], v[64:79]
    v_mfma_f32_32x32x16_bf16 v[64:79], v[112:115], v[84:87], v[64:79]
    s_mov_b64 exec, s[58:59]
    ds_read_b128 v[100:103], v10 offset:30720
    ds_read_b128 v[104:107], v10 offset:31232
    s_mov_b64 exec, -1
    s_setprio 3
    s_waitcnt lgkmcnt(2)
    v_mfma_f32_32x32x16_bf16 v[48:63], v[92:95], v[4:7], v[16:31]
    v_exp_f32 v32, v32
    v_exp_f32 v33, v33
    v_exp_f32 v34, v34
    v_exp_f32 v35, v35
    v_exp_f32 v36, v36
    v_exp_f32 v37, v37
    v_exp_f32 v38, v38
    v_exp_f32 v39, v39
    v_exp_f32 v40, v40
    v_exp_f32 v41, v41
    v_exp_f32 v42, v42
    v_exp_f32 v43, v43
    v_exp_f32 v44, v44
    v_exp_f32 v45, v45
    v_exp_f32 v46, v46
    v_exp_f32 v47, v47
    v_cvt_pk_bf16_f32 v80, v32, v33
    v_cvt_pk_bf16_f32 v81, v34, v35
    v_cvt_pk_bf16_f32 v82, v36, v37
    v_cvt_pk_bf16_f32 v83, v38, v39
    v_cvt_pk_bf16_f32 v84, v40, v41
    v_cvt_pk_bf16_f32 v85, v42, v43
    v_cvt_pk_bf16_f32 v86, v44, v45
    v_cvt_pk_bf16_f32 v87, v46, v47
    s_waitcnt lgkmcnt(0)
    v_mfma_f32_32x32x16_bf16 v[64:79], v[100:103], v[80:83], v[64:79]
    v_mfma_f32_32x32x16_bf16 v[64:79], v[104:107], v[84:87], v[64:79]
    s_mov_b64 exec, s[58:59]
    ds_read_b128 v[108:111], v10 offset:31744
    ds_read_b128 v[112:115], v10 offset:32256
    s_mov_b64 exec, -1
    v_exp_f32 v48, v48
    v_exp_f32 v49, v49
    v_exp_f32 v50, v50
    v_exp_f32 v51, v51
    v_exp_f32 v52, v52
    v_exp_f32 v53, v53
    v_exp_f32 v54, v54
    v_exp_f32 v55, v55
    v_exp_f32 v56, v56
    v_exp_f32 v57, v57
    v_exp_f32 v58, v58
    v_exp_f32 v59, v59
    v_exp_f32 v60, v60
    v_exp_f32 v61, v61
    v_exp_f32 v62, v62
    v_exp_f32 v63, v63
    v_cvt_pk_bf16_f32 v80, v48, v49
    v_cvt_pk_bf16_f32 v81, v50, v51
    v_cvt_pk_bf16_f32 v82, v52, v53
    v_cvt_pk_bf16_f32 v83, v54, v55
    v_cvt_pk_bf16_f32 v84, v56, v57
    v_cvt_pk_bf16_f32 v85, v58, v59
    v_cvt_pk_bf16_f32 v86, v60, v61
    v_cvt_pk_bf16_f32 v87, v62, v63
    s_waitcnt lgkmcnt(0)
    v_mfma_f32_32x32x16_bf16 v[64:79], v[108:111], v[80:83], v[64:79]
    v_mfma_f32_32x32x16_bf16 v[64:79], v[112:115], v[84:87], v[64:79]
    s_nop 15
    v_cmp_gt_f32 vcc, 0x1f800000, v72
    v_cmp_u_f32 s[60:61], v72, v72
    s_or_b64 vcc, vcc, s[60:61]
    s_cbranch_vccz attn_comb10
    v_mov_b32 v11, 0xff800000
    ds_read_b128 v[88:91], v9 offset:0
    ds_read_b128 v[92:95], v9 offset:1024
    s_waitcnt lgkmcnt(1)
    v_mfma_f32_32x32x16_bf16 v[32:47], v[88:91], v[4:7], 0
    ds_read_b128 v[96:99], v9 offset:2048
    s_waitcnt lgkmcnt(1)
    v_mfma_f32_32x32x16_bf16 v[48:63], v[92:95], v[4:7], 0
    s_nop 10
    v_max3_f32 v11, v32, v33, v11
    v_max3_f32 v11, v34, v35, v11
    v_max3_f32 v11, v36, v37, v11
    v_max3_f32 v11, v38, v39, v11
    v_max3_f32 v11, v40, v41, v11
    v_max3_f32 v11, v42, v43, v11
    v_max3_f32 v11, v44, v45, v11
    v_max3_f32 v11, v46, v47, v11
    ds_read_b128 v[88:91], v9 offset:3072
    s_waitcnt lgkmcnt(1)
    v_mfma_f32_32x32x16_bf16 v[32:47], v[96:99], v[4:7], 0
    s_nop 3
    v_max3_f32 v11, v48, v49, v11
    v_max3_f32 v11, v50, v51, v11
    v_max3_f32 v11, v52, v53, v11
    v_max3_f32 v11, v54, v55, v11
    v_max3_f32 v11, v56, v57, v11
    v_max3_f32 v11, v58, v59, v11
    v_max3_f32 v11, v60, v61, v11
    v_max3_f32 v11, v62, v63, v11
    ds_read_b128 v[92:95], v9 offset:4096
    s_waitcnt lgkmcnt(1)
    v_mfma_f32_32x32x16_bf16 v[48:63], v[88:91], v[4:7], 0
    s_nop 3
    v_max3_f32 v11, v32, v33, v11
    v_max3_f32 v11, v34, v35, v11
    v_max3_f32 v11, v36, v37, v11
    v_max3_f32 v11, v38, v39, v11
    v_max3_f32 v11, v40, v41, v11
    v_max3_f32 v11, v42, v43, v11
    v_max3_f32 v11, v44, v45, v11
    v_max3_f32 v11, v46, v47, v11
    ds_read_b128 v[96:99], v9 offset:5120
    s_waitcnt lgkmcnt(1)
    v_mfma_f32_32x32x16_bf16 v[32:47], v[92:95], v[4:7], 0
    s_nop 3
    v_max3_f32 v11, v48, v49, v11
    v_max3_f32 v11, v50, v51, v11
    v_max3_f32 v11, v52, v53, v11
    v_max3_f32 v11, v54, v55, v11
    v_max3_f32 v11, v56, v57, v11
    v_max3_f32 v11, v58, v59, v11
    v_max3_f32 v11, v60, v61, v11
    v_max3_f32 v11, v62, v63, v11
    ds_read_b128 v[88:91], v9 offset:6144
    s_waitcnt lgkmcnt(1)
    v_mfma_f32_32x32x16_bf16 v[48:63], v[96:99], v[4:7], 0
    s_nop 3
    v_max3_f32 v11, v32, v33, v11
    v_max3_f32 v11, v34, v35, v11
    v_max3_f32 v11, v36, v37, v11
    v_max3_f32 v11, v38, v39, v11
    v_max3_f32 v11, v40, v41, v11
    v_max3_f32 v11, v42, v43, v11
    v_max3_f32 v11, v44, v45, v11
    v_max3_f32 v11, v46, v47, v11
    ds_read_b128 v[92:95], v9 offset:7168
    s_waitcnt lgkmcnt(1)
    v_mfma_f32_32x32x16_bf16 v[32:47], v[88:91], v[4:7], 0
    s_nop 3
    v_max3_f32 v11, v48, v49, v11
    v_max3_f32 v11, v50, v51, v11
    v_max3_f32 v11, v52, v53, v11
    v_max3_f32 v11, v54, v55, v11
    v_max3_f32 v11, v56, v57, v11
    v_max3_f32 v11, v58, v59, v11
    v_max3_f32 v11, v60, v61, v11
    v_max3_f32 v11, v62, v63, v11
    ds_read_b128 v[96:99], v9 offset:8192
    s_waitcnt lgkmcnt(1)
    v_mfma_f32_32x32x16_bf16 v[48:63], v[92:95], v[4:7], 0
    s_nop 3
    v_max3_f32 v11, v32, v33, v11
    v_max3_f32 v11, v34, v35, v11
    v_max3_f32 v11, v36, v37, v11
    v_max3_f32 v11, v38, v39, v11
    v_max3_f32 v11, v40, v41, v11
    v_max3_f32 v11, v42, v43, v11
    v_max3_f32 v11, v44, v45, v11
    v_max3_f32 v11, v46, v47, v11
    ds_read_b128 v[88:91], v9 offset:9216
    s_waitcnt lgkmcnt(1)
    v_mfma_f32_32x32x16_bf16 v[32:47], v[96:99], v[4:7], 0
    s_nop 3
    v_max3_f32 v11, v48, v49, v11
    v_max3_f32 v11, v50, v51, v11
    v_max3_f32 v11, v52, v53, v11
    v_max3_f32 v11, v54, v55, v11
    v_max3_f32 v11, v56, v57, v11
    v_max3_f32 v11, v58, v59, v11
    v_max3_f32 v11, v60, v61, v11
    v_max3_f32 v11, v62, v63, v11
    ds_read_b128 v[92:95], v9 offset:10240
    s_waitcnt lgkmcnt(1)
    v_mfma_f32_32x32x16_bf16 v[48:63], v[88:91], v[4:7], 0
    s_nop 3
    v_max3_f32 v11, v32, v33, v11
    v_max3_f32 v11, v34, v35, v11
    v_max3_f32 v11, v36, v37, v11
    v_max3_f32 v11, v38, v39, v11
    v_max3_f32 v11, v40, v41, v11
    v_max3_f32 v11, v42, v43, v11
    v_max3_f32 v11, v44, v45, v11
    v_max3_f32 v11, v46, v47, v11
    ds_read_b128 v[96:99], v9 offset:11264
    s_waitcnt lgkmcnt(1)
    v_mfma_f32_32x32x16_bf16 v[32:47], v[92:95], v[4:7], 0
    s_nop 3
    v_max3_f32 v11, v48, v49, v11
    v_max3_f32 v11, v50, v51, v11
    v_max3_f32 v11, v52, v53, v11
    v_max3_f32 v11, v54, v55, v11
    v_max3_f32 v11, v56, v57, v11
    v_max3_f32 v11, v58, v59, v11
    v_max3_f32 v11, v60, v61, v11
    v_max3_f32 v11, v62, v63, v11
    ds_read_b128 v[88:91], v9 offset:12288
    s_waitcnt lgkmcnt(1)
    v_mfma_f32_32x32x16_bf16 v[48:63], v[96:99], v[4:7], 0
    s_nop 3
    v_max3_f32 v11, v32, v33, v11
    v_max3_f32 v11, v34, v35, v11
    v_max3_f32 v11, v36, v37, v11
    v_max3_f32 v11, v38, v39, v11
    v_max3_f32 v11, v40, v41, v11
    v_max3_f32 v11, v42, v43, v11
    v_max3_f32 v11, v44, v45, v11
    v_max3_f32 v11, v46, v47, v11
    ds_read_b128 v[92:95], v9 offset:13312
    s_waitcnt lgkmcnt(1)
    v_mfma_f32_32x32x16_bf16 v[32:47], v[88:91], v[4:7], 0
    s_nop 3
    v_max3_f32 v11, v48, v49, v11
    v_max3_f32 v11, v50, v51, v11
    v_max3_f32 v11, v52, v53, v11
    v_max3_f32 v11, v54, v55, v11
    v_max3_f32 v11, v56, v57, v11
    v_max3_f32 v11, v58, v59, v11
    v_max3_f32 v11, v60, v61, v11
    v_max3_f32 v11, v62, v63, v11
    ds_read_b128 v[96:99], v9 offset:14336
    s_waitcnt lgkmcnt(1)
    v_mfma_f32_32x32x16_bf16 v[48:63], v[92:95], v[4:7], 0
    s_nop 3
    v_max3_f32 v11, v32, v33, v11
    v_max3_f32 v11, v34, v35, v11
    v_max3_f32 v11, v36, v37, v11
    v_max3_f32 v11, v38, v39, v11
    v_max3_f32 v11, v40, v41, v11
    v_max3_f32 v11, v42, v43, v11
    v_max3_f32 v11, v44, v45, v11
    v_max3_f32 v11, v46, v47, v11
    ds_read_b128 v[88:91], v9 offset:15360
    s_waitcnt lgkmcnt(1)
    v_mfma_f32_32x32x16_bf16 v[32:47], v[96:99], v[4:7], 0
    s_nop 3
    v_max3_f32 v11, v48, v49, v11
    v_max3_f32 v11, v50, v51, v11
    v_max3_f32 v11, v52, v53, v11
    v_max3_f32 v11, v54, v55, v11
    v_max3_f32 v11, v56, v57, v11
    v_max3_f32 v11, v58, v59, v11
    v_max3_f32 v11, v60, v61, v11
    v_max3_f32 v11, v62, v63, v11
    ds_read_b128 v[92:95], v9 offset:16384
    s_waitcnt lgkmcnt(1)
    v_mfma_f32_32x32x16_bf16 v[48:63], v[88:91], v[4:7], 0
    s_nop 3
    v_max3_f32 v11, v32, v33, v11
    v_max3_f32 v11, v34, v35, v11
    v_max3_f32 v11, v36, v37, v11
    v_max3_f32 v11, v38, v39, v11
    v_max3_f32 v11, v40, v41, v11
    v_max3_f32 v11, v42, v43, v11
    v_max3_f32 v11, v44, v45, v11
    v_max3_f32 v11, v46, v47, v11
    ds_read_b128 v[96:99], v9 offset:17408
    s_waitcnt lgkmcnt(1)
    v_mfma_f32_32x32x16_bf16 v[32:47], v[92:95], v[4:7], 0
    s_nop 3
    v_max3_f32 v11, v48, v49, v11
    v_max3_f32 v11, v50, v51, v11
    v_max3_f32 v11, v52, v53, v11
    v_max3_f32 v11, v54, v55, v11
    v_max3_f32 v11, v56, v57, v11
    v_max3_f32 v11, v58, v59, v11
    v_max3_f32 v11, v60, v61, v11
    v_max3_f32 v11, v62, v63, v11
    ds_read_b128 v[88:91], v9 offset:18432
    s_waitcnt lgkmcnt(1)
    v_mfma_f32_32x32x16_bf16 v[48:63], v[96:99], v[4:7], 0
    s_nop 3
    v_max3_f32 v11, v32, v33, v11
    v_max3_f32 v11, v34, v35, v11
    v_max3_f32 v11, v36, v37, v11
    v_max3_f32 v11, v38, v39, v11
    v_max3_f32 v11, v40, v41, v11
    v_max3_f32 v11, v42, v43, v11
    v_max3_f32 v11, v44, v45, v11
    v_max3_f32 v11, v46, v47, v11
    ds_read_b128 v[92:95], v9 offset:19456
    s_waitcnt lgkmcnt(1)
    v_mfma_f32_32x32x16_bf16 v[32:47], v[88:91], v[4:7], 0
    s_nop 3
    v_max3_f32 v11, v48, v49, v11
    v_max3_f32 v11, v50, v51, v11
    v_max3_f32 v11, v52, v53, v11
    v_max3_f32 v11, v54, v55, v11
    v_max3_f32 v11, v56, v57, v11
    v_max3_f32 v11, v58, v59, v11
    v_max3_f32 v11, v60, v61, v11
    v_max3_f32 v11, v62, v63, v11
    ds_read_b128 v[96:99], v9 offset:20480
    s_waitcnt lgkmcnt(1)
    v_mfma_f32_32x32x16_bf16 v[48:63], v[92:95], v[4:7], 0
    s_nop 3
    v_max3_f32 v11, v32, v33, v11
    v_max3_f32 v11, v34, v35, v11
    v_max3_f32 v11, v36, v37, v11
    v_max3_f32 v11, v38, v39, v11
    v_max3_f32 v11, v40, v41, v11
    v_max3_f32 v11, v42, v43, v11
    v_max3_f32 v11, v44, v45, v11
    v_max3_f32 v11, v46, v47, v11
    ds_read_b128 v[88:91], v9 offset:21504
    s_waitcnt lgkmcnt(1)
    v_mfma_f32_32x32x16_bf16 v[32:47], v[96:99], v[4:7], 0
    s_nop 3
    v_max3_f32 v11, v48, v49, v11
    v_max3_f32 v11, v50, v51, v11
    v_max3_f32 v11, v52, v53, v11
    v_max3_f32 v11, v54, v55, v11
    v_max3_f32 v11, v56, v57, v11
    v_max3_f32 v11, v58, v59, v11
    v_max3_f32 v11, v60, v61, v11
    v_max3_f32 v11, v62, v63, v11
    ds_read_b128 v[92:95], v9 offset:22528
    s_waitcnt lgkmcnt(1)
    v_mfma_f32_32x32x16_bf16 v[48:63], v[88:91], v[4:7], 0
    s_nop 3
    v_max3_f32 v11, v32, v33, v11
    v_max3_f32 v11, v34, v35, v11
    v_max3_f32 v11, v36, v37, v11
    v_max3_f32 v11, v38, v39, v11
    v_max3_f32 v11, v40, v41, v11
    v_max3_f32 v11, v42, v43, v11
    v_max3_f32 v11, v44, v45, v11
    v_max3_f32 v11, v46, v47, v11
    ds_read_b128 v[96:99], v9 offset:23552
    s_waitcnt lgkmcnt(1)
    v_mfma_f32_32x32x16_bf16 v[32:47], v[92:95], v[4:7], 0
    s_nop 3
    v_max3_f32 v11, v48, v49, v11
    v_max3_f32 v11, v50, v51, v11
    v_max3_f32 v11, v52, v53, v11
    v_max3_f32 v11, v54, v55, v11
    v_max3_f32 v11, v56, v57, v11
    v_max3_f32 v11, v58, v59, v11
    v_max3_f32 v11, v60, v61, v11
    v_max3_f32 v11, v62, v63, v11
    ds_read_b128 v[88:91], v9 offset:24576
    s_waitcnt lgkmcnt(1)
    v_mfma_f32_32x32x16_bf16 v[48:63], v[96:99], v[4:7], 0
    s_nop 3
    v_max3_f32 v11, v32, v33, v11
    v_max3_f32 v11, v34, v35, v11
    v_max3_f32 v11, v36, v37, v11
    v_max3_f32 v11, v38, v39, v11
    v_max3_f32 v11, v40, v41, v11
    v_max3_f32 v11, v42, v43, v11
    v_max3_f32 v11, v44, v45, v11
    v_max3_f32 v11, v46, v47, v11
    ds_read_b128 v[92:95], v9 offset:25600
    s_waitcnt lgkmcnt(1)
    v_mfma_f32_32x32x16_bf16 v[32:47], v[88:91], v[4:7], 0
    s_nop 3
    v_max3_f32 v11, v48, v49, v11
    v_max3_f32 v11, v50, v51, v11
    v_max3_f32 v11, v52, v53, v11
    v_max3_f32 v11, v54, v55, v11
    v_max3_f32 v11, v56, v57, v11
    v_max3_f32 v11, v58, v59, v11
    v_max3_f32 v11, v60, v61, v11
    v_max3_f32 v11, v62, v63, v11
    ds_read_b128 v[96:99], v9 offset:26624
    s_waitcnt lgkmcnt(1)
    v_mfma_f32_32x32x16_bf16 v[48:63], v[92:95], v[4:7], 0
    s_nop 3
    v_max3_f32 v11, v32, v33, v11
    v_max3_f32 v11, v34, v35, v11
    v_max3_f32 v11, v36, v37, v11
    v_max3_f32 v11, v38, v39, v11
    v_max3_f32 v11, v40, v41, v11
    v_max3_f32 v11, v42, v43, v11
    v_max3_f32 v11, v44, v45, v11
    v_max3_f32 v11, v46, v47, v11
    ds_read_b128 v[88:91], v9 offset:27648
    s_waitcnt lgkmcnt(1)
    v_mfma_f32_32x32x16_bf16 v[32:47], v[96:99], v[4:7], 0
    s_nop 3
    v_max3_f32 v11, v48, v49, v11
    v_max3_f32 v11, v50, v51, v11
    v_max3_f32 v11, v52, v53, v11
    v_max3_f32 v11, v54, v55, v11
    v_max3_f32 v11, v56, v57, v11
    v_max3_f32 v11, v58, v59, v11
    v_max3_f32 v11, v60, v61, v11
    v_max3_f32 v11, v62, v63, v11
    ds_read_b128 v[92:95], v9 offset:28672
    s_waitcnt lgkmcnt(1)
    v_mfma_f32_32x32x16_bf16 v[48:63], v[88:91], v[4:7], 0
    s_nop 3
    v_max3_f32 v11, v32, v33, v11
    v_max3_f32 v11, v34, v35, v11
    v_max3_f32 v11, v36, v37, v11
    v_max3_f32 v11, v38, v39, v11
    v_max3_f32 v11, v40, v41, v11
    v_max3_f32 v11, v42, v43, v11
    v_max3_f32 v11, v44, v45, v11
    v_max3_f32 v11, v46, v47, v11
    ds_read_b128 v[96:99], v9 offset:29696
    s_waitcnt lgkmcnt(1)
    v_mfma_f32_32x32x16_bf16 v[32:47], v[92:95], v[4:7], 0
    s_nop 3
    v_max3_f32 v11, v48, v49, v11
    v_max3_f32 v11, v50, v51, v11
    v_max3_f32 v11, v52, v53, v11
    v_max3_f32 v11, v54, v55, v11
    v_max3_f32 v11, v56, v57, v11
    v_max3_f32 v11, v58, v59, v11
    v_max3_f32 v11, v60, v61, v11
    v_max3_f32 v11, v62, v63, v11
    ds_read_b128 v[88:91], v9 offset:30720
    s_waitcnt lgkmcnt(1)
    v_mfma_f32_32x32x16_bf16 v[48:63], v[96:99], v[4:7], 0
    s_nop 3
    v_max3_f32 v11, v32, v33, v11
    v_max3_f32 v11, v34, v35, v11
    v_max3_f32 v11, v36, v37, v11
    v_max3_f32 v11, v38, v39, v11
    v_max3_f32 v11, v40, v41, v11
    v_max3_f32 v11, v42, v43, v11
    v_max3_f32 v11, v44, v45, v11
    v_max3_f32 v11, v46, v47, v11
    ds_read_b128 v[92:95], v9 offset:31744
    s_waitcnt lgkmcnt(1)
    v_mfma_f32_32x32x16_bf16 v[32:47], v[88:91], v[4:7], 0
    s_nop 3
    v_max3_f32 v11, v48, v49, v11
    v_max3_f32 v11, v50, v51, v11
    v_max3_f32 v11, v52, v53, v11
    v_max3_f32 v11, v54, v55, v11
    v_max3_f32 v11, v56, v57, v11
    v_max3_f32 v11, v58, v59, v11
    v_max3_f32 v11, v60, v61, v11
    v_max3_f32 v11, v62, v63, v11
    s_waitcnt lgkmcnt(0)
    v_mfma_f32_32x32x16_bf16 v[48:63], v[92:95], v[4:7], 0
    s_nop 3
    v_max3_f32 v11, v32, v33, v11
    v_max3_f32 v11, v34, v35, v11
    v_max3_f32 v11, v36, v37, v11
    v_max3_f32 v11, v38, v39, v11
    v_max3_f32 v11, v40, v41, v11
    v_max3_f32 v11, v42, v43, v11
    v_max3_f32 v11, v44, v45, v11
    v_max3_f32 v11, v46, v47, v11
    s_nop 3
    v_max3_f32 v11, v48, v49, v11
    v_max3_f32 v11, v50, v51, v11
    v_max3_f32 v11, v52, v53, v11
    v_max3_f32 v11, v54, v55, v11
    v_max3_f32 v11, v56, v57, v11
    v_max3_f32 v11, v58, v59, v11
    v_max3_f32 v11, v60, v61, v11
    v_max3_f32 v11, v62, v63, v11
    v_mov_b32 v12, v11
    s_nop 1
    v_permlane32_swap_b32 v11, v12
    s_nop 1
    v_max_f32 v11, v11, v12
    v_xor_b32 v16, 0x80000000, v11
    v_xor_b32 v17, 0x80000000, v11
    v_xor_b32 v18, 0x80000000, v11
    v_xor_b32 v19, 0x80000000, v11
    v_xor_b32 v20, 0x80000000, v11
    v_xor_b32 v21, 0x80000000, v11
    v_xor_b32 v22, 0x80000000, v11
    v_xor_b32 v23, 0x80000000, v11
    v_xor_b32 v24, 0x80000000, v11
    v_xor_b32 v25, 0x80000000, v11
    v_xor_b32 v26, 0x80000000, v11
    v_xor_b32 v27, 0x80000000, v11
    v_xor_b32 v28, 0x80000000, v11
    v_xor_b32 v29, 0x80000000, v11
    v_xor_b32 v30, 0x80000000, v11
    v_xor_b32 v31, 0x80000000, v11
    s_nop 1
    ds_read_b128 v[88:91], v9 offset:0
    ds_read_b128 v[92:95], v9 offset:1024
    s_mov_b64 exec, s[58:59]
    ds_read_b128 v[100:103], v10 offset:0
    ds_read_b128 v[104:107], v10 offset:512
    s_mov_b64 exec, -1
    s_waitcnt lgkmcnt(3)
    v_mfma_f32_32x32x16_bf16 v[32:47], v[88:91], v[4:7], v[16:31]
    ds_read_b128 v[96:99], v9 offset:2048
    s_waitcnt lgkmcnt(3)
    v_mfma_f32_32x32x16_bf16 v[48:63], v[92:95], v[4:7], v[16:31]
    s_nop 10
    v_exp_f32 v32, v32
    v_exp_f32 v33, v33
    v_exp_f32 v34, v34
    v_exp_f32 v35, v35
    v_exp_f32 v36, v36
    v_exp_f32 v37, v37
    v_exp_f32 v38, v38
    v_exp_f32 v39, v39
    v_exp_f32 v40, v40
    v_exp_f32 v41, v41
    v_exp_f32 v42, v42
    v_exp_f32 v43, v43
    v_exp_f32 v44, v44
    v_exp_f32 v45, v45
    v_exp_f32 v46, v46
    v_exp_f32 v47, v47
    v_cvt_pk_bf16_f32 v80, v32, v33
    v_cvt_pk_bf16_f32 v81, v34, v35
    v_cvt_pk_bf16_f32 v82, v36, v37
    v_cvt_pk_bf16_f32 v83, v38, v39
    v_cvt_pk_bf16_f32 v84, v40, v41
    v_cvt_pk_bf16_f32 v85, v42, v43
    v_cvt_pk_bf16_f32 v86, v44, v45
    v_cvt_pk_bf16_f32 v87, v46, v47
    s_waitcnt lgkmcnt(1)
    v_mfma_f32_32x32x16_bf16 v[64:79], v[100:103], v[80:83], 0
    v_mfma_f32_32x32x16_bf16 v[64:79], v[104:107], v[84:87], v[64:79]
    s_mov_b64 exec, s[58:59]
    ds_read_b128 v[108:111], v10 offset:1024
    ds_read_b128 v[112:115], v10 offset:1536
    s_mov_b64 exec, -1
    ds_read_b128 v[88:91], v9 offset:3072
    s_waitcnt lgkmcnt(3)
    v_mfma_f32_32x32x16_bf16 v[32:47], v[96:99], v[4:7], v[16:31]
    v_exp_f32 v48, v48
    v_exp_f32 v49, v49
    v_exp_f32 v50, v50
    v_exp_f32 v51, v51
    v_exp_f32 v52, v52
    v_exp_f32 v53, v53
    v_exp_f32 v54, v54
    v_exp_f32 v55, v55
    v_exp_f32 v56, v56
    v_exp_f32 v57, v57
    v_exp_f32 v58, v58
    v_exp_f32 v59, v59
    v_exp_f32 v60, v60
    v_exp_f32 v61, v61
    v_exp_f32 v62, v62
    v_exp_f32 v63, v63
    v_cvt_pk_bf16_f32 v80, v48, v49
    v_cvt_pk_bf16_f32 v81, v50, v51
    v_cvt_pk_bf16_f32 v82, v52, v53
    v_cvt_pk_bf16_f32 v83, v54, v55
    v_cvt_pk_bf16_f32 v84, v56, v57
    v_cvt_pk_bf16_f32 v85, v58, v59
    v_cvt_pk_bf16_f32 v86, v60, v61
    v_cvt_pk_bf16_f32 v87, v62, v63
    s_waitcnt lgkmcnt(1)
    v_mfma_f32_32x32x16_bf16 v[64:79], v[108:111], v[80:83], v[64:79]
    v_mfma_f32_32x32x16_bf16 v[64:79], v[112:115], v[84:87], v[64:79]
    s_mov_b64 exec, s[58:59]
    ds_read_b128 v[100:103], v10 offset:2048
    ds_read_b128 v[104:107], v10 offset:2560
    s_mov_b64 exec, -1
    ds_read_b128 v[92:95], v9 offset:4096
    s_waitcnt lgkmcnt(3)
    v_mfma_f32_32x32x16_bf16 v[48:63], v[88:91], v[4:7], v[16:31]
    v_exp_f32 v32, v32
    v_exp_f32 v33, v33
    v_exp_f32 v34, v34
    v_exp_f32 v35, v35
    v_exp_f32 v36, v36
    v_exp_f32 v37, v37
    v_exp_f32 v38, v38
    v_exp_f32 v39, v39
    v_exp_f32 v40, v40
    v_exp_f32 v41, v41
    v_exp_f32 v42, v42
    v_exp_f32 v43, v43
    v_exp_f32 v44, v44
    v_exp_f32 v45, v45
    v_exp_f32 v46, v46
    v_exp_f32 v47, v47
    v_cvt_pk_bf16_f32 v80, v32, v33
    v_cvt_pk_bf16_f32 v81, v34, v35
    v_cvt_pk_bf16_f32 v82, v36, v37
    v_cvt_pk_bf16_f32 v83, v38, v39
    v_cvt_pk_bf16_f32 v84, v40, v41
    v_cvt_pk_bf16_f32 v85, v42, v43
    v_cvt_pk_bf16_f32 v86, v44, v45
    v_cvt_pk_bf16_f32 v87, v46, v47
    s_waitcnt lgkmcnt(1)
    v_mfma_f32_32x32x16_bf16 v[64:79], v[100:103], v[80:83], v[64:79]
    v_mfma_f32_32x32x16_bf16 v[64:79], v[104:107], v[84:87], v[64:79]
    s_mov_b64 exec, s[58:59]
    ds_read_b128 v[108:111], v10 offset:3072
    ds_read_b128 v[112:115], v10 offset:3584
    s_mov_b64 exec, -1
    ds_read_b128 v[96:99], v9 offset:5120
    s_waitcnt lgkmcnt(3)
    v_mfma_f32_32x32x16_bf16 v[32:47], v[92:95], v[4:7], v[16:31]
    v_exp_f32 v48, v48
    v_exp_f32 v49, v49
    v_exp_f32 v50, v50
    v_exp_f32 v51, v51
    v_exp_f32 v52, v52
    v_exp_f32 v53, v53
    v_exp_f32 v54, v54
    v_exp_f32 v55, v55
    v_exp_f32 v56, v56
    v_exp_f32 v57, v57
    v_exp_f32 v58, v58
    v_exp_f32 v59, v59
    v_exp_f32 v60, v60
    v_exp_f32 v61, v61
    v_exp_f32 v62, v62
    v_exp_f32 v63, v63
    v_cvt_pk_bf16_f32 v80, v48, v49
    v_cvt_pk_bf16_f32 v81, v50, v51
    v_cvt_pk_bf16_f32 v82, v52, v53
    v_cvt_pk_bf16_f32 v83, v54, v55
    v_cvt_pk_bf16_f32 v84, v56, v57
    v_cvt_pk_bf16_f32 v85, v58, v59
    v_cvt_pk_bf16_f32 v86, v60, v61
    v_cvt_pk_bf16_f32 v87, v62, v63
    s_waitcnt lgkmcnt(1)
    v_mfma_f32_32x32x16_bf16 v[64:79], v[108:111], v[80:83], v[64:79]
    v_mfma_f32_32x32x16_bf16 v[64:79], v[112:115], v[84:87], v[64:79]
    s_mov_b64 exec, s[58:59]
    ds_read_b128 v[100:103], v10 offset:4096
    ds_read_b128 v[104:107], v10 offset:4608
    s_mov_b64 exec, -1
    ds_read_b128 v[88:91], v9 offset:6144
    s_waitcnt lgkmcnt(3)
    v_mfma_f32_32x32x16_bf16 v[48:63], v[96:99], v[4:7], v[16:31]
    v_exp_f32 v32, v32
    v_exp_f32 v33, v33
    v_exp_f32 v34, v34
    v_exp_f32 v35, v35
    v_exp_f32 v36, v36
    v_exp_f32 v37, v37
    v_exp_f32 v38, v38
    v_exp_f32 v39, v39
    v_exp_f32 v40, v40
    v_exp_f32 v41, v41
    v_exp_f32 v42, v42
    v_exp_f32 v43, v43
    v_exp_f32 v44, v44
    v_exp_f32 v45, v45
    v_exp_f32 v46, v46
    v_exp_f32 v47, v47
    v_cvt_pk_bf16_f32 v80, v32, v33
    v_cvt_pk_bf16_f32 v81, v34, v35
    v_cvt_pk_bf16_f32 v82, v36, v37
    v_cvt_pk_bf16_f32 v83, v38, v39
    v_cvt_pk_bf16_f32 v84, v40, v41
    v_cvt_pk_bf16_f32 v85, v42, v43
    v_cvt_pk_bf16_f32 v86, v44, v45
    v_cvt_pk_bf16_f32 v87, v46, v47
    s_waitcnt lgkmcnt(1)
    v_mfma_f32_32x32x16_bf16 v[64:79], v[100:103], v[80:83], v[64:79]
    v_mfma_f32_32x32x16_bf16 v[64:79], v[104:107], v[84:87], v[64:79]
    s_mov_b64 exec, s[58:59]
    ds_read_b128 v[108:111], v10 offset:5120
    ds_read_b128 v[112:115], v10 offset:5632
    s_mov_b64 exec, -1
    ds_read_b128 v[92:95], v9 offset:7168
    s_waitcnt lgkmcnt(3)
    v_mfma_f32_32x32x16_bf16 v[32:47], v[88:91], v[4:7], v[16:31]
    v_exp_f32 v48, v48
    v_exp_f32 v49, v49
    v_exp_f32 v50, v50
    v_exp_f32 v51, v51
    v_exp_f32 v52, v52
    v_exp_f32 v53, v53
    v_exp_f32 v54, v54
    v_exp_f32 v55, v55
    v_exp_f32 v56, v56
    v_exp_f32 v57, v57
    v_exp_f32 v58, v58
    v_exp_f32 v59, v59
    v_exp_f32 v60, v60
    v_exp_f32 v61, v61
    v_exp_f32 v62, v62
    v_exp_f32 v63, v63
    v_cvt_pk_bf16_f32 v80, v48, v49
    v_cvt_pk_bf16_f32 v81, v50, v51
    v_cvt_pk_bf16_f32 v82, v52, v53
    v_cvt_pk_bf16_f32 v83, v54, v55
    v_cvt_pk_bf16_f32 v84, v56, v57
    v_cvt_pk_bf16_f32 v85, v58, v59
    v_cvt_pk_bf16_f32 v86, v60, v61
    v_cvt_pk_bf16_f32 v87, v62, v63
    s_waitcnt lgkmcnt(1)
    v_mfma_f32_32x32x16_bf16 v[64:79], v[108:111], v[80:83], v[64:79]
    v_mfma_f32_32x32x16_bf16 v[64:79], v[112:115], v[84:87], v[64:79]
    s_mov_b64 exec, s[58:59]
    ds_read_b128 v[100:103], v10 offset:6144
    ds_read_b128 v[104:107], v10 offset:6656
    s_mov_b64 exec, -1
    ds_read_b128 v[96:99], v9 offset:8192
    s_waitcnt lgkmcnt(3)
    v_mfma_f32_32x32x16_bf16 v[48:63], v[92:95], v[4:7], v[16:31]
    v_exp_f32 v32, v32
    v_exp_f32 v33, v33
    v_exp_f32 v34, v34
    v_exp_f32 v35, v35
    v_exp_f32 v36, v36
    v_exp_f32 v37, v37
    v_exp_f32 v38, v38
    v_exp_f32 v39, v39
    v_exp_f32 v40, v40
    v_exp_f32 v41, v41
    v_exp_f32 v42, v42
    v_exp_f32 v43, v43
    v_exp_f32 v44, v44
    v_exp_f32 v45, v45
    v_exp_f32 v46, v46
    v_exp_f32 v47, v47
    v_cvt_pk_bf16_f32 v80, v32, v33
    v_cvt_pk_bf16_f32 v81, v34, v35
    v_cvt_pk_bf16_f32 v82, v36, v37
    v_cvt_pk_bf16_f32 v83, v38, v39
    v_cvt_pk_bf16_f32 v84, v40, v41
    v_cvt_pk_bf16_f32 v85, v42, v43
    v_cvt_pk_bf16_f32 v86, v44, v45
    v_cvt_pk_bf16_f32 v87, v46, v47
    s_waitcnt lgkmcnt(1)
    v_mfma_f32_32x32x16_bf16 v[64:79], v[100:103], v[80:83], v[64:79]
    v_mfma_f32_32x32x16_bf16 v[64:79], v[104:107], v[84:87], v[64:79]
    s_mov_b64 exec, s[58:59]
    ds_read_b128 v[108:111], v10 offset:7168
    ds_read_b128 v[112:115], v10 offset:7680
    s_mov_b64 exec, -1
    ds_read_b128 v[88:91], v9 offset:9216
    s_waitcnt lgkmcnt(3)
    v_mfma_f32_32x32x16_bf16 v[32:47], v[96:99], v[4:7], v[16:31]
    v_exp_f32 v48, v48
    v_exp_f32 v49, v49
    v_exp_f32 v50, v50
    v_exp_f32 v51, v51
    v_exp_f32 v52, v52
    v_exp_f32 v53, v53
    v_exp_f32 v54, v54
    v_exp_f32 v55, v55
    v_exp_f32 v56, v56
    v_exp_f32 v57, v57
    v_exp_f32 v58, v58
    v_exp_f32 v59, v59
    v_exp_f32 v60, v60
    v_exp_f32 v61, v61
    v_exp_f32 v62, v62
    v_exp_f32 v63, v63
    v_cvt_pk_bf16_f32 v80, v48, v49
    v_cvt_pk_bf16_f32 v81, v50, v51
    v_cvt_pk_bf16_f32 v82, v52, v53
    v_cvt_pk_bf16_f32 v83, v54, v55
    v_cvt_pk_bf16_f32 v84, v56, v57
    v_cvt_pk_bf16_f32 v85, v58, v59
    v_cvt_pk_bf16_f32 v86, v60, v61
    v_cvt_pk_bf16_f32 v87, v62, v63
    s_waitcnt lgkmcnt(1)
    v_mfma_f32_32x32x16_bf16 v[64:79], v[108:111], v[80:83], v[64:79]
    v_mfma_f32_32x32x16_bf16 v[64:79], v[112:115], v[84:87], v[64:79]
    s_mov_b64 exec, s[58:59]
    ds_read_b128 v[100:103], v10 offset:8192
    ds_read_b128 v[104:107], v10 offset:8704
    s_mov_b64 exec, -1
    ds_read_b128 v[92:95], v9 offset:10240
    s_waitcnt lgkmcnt(3)
    v_mfma_f32_32x32x16_bf16 v[48:63], v[88:91], v[4:7], v[16:31]
    v_exp_f32 v32, v32
    v_exp_f32 v33, v33
    v_exp_f32 v34, v34
    v_exp_f32 v35, v35
    v_exp_f32 v36, v36
    v_exp_f32 v37, v37
    v_exp_f32 v38, v38
    v_exp_f32 v39, v39
    v_exp_f32 v40, v40
    v_exp_f32 v41, v41
    v_exp_f32 v42, v42
    v_exp_f32 v43, v43
    v_exp_f32 v44, v44
    v_exp_f32 v45, v45
    v_exp_f32 v46, v46
    v_exp_f32 v47, v47
    v_cvt_pk_bf16_f32 v80, v32, v33
    v_cvt_pk_bf16_f32 v81, v34, v35
    v_cvt_pk_bf16_f32 v82, v36, v37
    v_cvt_pk_bf16_f32 v83, v38, v39
    v_cvt_pk_bf16_f32 v84, v40, v41
    v_cvt_pk_bf16_f32 v85, v42, v43
    v_cvt_pk_bf16_f32 v86, v44, v45
    v_cvt_pk_bf16_f32 v87, v46, v47
    s_waitcnt lgkmcnt(1)
    v_mfma_f32_32x32x16_bf16 v[64:79], v[100:103], v[80:83], v[64:79]
    v_mfma_f32_32x32x16_bf16 v[64:79], v[104:107], v[84:87], v[64:79]
    s_mov_b64 exec, s[58:59]
    ds_read_b128 v[108:111], v10 offset:9216
    ds_read_b128 v[112:115], v10 offset:9728
    s_mov_b64 exec, -1
    ds_read_b128 v[96:99], v9 offset:11264
    s_waitcnt lgkmcnt(3)
    v_mfma_f32_32x32x16_bf16 v[32:47], v[92:95], v[4:7], v[16:31]
    v_exp_f32 v48, v48
    v_exp_f32 v49, v49
    v_exp_f32 v50, v50
    v_exp_f32 v51, v51
    v_exp_f32 v52, v52
    v_exp_f32 v53, v53
    v_exp_f32 v54, v54
    v_exp_f32 v55, v55
    v_exp_f32 v56, v56
    v_exp_f32 v57, v57
    v_exp_f32 v58, v58
    v_exp_f32 v59, v59
    v_exp_f32 v60, v60
    v_exp_f32 v61, v61
    v_exp_f32 v62, v62
    v_exp_f32 v63, v63
    v_cvt_pk_bf16_f32 v80, v48, v49
    v_cvt_pk_bf16_f32 v81, v50, v51
    v_cvt_pk_bf16_f32 v82, v52, v53
    v_cvt_pk_bf16_f32 v83, v54, v55
    v_cvt_pk_bf16_f32 v84, v56, v57
    v_cvt_pk_bf16_f32 v85, v58, v59
    v_cvt_pk_bf16_f32 v86, v60, v61
    v_cvt_pk_bf16_f32 v87, v62, v63
    s_waitcnt lgkmcnt(1)
    v_mfma_f32_32x32x16_bf16 v[64:79], v[108:111], v[80:83], v[64:79]
    v_mfma_f32_32x32x16_bf16 v[64:79], v[112:115], v[84:87], v[64:79]
    s_mov_b64 exec, s[58:59]
    ds_read_b128 v[100:103], v10 offset:10240
    ds_read_b128 v[104:107], v10 offset:10752
    s_mov_b64 exec, -1
    ds_read_b128 v[88:91], v9 offset:12288
    s_waitcnt lgkmcnt(3)
    v_mfma_f32_32x32x16_bf16 v[48:63], v[96:99], v[4:7], v[16:31]
    v_exp_f32 v32, v32
    v_exp_f32 v33, v33
    v_exp_f32 v34, v34
    v_exp_f32 v35, v35
    v_exp_f32 v36, v36
    v_exp_f32 v37, v37
    v_exp_f32 v38, v38
    v_exp_f32 v39, v39
    v_exp_f32 v40, v40
    v_exp_f32 v41, v41
    v_exp_f32 v42, v42
    v_exp_f32 v43, v43
    v_exp_f32 v44, v44
    v_exp_f32 v45, v45
    v_exp_f32 v46, v46
    v_exp_f32 v47, v47
    v_cvt_pk_bf16_f32 v80, v32, v33
    v_cvt_pk_bf16_f32 v81, v34, v35
    v_cvt_pk_bf16_f32 v82, v36, v37
    v_cvt_pk_bf16_f32 v83, v38, v39
    v_cvt_pk_bf16_f32 v84, v40, v41
    v_cvt_pk_bf16_f32 v85, v42, v43
    v_cvt_pk_bf16_f32 v86, v44, v45
    v_cvt_pk_bf16_f32 v87, v46, v47
    s_waitcnt lgkmcnt(1)
    v_mfma_f32_32x32x16_bf16 v[64:79], v[100:103], v[80:83], v[64:79]
    v_mfma_f32_32x32x16_bf16 v[64:79], v[104:107], v[84:87], v[64:79]
    s_mov_b64 exec, s[58:59]
    ds_read_b128 v[108:111], v10 offset:11264
    ds_read_b128 v[112:115], v10 offset:11776
    s_mov_b64 exec, -1
    ds_read_b128 v[92:95], v9 offset:13312
    s_waitcnt lgkmcnt(3)
    v_mfma_f32_32x32x16_bf16 v[32:47], v[88:91], v[4:7], v[16:31]
    v_exp_f32 v48, v48
    v_exp_f32 v49, v49
    v_exp_f32 v50, v50
    v_exp_f32 v51, v51
    v_exp_f32 v52, v52
    v_exp_f32 v53, v53
    v_exp_f32 v54, v54
    v_exp_f32 v55, v55
    v_exp_f32 v56, v56
    v_exp_f32 v57, v57
    v_exp_f32 v58, v58
    v_exp_f32 v59, v59
    v_exp_f32 v60, v60
    v_exp_f32 v61, v61
    v_exp_f32 v62, v62
    v_exp_f32 v63, v63
    v_cvt_pk_bf16_f32 v80, v48, v49
    v_cvt_pk_bf16_f32 v81, v50, v51
    v_cvt_pk_bf16_f32 v82, v52, v53
    v_cvt_pk_bf16_f32 v83, v54, v55
    v_cvt_pk_bf16_f32 v84, v56, v57
    v_cvt_pk_bf16_f32 v85, v58, v59
    v_cvt_pk_bf16_f32 v86, v60, v61
    v_cvt_pk_bf16_f32 v87, v62, v63
    s_waitcnt lgkmcnt(1)
    v_mfma_f32_32x32x16_bf16 v[64:79], v[108:111], v[80:83], v[64:79]
    v_mfma_f32_32x32x16_bf16 v[64:79], v[112:115], v[84:87], v[64:79]
    s_mov_b64 exec, s[58:59]
    ds_read_b128 v[100:103], v10 offset:12288
    ds_read_b128 v[104:107], v10 offset:12800
    s_mov_b64 exec, -1
    ds_read_b128 v[96:99], v9 offset:14336
    s_waitcnt lgkmcnt(3)
    v_mfma_f32_32x32x16_bf16 v[48:63], v[92:95], v[4:7], v[16:31]
    v_exp_f32 v32, v32
    v_exp_f32 v33, v33
    v_exp_f32 v34, v34
    v_exp_f32 v35, v35
    v_exp_f32 v36, v36
    v_exp_f32 v37, v37
    v_exp_f32 v38, v38
    v_exp_f32 v39, v39
    v_exp_f32 v40, v40
    v_exp_f32 v41, v41
    v_exp_f32 v42, v42
    v_exp_f32 v43, v43
    v_exp_f32 v44, v44
    v_exp_f32 v45, v45
    v_exp_f32 v46, v46
    v_exp_f32 v47, v47
    v_cvt_pk_bf16_f32 v80, v32, v33
    v_cvt_pk_bf16_f32 v81, v34, v35
    v_cvt_pk_bf16_f32 v82, v36, v37
    v_cvt_pk_bf16_f32 v83, v38, v39
    v_cvt_pk_bf16_f32 v84, v40, v41
    v_cvt_pk_bf16_f32 v85, v42, v43
    v_cvt_pk_bf16_f32 v86, v44, v45
    v_cvt_pk_bf16_f32 v87, v46, v47
    s_waitcnt lgkmcnt(1)
    v_mfma_f32_32x32x16_bf16 v[64:79], v[100:103], v[80:83], v[64:79]
    v_mfma_f32_32x32x16_bf16 v[64:79], v[104:107], v[84:87], v[64:79]
    s_mov_b64 exec, s[58:59]
    ds_read_b128 v[108:111], v10 offset:13312
    ds_read_b128 v[112:115], v10 offset:13824
    s_mov_b64 exec, -1
    ds_read_b128 v[88:91], v9 offset:15360
    s_waitcnt lgkmcnt(3)
    v_mfma_f32_32x32x16_bf16 v[32:47], v[96:99], v[4:7], v[16:31]
    v_exp_f32 v48, v48
    v_exp_f32 v49, v49
    v_exp_f32 v50, v50
    v_exp_f32 v51, v51
    v_exp_f32 v52, v52
    v_exp_f32 v53, v53
    v_exp_f32 v54, v54
    v_exp_f32 v55, v55
    v_exp_f32 v56, v56
    v_exp_f32 v57, v57
    v_exp_f32 v58, v58
    v_exp_f32 v59, v59
    v_exp_f32 v60, v60
    v_exp_f32 v61, v61
    v_exp_f32 v62, v62
    v_exp_f32 v63, v63
    v_cvt_pk_bf16_f32 v80, v48, v49
    v_cvt_pk_bf16_f32 v81, v50, v51
    v_cvt_pk_bf16_f32 v82, v52, v53
    v_cvt_pk_bf16_f32 v83, v54, v55
    v_cvt_pk_bf16_f32 v84, v56, v57
    v_cvt_pk_bf16_f32 v85, v58, v59
    v_cvt_pk_bf16_f32 v86, v60, v61
    v_cvt_pk_bf16_f32 v87, v62, v63
    s_waitcnt lgkmcnt(1)
    v_mfma_f32_32x32x16_bf16 v[64:79], v[108:111], v[80:83], v[64:79]
    v_mfma_f32_32x32x16_bf16 v[64:79], v[112:115], v[84:87], v[64:79]
    s_mov_b64 exec, s[58:59]
    ds_read_b128 v[100:103], v10 offset:14336
    ds_read_b128 v[104:107], v10 offset:14848
    s_mov_b64 exec, -1
    ds_read_b128 v[92:95], v9 offset:16384
    s_waitcnt lgkmcnt(3)
    v_mfma_f32_32x32x16_bf16 v[48:63], v[88:91], v[4:7], v[16:31]
    v_exp_f32 v32, v32
    v_exp_f32 v33, v33
    v_exp_f32 v34, v34
    v_exp_f32 v35, v35
    v_exp_f32 v36, v36
    v_exp_f32 v37, v37
    v_exp_f32 v38, v38
    v_exp_f32 v39, v39
    v_exp_f32 v40, v40
    v_exp_f32 v41, v41
    v_exp_f32 v42, v42
    v_exp_f32 v43, v43
    v_exp_f32 v44, v44
    v_exp_f32 v45, v45
    v_exp_f32 v46, v46
    v_exp_f32 v47, v47
    v_cvt_pk_bf16_f32 v80, v32, v33
    v_cvt_pk_bf16_f32 v81, v34, v35
    v_cvt_pk_bf16_f32 v82, v36, v37
    v_cvt_pk_bf16_f32 v83, v38, v39
    v_cvt_pk_bf16_f32 v84, v40, v41
    v_cvt_pk_bf16_f32 v85, v42, v43
    v_cvt_pk_bf16_f32 v86, v44, v45
    v_cvt_pk_bf16_f32 v87, v46, v47
    s_waitcnt lgkmcnt(1)
    v_mfma_f32_32x32x16_bf16 v[64:79], v[100:103], v[80:83], v[64:79]
    v_mfma_f32_32x32x16_bf16 v[64:79], v[104:107], v[84:87], v[64:79]
    s_mov_b64 exec, s[58:59]
    ds_read_b128 v[108:111], v10 offset:15360
    ds_read_b128 v[112:115], v10 offset:15872
    s_mov_b64 exec, -1
    ds_read_b128 v[96:99], v9 offset:17408
    s_waitcnt lgkmcnt(3)
    v_mfma_f32_32x32x16_bf16 v[32:47], v[92:95], v[4:7], v[16:31]
    v_exp_f32 v48, v48
    v_exp_f32 v49, v49
    v_exp_f32 v50, v50
    v_exp_f32 v51, v51
    v_exp_f32 v52, v52
    v_exp_f32 v53, v53
    v_exp_f32 v54, v54
    v_exp_f32 v55, v55
    v_exp_f32 v56, v56
    v_exp_f32 v57, v57
    v_exp_f32 v58, v58
    v_exp_f32 v59, v59
    v_exp_f32 v60, v60
    v_exp_f32 v61, v61
    v_exp_f32 v62, v62
    v_exp_f32 v63, v63
    v_cvt_pk_bf16_f32 v80, v48, v49
    v_cvt_pk_bf16_f32 v81, v50, v51
    v_cvt_pk_bf16_f32 v82, v52, v53
    v_cvt_pk_bf16_f32 v83, v54, v55
    v_cvt_pk_bf16_f32 v84, v56, v57
    v_cvt_pk_bf16_f32 v85, v58, v59
    v_cvt_pk_bf16_f32 v86, v60, v61
    v_cvt_pk_bf16_f32 v87, v62, v63
    s_waitcnt lgkmcnt(1)
    v_mfma_f32_32x32x16_bf16 v[64:79], v[108:111], v[80:83], v[64:79]
    v_mfma_f32_32x32x16_bf16 v[64:79], v[112:115], v[84:87], v[64:79]
    s_mov_b64 exec, s[58:59]
    ds_read_b128 v[100:103], v10 offset:16384
    ds_read_b128 v[104:107], v10 offset:16896
    s_mov_b64 exec, -1
    ds_read_b128 v[88:91], v9 offset:18432
    s_waitcnt lgkmcnt(3)
    v_mfma_f32_32x32x16_bf16 v[48:63], v[96:99], v[4:7], v[16:31]
    v_exp_f32 v32, v32
    v_exp_f32 v33, v33
    v_exp_f32 v34, v34
    v_exp_f32 v35, v35
    v_exp_f32 v36, v36
    v_exp_f32 v37, v37
    v_exp_f32 v38, v38
    v_exp_f32 v39, v39
    v_exp_f32 v40, v40
    v_exp_f32 v41, v41
    v_exp_f32 v42, v42
    v_exp_f32 v43, v43
    v_exp_f32 v44, v44
    v_exp_f32 v45, v45
    v_exp_f32 v46, v46
    v_exp_f32 v47, v47
    v_cvt_pk_bf16_f32 v80, v32, v33
    v_cvt_pk_bf16_f32 v81, v34, v35
    v_cvt_pk_bf16_f32 v82, v36, v37
    v_cvt_pk_bf16_f32 v83, v38, v39
    v_cvt_pk_bf16_f32 v84, v40, v41
    v_cvt_pk_bf16_f32 v85, v42, v43
    v_cvt_pk_bf16_f32 v86, v44, v45
    v_cvt_pk_bf16_f32 v87, v46, v47
    s_waitcnt lgkmcnt(1)
    v_mfma_f32_32x32x16_bf16 v[64:79], v[100:103], v[80:83], v[64:79]
    v_mfma_f32_32x32x16_bf16 v[64:79], v[104:107], v[84:87], v[64:79]
    s_mov_b64 exec, s[58:59]
    ds_read_b128 v[108:111], v10 offset:17408
    ds_read_b128 v[112:115], v10 offset:17920
    s_mov_b64 exec, -1
    ds_read_b128 v[92:95], v9 offset:19456
    s_waitcnt lgkmcnt(3)
    v_mfma_f32_32x32x16_bf16 v[32:47], v[88:91], v[4:7], v[16:31]
    v_exp_f32 v48, v48
    v_exp_f32 v49, v49
    v_exp_f32 v50, v50
    v_exp_f32 v51, v51
    v_exp_f32 v52, v52
    v_exp_f32 v53, v53
    v_exp_f32 v54, v54
    v_exp_f32 v55, v55
    v_exp_f32 v56, v56
    v_exp_f32 v57, v57
    v_exp_f32 v58, v58
    v_exp_f32 v59, v59
    v_exp_f32 v60, v60
    v_exp_f32 v61, v61
    v_exp_f32 v62, v62
    v_exp_f32 v63, v63
    v_cvt_pk_bf16_f32 v80, v48, v49
    v_cvt_pk_bf16_f32 v81, v50, v51
    v_cvt_pk_bf16_f32 v82, v52, v53
    v_cvt_pk_bf16_f32 v83, v54, v55
    v_cvt_pk_bf16_f32 v84, v56, v57
    v_cvt_pk_bf16_f32 v85, v58, v59
    v_cvt_pk_bf16_f32 v86, v60, v61
    v_cvt_pk_bf16_f32 v87, v62, v63
    s_waitcnt lgkmcnt(1)
    v_mfma_f32_32x32x16_bf16 v[64:79], v[108:111], v[80:83], v[64:79]
    v_mfma_f32_32x32x16_bf16 v[64:79], v[112:115], v[84:87], v[64:79]
    s_mov_b64 exec, s[58:59]
    ds_read_b128 v[100:103], v10 offset:18432
    ds_read_b128 v[104:107], v10 offset:18944
    s_mov_b64 exec, -1
    ds_read_b128 v[96:99], v9 offset:20480
    s_waitcnt lgkmcnt(3)
    v_mfma_f32_32x32x16_bf16 v[48:63], v[92:95], v[4:7], v[16:31]
    v_exp_f32 v32, v32
    v_exp_f32 v33, v33
    v_exp_f32 v34, v34
    v_exp_f32 v35, v35
    v_exp_f32 v36, v36
    v_exp_f32 v37, v37
    v_exp_f32 v38, v38
    v_exp_f32 v39, v39
    v_exp_f32 v40, v40
    v_exp_f32 v41, v41
    v_exp_f32 v42, v42
    v_exp_f32 v43, v43
    v_exp_f32 v44, v44
    v_exp_f32 v45, v45
    v_exp_f32 v46, v46
    v_exp_f32 v47, v47
    v_cvt_pk_bf16_f32 v80, v32, v33
    v_cvt_pk_bf16_f32 v81, v34, v35
    v_cvt_pk_bf16_f32 v82, v36, v37
    v_cvt_pk_bf16_f32 v83, v38, v39
    v_cvt_pk_bf16_f32 v84, v40, v41
    v_cvt_pk_bf16_f32 v85, v42, v43
    v_cvt_pk_bf16_f32 v86, v44, v45
    v_cvt_pk_bf16_f32 v87, v46, v47
    s_waitcnt lgkmcnt(1)
    v_mfma_f32_32x32x16_bf16 v[64:79], v[100:103], v[80:83], v[64:79]
    v_mfma_f32_32x32x16_bf16 v[64:79], v[104:107], v[84:87], v[64:79]
    s_mov_b64 exec, s[58:59]
    ds_read_b128 v[108:111], v10 offset:19456
    ds_read_b128 v[112:115], v10 offset:19968
    s_mov_b64 exec, -1
    ds_read_b128 v[88:91], v9 offset:21504
    s_waitcnt lgkmcnt(3)
    v_mfma_f32_32x32x16_bf16 v[32:47], v[96:99], v[4:7], v[16:31]
    v_exp_f32 v48, v48
    v_exp_f32 v49, v49
    v_exp_f32 v50, v50
    v_exp_f32 v51, v51
    v_exp_f32 v52, v52
    v_exp_f32 v53, v53
    v_exp_f32 v54, v54
    v_exp_f32 v55, v55
    v_exp_f32 v56, v56
    v_exp_f32 v57, v57
    v_exp_f32 v58, v58
    v_exp_f32 v59, v59
    v_exp_f32 v60, v60
    v_exp_f32 v61, v61
    v_exp_f32 v62, v62
    v_exp_f32 v63, v63
    v_cvt_pk_bf16_f32 v80, v48, v49
    v_cvt_pk_bf16_f32 v81, v50, v51
    v_cvt_pk_bf16_f32 v82, v52, v53
    v_cvt_pk_bf16_f32 v83, v54, v55
    v_cvt_pk_bf16_f32 v84, v56, v57
    v_cvt_pk_bf16_f32 v85, v58, v59
    v_cvt_pk_bf16_f32 v86, v60, v61
    v_cvt_pk_bf16_f32 v87, v62, v63
    s_waitcnt lgkmcnt(1)
    v_mfma_f32_32x32x16_bf16 v[64:79], v[108:111], v[80:83], v[64:79]
    v_mfma_f32_32x32x16_bf16 v[64:79], v[112:115], v[84:87], v[64:79]
    s_mov_b64 exec, s[58:59]
    ds_read_b128 v[100:103], v10 offset:20480
    ds_read_b128 v[104:107], v10 offset:20992
    s_mov_b64 exec, -1
    ds_read_b128 v[92:95], v9 offset:22528
    s_waitcnt lgkmcnt(3)
    v_mfma_f32_32x32x16_bf16 v[48:63], v[88:91], v[4:7], v[16:31]
    v_exp_f32 v32, v32
    v_exp_f32 v33, v33
    v_exp_f32 v34, v34
    v_exp_f32 v35, v35
    v_exp_f32 v36, v36
    v_exp_f32 v37, v37
    v_exp_f32 v38, v38
    v_exp_f32 v39, v39
    v_exp_f32 v40, v40
    v_exp_f32 v41, v41
    v_exp_f32 v42, v42
    v_exp_f32 v43, v43
    v_exp_f32 v44, v44
    v_exp_f32 v45, v45
    v_exp_f32 v46, v46
    v_exp_f32 v47, v47
    v_cvt_pk_bf16_f32 v80, v32, v33
    v_cvt_pk_bf16_f32 v81, v34, v35
    v_cvt_pk_bf16_f32 v82, v36, v37
    v_cvt_pk_bf16_f32 v83, v38, v39
    v_cvt_pk_bf16_f32 v84, v40, v41
    v_cvt_pk_bf16_f32 v85, v42, v43
    v_cvt_pk_bf16_f32 v86, v44, v45
    v_cvt_pk_bf16_f32 v87, v46, v47
    s_waitcnt lgkmcnt(1)
    v_mfma_f32_32x32x16_bf16 v[64:79], v[100:103], v[80:83], v[64:79]
    v_mfma_f32_32x32x16_bf16 v[64:79], v[104:107], v[84:87], v[64:79]
    s_mov_b64 exec, s[58:59]
    ds_read_b128 v[108:111], v10 offset:21504
    ds_read_b128 v[112:115], v10 offset:22016
    s_mov_b64 exec, -1
    ds_read_b128 v[96:99], v9 offset:23552
    s_waitcnt lgkmcnt(3)
    v_mfma_f32_32x32x16_bf16 v[32:47], v[92:95], v[4:7], v[16:31]
    v_exp_f32 v48, v48
    v_exp_f32 v49, v49
    v_exp_f32 v50, v50
    v_exp_f32 v51, v51
    v_exp_f32 v52, v52
    v_exp_f32 v53, v53
    v_exp_f32 v54, v54
    v_exp_f32 v55, v55
    v_exp_f32 v56, v56
    v_exp_f32 v57, v57
    v_exp_f32 v58, v58
    v_exp_f32 v59, v59
    v_exp_f32 v60, v60
    v_exp_f32 v61, v61
    v_exp_f32 v62, v62
    v_exp_f32 v63, v63
    v_cvt_pk_bf16_f32 v80, v48, v49
    v_cvt_pk_bf16_f32 v81, v50, v51
    v_cvt_pk_bf16_f32 v82, v52, v53
    v_cvt_pk_bf16_f32 v83, v54, v55
    v_cvt_pk_bf16_f32 v84, v56, v57
    v_cvt_pk_bf16_f32 v85, v58, v59
    v_cvt_pk_bf16_f32 v86, v60, v61
    v_cvt_pk_bf16_f32 v87, v62, v63
    s_waitcnt lgkmcnt(1)
    v_mfma_f32_32x32x16_bf16 v[64:79], v[108:111], v[80:83], v[64:79]
    v_mfma_f32_32x32x16_bf16 v[64:79], v[112:115], v[84:87], v[64:79]
    s_mov_b64 exec, s[58:59]
    ds_read_b128 v[100:103], v10 offset:22528
    ds_read_b128 v[104:107], v10 offset:23040
    s_mov_b64 exec, -1
    ds_read_b128 v[88:91], v9 offset:24576
    s_waitcnt lgkmcnt(3)
    v_mfma_f32_32x32x16_bf16 v[48:63], v[96:99], v[4:7], v[16:31]
    v_exp_f32 v32, v32
    v_exp_f32 v33, v33
    v_exp_f32 v34, v34
    v_exp_f32 v35, v35
    v_exp_f32 v36, v36
    v_exp_f32 v37, v37
    v_exp_f32 v38, v38
    v_exp_f32 v39, v39
    v_exp_f32 v40, v40
    v_exp_f32 v41, v41
    v_exp_f32 v42, v42
    v_exp_f32 v43, v43
    v_exp_f32 v44, v44
    v_exp_f32 v45, v45
    v_exp_f32 v46, v46
    v_exp_f32 v47, v47
    v_cvt_pk_bf16_f32 v80, v32, v33
    v_cvt_pk_bf16_f32 v81, v34, v35
    v_cvt_pk_bf16_f32 v82, v36, v37
    v_cvt_pk_bf16_f32 v83, v38, v39
    v_cvt_pk_bf16_f32 v84, v40, v41
    v_cvt_pk_bf16_f32 v85, v42, v43
    v_cvt_pk_bf16_f32 v86, v44, v45
    v_cvt_pk_bf16_f32 v87, v46, v47
    s_waitcnt lgkmcnt(1)
    v_mfma_f32_32x32x16_bf16 v[64:79], v[100:103], v[80:83], v[64:79]
    v_mfma_f32_32x32x16_bf16 v[64:79], v[104:107], v[84:87], v[64:79]
    s_mov_b64 exec, s[58:59]
    ds_read_b128 v[108:111], v10 offset:23552
    ds_read_b128 v[112:115], v10 offset:24064
    s_mov_b64 exec, -1
    ds_read_b128 v[92:95], v9 offset:25600
    s_waitcnt lgkmcnt(3)
    v_mfma_f32_32x32x16_bf16 v[32:47], v[88:91], v[4:7], v[16:31]
    v_exp_f32 v48, v48
    v_exp_f32 v49, v49
    v_exp_f32 v50, v50
    v_exp_f32 v51, v51
    v_exp_f32 v52, v52
    v_exp_f32 v53, v53
    v_exp_f32 v54, v54
    v_exp_f32 v55, v55
    v_exp_f32 v56, v56
    v_exp_f32 v57, v57
    v_exp_f32 v58, v58
    v_exp_f32 v59, v59
    v_exp_f32 v60, v60
    v_exp_f32 v61, v61
    v_exp_f32 v62, v62
    v_exp_f32 v63, v63
    v_cvt_pk_bf16_f32 v80, v48, v49
    v_cvt_pk_bf16_f32 v81, v50, v51
    v_cvt_pk_bf16_f32 v82, v52, v53
    v_cvt_pk_bf16_f32 v83, v54, v55
    v_cvt_pk_bf16_f32 v84, v56, v57
    v_cvt_pk_bf16_f32 v85, v58, v59
    v_cvt_pk_bf16_f32 v86, v60, v61
    v_cvt_pk_bf16_f32 v87, v62, v63
    s_waitcnt lgkmcnt(1)
    v_mfma_f32_32x32x16_bf16 v[64:79], v[108:111], v[80:83], v[64:79]
    v_mfma_f32_32x32x16_bf16 v[64:79], v[112:115], v[84:87], v[64:79]
    s_mov_b64 exec, s[58:59]
    ds_read_b128 v[100:103], v10 offset:24576
    ds_read_b128 v[104:107], v10 offset:25088
    s_mov_b64 exec, -1
    ds_read_b128 v[96:99], v9 offset:26624
    s_waitcnt lgkmcnt(3)
    v_mfma_f32_32x32x16_bf16 v[48:63], v[92:95], v[4:7], v[16:31]
    v_exp_f32 v32, v32
    v_exp_f32 v33, v33
    v_exp_f32 v34, v34
    v_exp_f32 v35, v35
    v_exp_f32 v36, v36
    v_exp_f32 v37, v37
    v_exp_f32 v38, v38
    v_exp_f32 v39, v39
    v_exp_f32 v40, v40
    v_exp_f32 v41, v41
    v_exp_f32 v42, v42
    v_exp_f32 v43, v43
    v_exp_f32 v44, v44
    v_exp_f32 v45, v45
    v_exp_f32 v46, v46
    v_exp_f32 v47, v47
    v_cvt_pk_bf16_f32 v80, v32, v33
    v_cvt_pk_bf16_f32 v81, v34, v35
    v_cvt_pk_bf16_f32 v82, v36, v37
    v_cvt_pk_bf16_f32 v83, v38, v39
    v_cvt_pk_bf16_f32 v84, v40, v41
    v_cvt_pk_bf16_f32 v85, v42, v43
    v_cvt_pk_bf16_f32 v86, v44, v45
    v_cvt_pk_bf16_f32 v87, v46, v47
    s_waitcnt lgkmcnt(1)
    v_mfma_f32_32x32x16_bf16 v[64:79], v[100:103], v[80:83], v[64:79]
    v_mfma_f32_32x32x16_bf16 v[64:79], v[104:107], v[84:87], v[64:79]
    s_mov_b64 exec, s[58:59]
    ds_read_b128 v[108:111], v10 offset:25600
    ds_read_b128 v[112:115], v10 offset:26112
    s_mov_b64 exec, -1
    ds_read_b128 v[88:91], v9 offset:27648
    s_waitcnt lgkmcnt(3)
    v_mfma_f32_32x32x16_bf16 v[32:47], v[96:99], v[4:7], v[16:31]
    v_exp_f32 v48, v48
    v_exp_f32 v49, v49
    v_exp_f32 v50, v50
    v_exp_f32 v51, v51
    v_exp_f32 v52, v52
    v_exp_f32 v53, v53
    v_exp_f32 v54, v54
    v_exp_f32 v55, v55
    v_exp_f32 v56, v56
    v_exp_f32 v57, v57
    v_exp_f32 v58, v58
    v_exp_f32 v59, v59
    v_exp_f32 v60, v60
    v_exp_f32 v61, v61
    v_exp_f32 v62, v62
    v_exp_f32 v63, v63
    v_cvt_pk_bf16_f32 v80, v48, v49
    v_cvt_pk_bf16_f32 v81, v50, v51
    v_cvt_pk_bf16_f32 v82, v52, v53
    v_cvt_pk_bf16_f32 v83, v54, v55
    v_cvt_pk_bf16_f32 v84, v56, v57
    v_cvt_pk_bf16_f32 v85, v58, v59
    v_cvt_pk_bf16_f32 v86, v60, v61
    v_cvt_pk_bf16_f32 v87, v62, v63
    s_waitcnt lgkmcnt(1)
    v_mfma_f32_32x32x16_bf16 v[64:79], v[108:111], v[80:83], v[64:79]
    v_mfma_f32_32x32x16_bf16 v[64:79], v[112:115], v[84:87], v[64:79]
    s_mov_b64 exec, s[58:59]
    ds_read_b128 v[100:103], v10 offset:26624
    ds_read_b128 v[104:107], v10 offset:27136
    s_mov_b64 exec, -1
    ds_read_b128 v[92:95], v9 offset:28672
    s_waitcnt lgkmcnt(3)
    v_mfma_f32_32x32x16_bf16 v[48:63], v[88:91], v[4:7], v[16:31]
    v_exp_f32 v32, v32
    v_exp_f32 v33, v33
    v_exp_f32 v34, v34
    v_exp_f32 v35, v35
    v_exp_f32 v36, v36
    v_exp_f32 v37, v37
    v_exp_f32 v38, v38
    v_exp_f32 v39, v39
    v_exp_f32 v40, v40
    v_exp_f32 v41, v41
    v_exp_f32 v42, v42
    v_exp_f32 v43, v43
    v_exp_f32 v44, v44
    v_exp_f32 v45, v45
    v_exp_f32 v46, v46
    v_exp_f32 v47, v47
    v_cvt_pk_bf16_f32 v80, v32, v33
    v_cvt_pk_bf16_f32 v81, v34, v35
    v_cvt_pk_bf16_f32 v82, v36, v37
    v_cvt_pk_bf16_f32 v83, v38, v39
    v_cvt_pk_bf16_f32 v84, v40, v41
    v_cvt_pk_bf16_f32 v85, v42, v43
    v_cvt_pk_bf16_f32 v86, v44, v45
    v_cvt_pk_bf16_f32 v87, v46, v47
    s_waitcnt lgkmcnt(1)
    v_mfma_f32_32x32x16_bf16 v[64:79], v[100:103], v[80:83], v[64:79]
    v_mfma_f32_32x32x16_bf16 v[64:79], v[104:107], v[84:87], v[64:79]
    s_mov_b64 exec, s[58:59]
    ds_read_b128 v[108:111], v10 offset:27648
    ds_read_b128 v[112:115], v10 offset:28160
    s_mov_b64 exec, -1
    ds_read_b128 v[96:99], v9 offset:29696
    s_waitcnt lgkmcnt(3)
    v_mfma_f32_32x32x16_bf16 v[32:47], v[92:95], v[4:7], v[16:31]
    v_exp_f32 v48, v48
    v_exp_f32 v49, v49
    v_exp_f32 v50, v50
    v_exp_f32 v51, v51
    v_exp_f32 v52, v52
    v_exp_f32 v53, v53
    v_exp_f32 v54, v54
    v_exp_f32 v55, v55
    v_exp_f32 v56, v56
    v_exp_f32 v57, v57
    v_exp_f32 v58, v58
    v_exp_f32 v59, v59
    v_exp_f32 v60, v60
    v_exp_f32 v61, v61
    v_exp_f32 v62, v62
    v_exp_f32 v63, v63
    v_cvt_pk_bf16_f32 v80, v48, v49
    v_cvt_pk_bf16_f32 v81, v50, v51
    v_cvt_pk_bf16_f32 v82, v52, v53
    v_cvt_pk_bf16_f32 v83, v54, v55
    v_cvt_pk_bf16_f32 v84, v56, v57
    v_cvt_pk_bf16_f32 v85, v58, v59
    v_cvt_pk_bf16_f32 v86, v60, v61
    v_cvt_pk_bf16_f32 v87, v62, v63
    s_waitcnt lgkmcnt(1)
    v_mfma_f32_32x32x16_bf16 v[64:79], v[108:111], v[80:83], v[64:79]
    v_mfma_f32_32x32x16_bf16 v[64:79], v[112:115], v[84:87], v[64:79]
    s_mov_b64 exec, s[58:59]
    ds_read_b128 v[100:103], v10 offset:28672
    ds_read_b128 v[104:107], v10 offset:29184
    s_mov_b64 exec, -1
    ds_read_b128 v[88:91], v9 offset:30720
    s_waitcnt lgkmcnt(3)
    v_mfma_f32_32x32x16_bf16 v[48:63], v[96:99], v[4:7], v[16:31]
    v_exp_f32 v32, v32
    v_exp_f32 v33, v33
    v_exp_f32 v34, v34
    v_exp_f32 v35, v35
    v_exp_f32 v36, v36
    v_exp_f32 v37, v37
    v_exp_f32 v38, v38
    v_exp_f32 v39, v39
    v_exp_f32 v40, v40
    v_exp_f32 v41, v41
    v_exp_f32 v42, v42
    v_exp_f32 v43, v43
    v_exp_f32 v44, v44
    v_exp_f32 v45, v45
    v_exp_f32 v46, v46
    v_exp_f32 v47, v47
    v_cvt_pk_bf16_f32 v80, v32, v33
    v_cvt_pk_bf16_f32 v81, v34, v35
    v_cvt_pk_bf16_f32 v82, v36, v37
    v_cvt_pk_bf16_f32 v83, v38, v39
    v_cvt_pk_bf16_f32 v84, v40, v41
    v_cvt_pk_bf16_f32 v85, v42, v43
    v_cvt_pk_bf16_f32 v86, v44, v45
    v_cvt_pk_bf16_f32 v87, v46, v47
    s_waitcnt lgkmcnt(1)
    v_mfma_f32_32x32x16_bf16 v[64:79], v[100:103], v[80:83], v[64:79]
    v_mfma_f32_32x32x16_bf16 v[64:79], v[104:107], v[84:87], v[64:79]
    s_mov_b64 exec, s[58:59]
    ds_read_b128 v[108:111], v10 offset:29696
    ds_read_b128 v[112:115], v10 offset:30208
    s_mov_b64 exec, -1
    ds_read_b128 v[92:95], v9 offset:31744
    s_waitcnt lgkmcnt(3)
    v_mfma_f32_32x32x16_bf16 v[32:47], v[88:91], v[4:7], v[16:31]
    v_exp_f32 v48, v48
    v_exp_f32 v49, v49
    v_exp_f32 v50, v50
    v_exp_f32 v51, v51
    v_exp_f32 v52, v52
    v_exp_f32 v53, v53
    v_exp_f32 v54, v54
    v_exp_f32 v55, v55
    v_exp_f32 v56, v56
    v_exp_f32 v57, v57
    v_exp_f32 v58, v58
    v_exp_f32 v59, v59
    v_exp_f32 v60, v60
    v_exp_f32 v61, v61
    v_exp_f32 v62, v62
    v_exp_f32 v63, v63
    v_cvt_pk_bf16_f32 v80, v48, v49
    v_cvt_pk_bf16_f32 v81, v50, v51
    v_cvt_pk_bf16_f32 v82, v52, v53
    v_cvt_pk_bf16_f32 v83, v54, v55
    v_cvt_pk_bf16_f32 v84, v56, v57
    v_cvt_pk_bf16_f32 v85, v58, v59
    v_cvt_pk_bf16_f32 v86, v60, v61
    v_cvt_pk_bf16_f32 v87, v62, v63
    s_waitcnt lgkmcnt(1)
    v_mfma_f32_32x32x16_bf16 v[64:79], v[108:111], v[80:83], v[64:79]
    v_mfma_f32_32x32x16_bf16 v[64:79], v[112:115], v[84:87], v[64:79]
    s_mov_b64 exec, s[58:59]
    ds_read_b128 v[100:103], v10 offset:30720
    ds_read_b128 v[104:107], v10 offset:31232
    s_mov_b64 exec, -1
    s_waitcnt lgkmcnt(2)
    v_mfma_f32_32x32x16_bf16 v[48:63], v[92:95], v[4:7], v[16:31]
    v_exp_f32 v32, v32
    v_exp_f32 v33, v33
    v_exp_f32 v34, v34
    v_exp_f32 v35, v35
    v_exp_f32 v36, v36
    v_exp_f32 v37, v37
    v_exp_f32 v38, v38
    v_exp_f32 v39, v39
    v_exp_f32 v40, v40
    v_exp_f32 v41, v41
    v_exp_f32 v42, v42
    v_exp_f32 v43, v43
    v_exp_f32 v44, v44
    v_exp_f32 v45, v45
    v_exp_f32 v46, v46
    v_exp_f32 v47, v47
    v_cvt_pk_bf16_f32 v80, v32, v33
    v_cvt_pk_bf16_f32 v81, v34, v35
    v_cvt_pk_bf16_f32 v82, v36, v37
    v_cvt_pk_bf16_f32 v83, v38, v39
    v_cvt_pk_bf16_f32 v84, v40, v41
    v_cvt_pk_bf16_f32 v85, v42, v43
    v_cvt_pk_bf16_f32 v86, v44, v45
    v_cvt_pk_bf16_f32 v87, v46, v47
    s_waitcnt lgkmcnt(0)
    v_mfma_f32_32x32x16_bf16 v[64:79], v[100:103], v[80:83], v[64:79]
    v_mfma_f32_32x32x16_bf16 v[64:79], v[104:107], v[84:87], v[64:79]
    s_mov_b64 exec, s[58:59]
    ds_read_b128 v[108:111], v10 offset:31744
    ds_read_b128 v[112:115], v10 offset:32256
    s_mov_b64 exec, -1
    v_exp_f32 v48, v48
    v_exp_f32 v49, v49
    v_exp_f32 v50, v50
    v_exp_f32 v51, v51
    v_exp_f32 v52, v52
    v_exp_f32 v53, v53
    v_exp_f32 v54, v54
    v_exp_f32 v55, v55
    v_exp_f32 v56, v56
    v_exp_f32 v57, v57
    v_exp_f32 v58, v58
    v_exp_f32 v59, v59
    v_exp_f32 v60, v60
    v_exp_f32 v61, v61
    v_exp_f32 v62, v62
    v_exp_f32 v63, v63
    v_cvt_pk_bf16_f32 v80, v48, v49
    v_cvt_pk_bf16_f32 v81, v50, v51
    v_cvt_pk_bf16_f32 v82, v52, v53
    v_cvt_pk_bf16_f32 v83, v54, v55
    v_cvt_pk_bf16_f32 v84, v56, v57
    v_cvt_pk_bf16_f32 v85, v58, v59
    v_cvt_pk_bf16_f32 v86, v60, v61
    v_cvt_pk_bf16_f32 v87, v62, v63
    s_waitcnt lgkmcnt(0)
    v_mfma_f32_32x32x16_bf16 v[64:79], v[108:111], v[80:83], v[64:79]
    v_mfma_f32_32x32x16_bf16 v[64:79], v[112:115], v[84:87], v[64:79]
    s_nop 15
attn_comb10:
    s_mul_i32 s60, s48, 2560
    s_add_u32 s60, s60, 0x20000
    v_lshlrev_b32 v12, 2, v1
    v_add_u32 v12, s60, v12
    s_cmp_eq_u32 s49, 0
    s_cbranch_scc1 attn_w111
    ds_write_b32 v12, v64 offset:0
    ds_write_b32 v12, v65 offset:256
    ds_write_b32 v12, v66 offset:512
    ds_write_b32 v12, v67 offset:768
    ds_write_b32 v12, v68 offset:1024
    ds_write_b32 v12, v69 offset:1280
    ds_write_b32 v12, v70 offset:1536
    ds_write_b32 v12, v71 offset:1792
    ds_write_b32 v12, v72 offset:2048
    ds_write_b32 v12, v11 offset:2304
    s_waitcnt lgkmcnt(0)
    s_barrier
    s_branch attn_end1
attn_w111:
    s_barrier
    ds_read_b32 v32, v12 offset:0
    ds_read_b32 v33, v12 offset:256
    ds_read_b32 v34, v12 offset:512
    ds_read_b32 v35, v12 offset:768
    ds_read_b32 v36, v12 offset:1024
    ds_read_b32 v37, v12 offset:1280
    ds_read_b32 v38, v12 offset:1536
    ds_read_b32 v39, v12 offset:1792
    ds_read_b32 v40, v12 offset:2048
    ds_read_b32 v41, v12 offset:2304
    s_waitcnt lgkmcnt(0)
    v_max_f32 v13, v11, v41
    v_sub_f32 v14, v11, v13
    v_sub_f32 v15, v41, v13
    v_exp_f32 v14, v14
    v_exp_f32 v15, v15
    s_nop 1
    v_mul_f32 v64, v14, v64
    v_mul_f32 v65, v14, v65
    v_mul_f32 v66, v14, v66
    v_mul_f32 v67, v14, v67
    v_mul_f32 v68, v14, v68
    v_mul_f32 v69, v14, v69
    v_mul_f32 v70, v14, v70
    v_mul_f32 v71, v14, v71
    v_mul_f32 v72, v14, v72
    v_fma_f32 v64, v15, v32, v64
    v_fma_f32 v65, v15, v33, v65
    v_fma_f32 v66, v15, v34, v66
    v_fma_f32 v67, v15, v35, v67
    v_fma_f32 v68, v15, v36, v68
    v_fma_f32 v69, v15, v37, v69
    v_fma_f32 v70, v15, v38, v70
    v_fma_f32 v71, v15, v39, v71
    v_fma_f32 v72, v15, v40, v72
    v_rcp_f32 v13, v72
    s_nop 1
    v_mul_f32 v64, v13, v64
    v_mul_f32 v65, v13, v65
    v_mul_f32 v66, v13, v66
    v_mul_f32 v67, v13, v67
    v_mul_f32 v68, v13, v68
    v_mul_f32 v69, v13, v69
    v_mul_f32 v70, v13, v70
    v_mul_f32 v71, v13, v71
    v_cvt_pk_bf16_f32 v80, v64, v65
    v_cvt_pk_bf16_f32 v81, v66, v67
    v_cvt_pk_bf16_f32 v82, v68, v69
    v_cvt_pk_bf16_f32 v83, v70, v71
    v_and_b32 v2, 31, v1
    v_lshlrev_b32 v2, 5, v2
    v_lshl_add_u32 v2, v3, 3, v2
    s_lshl_b32 s51, s50, 10
    s_add_u32 s51, s51, 0x300000
    buffer_store_dwordx2 v[80:81], v2, s[20:23], s51 offen
    buffer_store_dwordx2 v[82:83], v2, s[20:23], s51 offen offset:16
attn_end1:
    s_endpgm
.globl ffn_kernel
.p2align 8
.type ffn_kernel,@function
ffn_kernel:
    s_cmp_ge_u32 s2, 256
    s_cbranch_scc1 ffn_end1
    s_load_dwordx2 s[24:25], s[0:1], 32
    s_load_dwordx2 s[26:27], s[0:1], 0
    s_load_dwordx2 s[28:29], s[0:1], 72
    s_load_dwordx2 s[32:33], s[0:1], 88
    s_getreg_b32 s40, hwreg(HW_REG_XCC_ID)
    v_and_b32 v1, 63, v0
    v_lshrrev_b32 v2, 6, v0
    s_nop 1
    v_readfirstlane_b32 s3, v2
    s_and_b32 s48, s2, 7
    s_lshl_b32 s48, s48, 2
    s_bfe_u32 s49, s2, 0x20003
    s_add_u32 s48, s48, s49
    s_lshr_b32 s49, s2, 5
    s_lshr_b32 s38, s48, 1
    s_and_b32 s39, s48, 1
    s_lshl_b32 s37, s49, 1
    s_add_u32 s39, s39, s37
    s_lshl_b32 s42, s38, 13
    s_add_u32 s42, s42, 0x280000
    s_and_b32 s40, s40, 15
    s_or_b32 s40, s40, 0x80
    s_mul_i32 s43, s40, 0x01010101
    s_mul_i32 s34, s39, 196608
    s_add_u32 s34, s34, 0x1000000
    s_lshl_b32 s52, s3, 10
    v_lshlrev_b32 v60, 4, v1
    v_add_u32 v60, s52, v60
    s_lshl_b32 s36, s3, 12
    s_mul_i32 s35, s49, 176128
    s_mul_i32 s55, s3, 22
    s_lshr_b32 s54, s3, 1
    s_and_b32 s54, s54, s3
    s_sub_u32 s55, s55, s54
    s_lshl_b32 s54, s55, 11
    s_add_u32 s35, s35, s54
    s_add_u32 s35, s35, 0x1400000
    s_waitcnt lgkmcnt(0)
    s_mov_b32 s8, s24
    s_and_b32 s9, s25, 0xffff
    s_mov_b32 s10, 0x80000
    s_mov_b32 s11, 0x00020000
    s_mov_b32 s20, s32
    s_and_b32 s21, s33, 0xffff
    s_mov_b32 s22, 0x10000000
    s_mov_b32 s23, 0x00020000
    s_mov_b32 s12, s26
    s_and_b32 s13, s27, 0xffff
    s_mov_b32 s14, 0x200000
    s_mov_b32 s15, 0x00020000
    s_mov_b32 s16, s28
    s_and_b32 s17, s29, 0xffff
    s_mov_b32 s18, 0x200000
    s_mov_b32 s19, 0x00020000
    v_lshrrev_b32 v3, 4, v1
    s_lshl_b32 s50, s3, 2
    v_add_u32 v3, s50, v3
    v_and_b32 v4, 15, v1
    v_xor_b32 v4, v4, v3
    v_lshlrev_b32 v4, 4, v4
    s_lshl_b32 s51, s48, 6
    v_add_u32 v3, s51, v3
    v_mul_u32_u24 v3, 1024, v3
    v_add_u32 v4, v3, v4
    v_lshrrev_b32 v3, 3, v1
    s_lshl_b32 s50, s3, 3
    v_add_u32 v3, s50, v3
    v_and_b32 v5, 7, v1
    v_bfe_u32 v6, v1, 4, 1
    v_lshlrev_b32 v6, 2, v6
    v_xor_b32 v5, v5, v6
    v_lshlrev_b32 v5, 4, v5
    v_lshl_add_u32 v5, v3, 10, v5
    s_lshl_b32 s50, s49, 7
    v_add_u32 v5, s50, v5
    s_add_u32 m0, s52, 0
    s_mov_b32 s54, 3145728
    buffer_load_dwordx4 v4, s[20:23], s54 offen lds
    s_add_u32 m0, s52, 4096
    s_mov_b32 s54, 3162112
    buffer_load_dwordx4 v4, s[20:23], s54 offen lds
    s_add_u32 m0, s52, 8192
    s_mov_b32 s54, 3178496
    buffer_load_dwordx4 v4, s[20:23], s54 offen lds
    s_add_u32 m0, s52, 12288
    s_mov_b32 s54, 3194880
    buffer_load_dwordx4 v4, s[20:23], s54 offen lds
    s_add_u32 m0, s52, 16384
    s_mov_b32 s54, 0
    buffer_load_dwordx4 v5, s[8:11], s54 offen lds
    s_add_u32 m0, s52, 20480
    s_mov_b32 s54, 32768
    buffer_load_dwordx4 v5, s[8:11], s54 offen lds
    s_add_u32 m0, s52, 24576
    s_mov_b32 s54, 65536
    buffer_load_dwordx4 v5, s[8:11], s54 offen lds
    s_add_u32 m0, s52, 28672
    s_mov_b32 s54, 98304
    buffer_load_dwordx4 v5, s[8:11], s54 offen lds
    s_add_u32 m0, s52, 32768
    s_mov_b32 s54, 3145984
    buffer_load_dwordx4 v4, s[20:23], s54 offen lds
    s_add_u32 m0, s52, 36864
    s_mov_b32 s54, 3162368
    buffer_load_dwordx4 v4, s[20:23], s54 offen lds
    s_add_u32 m0, s52, 40960
    s_mov_b32 s54, 3178752
    buffer_load_dwordx4 v4, s[20:23], s54 offen lds
    s_add_u32 m0, s52, 45056
    s_mov_b32 s54, 3195136
    buffer_load_dwordx4 v4, s[20:23], s54 offen lds
    s_add_u32 m0, s52, 49152
    s_mov_b32 s54, 131072
    buffer_load_dwordx4 v5, s[8:11], s54 offen lds
    s_add_u32 m0, s52, 53248
    s_mov_b32 s54, 163840
    buffer_load_dwordx4 v5, s[8:11], s54 offen lds
    s_add_u32 m0, s52, 57344
    s_mov_b32 s54, 196608
    buffer_load_dwordx4 v5, s[8:11], s54 offen lds
    s_add_u32 m0, s52, 61440
    s_mov_b32 s54, 229376
    buffer_load_dwordx4 v5, s[8:11], s54 offen lds
    s_add_u32 m0, s52, 65536
    s_mov_b32 s54, 3146240
    buffer_load_dwordx4 v4, s[20:23], s54 offen lds
    s_add_u32 m0, s52, 69632
    s_mov_b32 s54, 3162624
    buffer_load_dwordx4 v4, s[20:23], s54 offen lds
    s_add_u32 m0, s52, 73728
    s_mov_b32 s54, 3179008
    buffer_load_dwordx4 v4, s[20:23], s54 offen lds
    s_add_u32 m0, s52, 77824
    s_mov_b32 s54, 3195392
    buffer_load_dwordx4 v4, s[20:23], s54 offen lds
    s_add_u32 m0, s52, 81920
    s_mov_b32 s54, 262144
    buffer_load_dwordx4 v5, s[8:11], s54 offen lds
    s_add_u32 m0, s52, 86016
    s_mov_b32 s54, 294912
    buffer_load_dwordx4 v5, s[8:11], s54 offen lds
    s_add_u32 m0, s52, 90112
    s_mov_b32 s54, 327680
    buffer_load_dwordx4 v5, s[8:11], s54 offen lds
    s_add_u32 m0, s52, 94208
    s_mov_b32 s54, 360448
    buffer_load_dwordx4 v5, s[8:11], s54 offen lds
    v_mov_b32 v56, s40
    s_cmp_eq_u32 s3, 0
    s_cselect_b64 exec, 1, 0
    s_add_u32 s44, s42, s39
    buffer_store_byte v56, off, s[20:23], s44 sc1
    s_mov_b64 exec, -1
    s_and_b32 s56, s3, 1
    s_lshr_b32 s57, s3, 1
    s_lshl_b32 s58, s56, 5
    s_add_u32 s58, s58, s51
    v_and_b32 v13, 31, v1
    v_add_u32 v13, s58, v13
    v_lshrrev_b32 v8, 5, v1
    v_lshlrev_b32 v12, 3, v8
    v_lshl_add_u32 v12, v13, 10, v12
    s_lshl_b32 s59, s49, 7
    s_lshl_b32 s60, s57, 6
    s_add_u32 s59, s59, s60
    buffer_load_dwordx2 v[48:49], v12, s[12:15], s59 offen offset:0
    buffer_load_dwordx2 v[50:51], v12, s[12:15], s59 offen offset:16
    buffer_load_dwordx2 v[52:53], v12, s[12:15], s59 offen offset:32
    buffer_load_dwordx2 v[54:55], v12, s[12:15], s59 offen offset:48
    v_and_b32 v7, 31, v1
    s_lshl_b32 s58, s56, 5
    v_add_u32 v7, s58, v7
    v_and_b32 v9, 15, v7
    v_xor_b32 v9, v9, v8
    v_lshlrev_b32 v9, 4, v9
    v_lshl_add_u32 v9, v7, 8, v9
    v_xor_b32 v16, 0, v9
    v_xor_b32 v17, 32, v9
    v_xor_b32 v18, 64, v9
    v_xor_b32 v19, 96, v9
    v_xor_b32 v20, 128, v9
    v_xor_b32 v21, 160, v9
    v_xor_b32 v22, 192, v9
    v_xor_b32 v23, 224, v9
    v_lshrrev_b32 v11, 5, v1
    v_lshlrev_b32 v11, 3, v11
    v_bfe_u32 v10, v1, 2, 2
    v_add_u32 v11, v11, v10
    v_bfe_u32 v10, v1, 4, 1
    v_lshlrev_b32 v10, 5, v10
    v_and_b32 v12, 3, v1
    v_lshl_add_u32 v10, v12, 3, v10
    s_lshl_b32 s58, s57, 6
    v_add_u32 v10, s58, v10
    v_bfe_u32 v12, v1, 3, 1
    v_lshlrev_b32 v12, 6, v12
    v_xor_b32 v10, v10, v12
    v_lshl_add_u32 v10, v11, 7, v10
    v_add_u32 v10, 0x4000, v10
    s_waitcnt vmcnt(21)
    s_barrier
    s_add_u32 m0, s52, 98304
    s_mov_b32 s54, 3146496
    buffer_load_dwordx4 v4, s[20:23], s54 offen lds
    s_add_u32 m0, s52, 102400
    s_mov_b32 s54, 3162880
    buffer_load_dwordx4 v4, s[20:23], s54 offen lds
    s_add_u32 m0, s52, 106496
    s_mov_b32 s54, 3179264
    buffer_load_dwordx4 v4, s[20:23], s54 offen lds
    s_add_u32 m0, s52, 110592
    s_mov_b32 s54, 3195648
    buffer_load_dwordx4 v4, s[20:23], s54 offen lds
    s_add_u32 m0, s52, 114688
    s_mov_b32 s54, 393216
    buffer_load_dwordx4 v5, s[8:11], s54 offen lds
    s_add_u32 m0, s52, 118784
    s_mov_b32 s54, 425984
    buffer_load_dwordx4 v5, s[8:11], s54 offen lds
    s_add_u32 m0, s52, 122880
    s_mov_b32 s54, 458752
    buffer_load_dwordx4 v5, s[8:11], s54 offen lds
    s_add_u32 m0, s52, 126976
    s_mov_b32 s54, 491520
    buffer_load_dwordx4 v5, s[8:11], s54 offen lds
    v_add_u32 v24, 0, v16
    v_add_u32 v25, 0, v17
    v_add_u32 v26, 0, v18
    v_add_u32 v27, 0, v19
    v_add_u32 v28, 0, v20
    v_add_u32 v29, 0, v21
    v_add_u32 v30, 0, v22
    v_add_u32 v31, 0, v23
    v_add_u32 v14, 0, v10
    ds_read_b128 v[64:67], v24
    ds_read_b64_tr_b16 v[96:97], v14 offset:0
    ds_read_b64_tr_b16 v[98:99], v14 offset:512
    ds_read_b128 v[68:71], v25
    ds_read_b64_tr_b16 v[100:101], v14 offset:2048
    ds_read_b64_tr_b16 v[102:103], v14 offset:2560
    ds_read_b128 v[72:75], v26
    ds_read_b64_tr_b16 v[104:105], v14 offset:4096
    ds_read_b64_tr_b16 v[106:107], v14 offset:4608
    ds_read_b128 v[76:79], v27
    ds_read_b64_tr_b16 v[108:109], v14 offset:6144
    ds_read_b64_tr_b16 v[110:111], v14 offset:6656
    ds_read_b128 v[80:83], v28
    ds_read_b64_tr_b16 v[112:113], v14 offset:8192
    ds_read_b64_tr_b16 v[114:115], v14 offset:8704
    ds_read_b128 v[84:87], v29
    ds_read_b64_tr_b16 v[116:117], v14 offset:10240
    ds_read_b64_tr_b16 v[118:119], v14 offset:10752
    ds_read_b128 v[88:91], v30
    ds_read_b64_tr_b16 v[120:121], v14 offset:12288
    ds_read_b64_tr_b16 v[122:123], v14 offset:12800
    ds_read_b128 v[92:95], v31
    ds_read_b64_tr_b16 v[124:125], v14 offset:14336
    ds_read_b64_tr_b16 v[126:127], v14 offset:14848
    s_waitcnt lgkmcnt(15)
    v_mfma_f32_32x32x16_bf16 v[32:47], v[96:99], v[64:67], 0
    s_waitcnt lgkmcnt(15)
    v_mfma_f32_32x32x16_bf16 v[32:47], v[100:103], v[68:71], v[32:47]
    s_waitcnt lgkmcnt(15)
    v_mfma_f32_32x32x16_bf16 v[32:47], v[104:107], v[72:75], v[32:47]
    s_waitcnt lgkmcnt(12)
    v_mfma_f32_32x32x16_bf16 v[32:47], v[108:111], v[76:79], v[32:47]
    s_waitcnt lgkmcnt(9)
    v_mfma_f32_32x32x16_bf16 v[32:47], v[112:115], v[80:83], v[32:47]
    s_waitcnt lgkmcnt(6)
    v_mfma_f32_32x32x16_bf16 v[32:47], v[116:119], v[84:87], v[32:47]
    s_waitcnt lgkmcnt(3)
    v_mfma_f32_32x32x16_bf16 v[32:47], v[120:123], v[88:91], v[32:47]
    s_waitcnt lgkmcnt(0)
    v_mfma_f32_32x32x16_bf16 v[32:47], v[124:127], v[92:95], v[32:47]
    s_waitcnt vmcnt(21)
    s_barrier
    v_add_u32 v24, 32768, v16
    v_add_u32 v25, 32768, v17
    v_add_u32 v26, 32768, v18
    v_add_u32 v27, 32768, v19
    v_add_u32 v28, 32768, v20
    v_add_u32 v29, 32768, v21
    v_add_u32 v30, 32768, v22
    v_add_u32 v31, 32768, v23
    v_add_u32 v14, 32768, v10
    ds_read_b128 v[64:67], v24
    ds_read_b64_tr_b16 v[96:97], v14 offset:0
    ds_read_b64_tr_b16 v[98:99], v14 offset:512
    ds_read_b128 v[68:71], v25
    ds_read_b64_tr_b16 v[100:101], v14 offset:2048
    ds_read_b64_tr_b16 v[102:103], v14 offset:2560
    ds_read_b128 v[72:75], v26
    ds_read_b64_tr_b16 v[104:105], v14 offset:4096
    ds_read_b64_tr_b16 v[106:107], v14 offset:4608
    ds_read_b128 v[76:79], v27
    ds_read_b64_tr_b16 v[108:109], v14 offset:6144
    ds_read_b64_tr_b16 v[110:111], v14 offset:6656
    ds_read_b128 v[80:83], v28
    ds_read_b64_tr_b16 v[112:113], v14 offset:8192
    ds_read_b64_tr_b16 v[114:115], v14 offset:8704
    ds_read_b128 v[84:87], v29
    ds_read_b64_tr_b16 v[116:117], v14 offset:10240
    ds_read_b64_tr_b16 v[118:119], v14 offset:10752
    ds_read_b128 v[88:91], v30
    ds_read_b64_tr_b16 v[120:121], v14 offset:12288
    ds_read_b64_tr_b16 v[122:123], v14 offset:12800
    ds_read_b128 v[92:95], v31
    ds_read_b64_tr_b16 v[124:125], v14 offset:14336
    ds_read_b64_tr_b16 v[126:127], v14 offset:14848
    s_waitcnt lgkmcnt(15)
    v_mfma_f32_32x32x16_bf16 v[32:47], v[96:99], v[64:67], v[32:47]
    s_waitcnt lgkmcnt(15)
    v_mfma_f32_32x32x16_bf16 v[32:47], v[100:103], v[68:71], v[32:47]
    s_waitcnt lgkmcnt(15)
    v_mfma_f32_32x32x16_bf16 v[32:47], v[104:107], v[72:75], v[32:47]
    s_waitcnt lgkmcnt(12)
    v_mfma_f32_32x32x16_bf16 v[32:47], v[108:111], v[76:79], v[32:47]
    s_waitcnt lgkmcnt(9)
    v_mfma_f32_32x32x16_bf16 v[32:47], v[112:115], v[80:83], v[32:47]
    s_waitcnt lgkmcnt(6)
    v_mfma_f32_32x32x16_bf16 v[32:47], v[116:119], v[84:87], v[32:47]
    s_waitcnt lgkmcnt(3)
    v_mfma_f32_32x32x16_bf16 v[32:47], v[120:123], v[88:91], v[32:47]
    s_waitcnt lgkmcnt(0)
    v_mfma_f32_32x32x16_bf16 v[32:47], v[124:127], v[92:95], v[32:47]
    s_waitcnt vmcnt(13)
    s_barrier
    v_add_u32 v24, 65536, v16
    v_add_u32 v25, 65536, v17
    v_add_u32 v26, 65536, v18
    v_add_u32 v27, 65536, v19
    v_add_u32 v28, 65536, v20
    v_add_u32 v29, 65536, v21
    v_add_u32 v30, 65536, v22
    v_add_u32 v31, 65536, v23
    v_add_u32 v14, 65536, v10
    ds_read_b128 v[64:67], v24
    ds_read_b64_tr_b16 v[96:97], v14 offset:0
    ds_read_b64_tr_b16 v[98:99], v14 offset:512
    ds_read_b128 v[68:71], v25
    ds_read_b64_tr_b16 v[100:101], v14 offset:2048
    ds_read_b64_tr_b16 v[102:103], v14 offset:2560
    ds_read_b128 v[72:75], v26
    ds_read_b64_tr_b16 v[104:105], v14 offset:4096
    ds_read_b64_tr_b16 v[106:107], v14 offset:4608
    ds_read_b128 v[76:79], v27
    ds_read_b64_tr_b16 v[108:109], v14 offset:6144
    ds_read_b64_tr_b16 v[110:111], v14 offset:6656
    ds_read_b128 v[80:83], v28
    ds_read_b64_tr_b16 v[112:113], v14 offset:8192
    ds_read_b64_tr_b16 v[114:115], v14 offset:8704
    ds_read_b128 v[84:87], v29
    ds_read_b64_tr_b16 v[116:117], v14 offset:10240
    ds_read_b64_tr_b16 v[118:119], v14 offset:10752
    ds_read_b128 v[88:91], v30
    ds_read_b64_tr_b16 v[120:121], v14 offset:12288
    ds_read_b64_tr_b16 v[122:123], v14 offset:12800
    ds_read_b128 v[92:95], v31
    ds_read_b64_tr_b16 v[124:125], v14 offset:14336
    ds_read_b64_tr_b16 v[126:127], v14 offset:14848
    s_waitcnt lgkmcnt(15)
    v_mfma_f32_32x32x16_bf16 v[32:47], v[96:99], v[64:67], v[32:47]
    s_waitcnt lgkmcnt(15)
    v_mfma_f32_32x32x16_bf16 v[32:47], v[100:103], v[68:71], v[32:47]
    s_waitcnt lgkmcnt(15)
    v_mfma_f32_32x32x16_bf16 v[32:47], v[104:107], v[72:75], v[32:47]
    s_waitcnt lgkmcnt(12)
    v_mfma_f32_32x32x16_bf16 v[32:47], v[108:111], v[76:79], v[32:47]
    s_waitcnt lgkmcnt(9)
    v_mfma_f32_32x32x16_bf16 v[32:47], v[112:115], v[80:83], v[32:47]
    s_waitcnt lgkmcnt(6)
    v_mfma_f32_32x32x16_bf16 v[32:47], v[116:119], v[84:87], v[32:47]
    s_waitcnt lgkmcnt(3)
    v_mfma_f32_32x32x16_bf16 v[32:47], v[120:123], v[88:91], v[32:47]
    s_waitcnt lgkmcnt(0)
    v_mfma_f32_32x32x16_bf16 v[32:47], v[124:127], v[92:95], v[32:47]
    s_waitcnt vmcnt(0)
    s_barrier
    buffer_load_dwordx4 v[248:251], off, s[20:23], s42 sc1
    v_add_u32 v24, 98304, v16
    v_add_u32 v25, 98304, v17
    v_add_u32 v26, 98304, v18
    v_add_u32 v27, 98304, v19
    v_add_u32 v28, 98304, v20
    v_add_u32 v29, 98304, v21
    v_add_u32 v30, 98304, v22
    v_add_u32 v31, 98304, v23
    v_add_u32 v14, 98304, v10
    ds_read_b128 v[64:67], v24
    ds_read_b64_tr_b16 v[96:97], v14 offset:0
    ds_read_b64_tr_b16 v[98:99], v14 offset:512
    ds_read_b128 v[68:71], v25
    ds_read_b64_tr_b16 v[100:101], v14 offset:2048
    ds_read_b64_tr_b16 v[102:103], v14 offset:2560
    ds_read_b128 v[72:75], v26
    ds_read_b64_tr_b16 v[104:105], v14 offset:4096
    ds_read_b64_tr_b16 v[106:107], v14 offset:4608
    ds_read_b128 v[76:79], v27
    ds_read_b64_tr_b16 v[108:109], v14 offset:6144
    ds_read_b64_tr_b16 v[110:111], v14 offset:6656
    ds_read_b128 v[80:83], v28
    ds_read_b64_tr_b16 v[112:113], v14 offset:8192
    ds_read_b64_tr_b16 v[114:115], v14 offset:8704
    ds_read_b128 v[84:87], v29
    ds_read_b64_tr_b16 v[116:117], v14 offset:10240
    ds_read_b64_tr_b16 v[118:119], v14 offset:10752
    ds_read_b128 v[88:91], v30
    ds_read_b64_tr_b16 v[120:121], v14 offset:12288
    ds_read_b64_tr_b16 v[122:123], v14 offset:12800
    ds_read_b128 v[92:95], v31
    ds_read_b64_tr_b16 v[124:125], v14 offset:14336
    ds_read_b64_tr_b16 v[126:127], v14 offset:14848
    s_waitcnt lgkmcnt(15)
    v_mfma_f32_32x32x16_bf16 v[32:47], v[96:99], v[64:67], v[32:47]
    s_waitcnt lgkmcnt(15)
    v_mfma_f32_32x32x16_bf16 v[32:47], v[100:103], v[68:71], v[32:47]
    s_waitcnt lgkmcnt(15)
    v_mfma_f32_32x32x16_bf16 v[32:47], v[104:107], v[72:75], v[32:47]
    s_waitcnt lgkmcnt(12)
    v_mfma_f32_32x32x16_bf16 v[32:47], v[108:111], v[76:79], v[32:47]
    s_waitcnt lgkmcnt(9)
    v_mfma_f32_32x32x16_bf16 v[32:47], v[112:115], v[80:83], v[32:47]
    s_waitcnt lgkmcnt(6)
    v_mfma_f32_32x32x16_bf16 v[32:47], v[116:119], v[84:87], v[32:47]
    s_waitcnt lgkmcnt(3)
    v_mfma_f32_32x32x16_bf16 v[32:47], v[120:123], v[88:91], v[32:47]
    s_waitcnt lgkmcnt(0)
    v_mfma_f32_32x32x16_bf16 v[32:47], v[124:127], v[92:95], v[32:47]
    s_nop 15
    v_lshlrev_b32 v64, 16, v48
    v_and_b32 v65, 0xffff0000, v48
    v_add_f32 v32, v32, v64
    v_add_f32 v33, v33, v65
    v_lshlrev_b32 v64, 16, v49
    v_and_b32 v65, 0xffff0000, v49
    v_add_f32 v34, v34, v64
    v_add_f32 v35, v35, v65
    v_lshlrev_b32 v64, 16, v50
    v_and_b32 v65, 0xffff0000, v50
    v_add_f32 v36, v36, v64
    v_add_f32 v37, v37, v65
    v_lshlrev_b32 v64, 16, v51
    v_and_b32 v65, 0xffff0000, v51
    v_add_f32 v38, v38, v64
    v_add_f32 v39, v39, v65
    v_lshlrev_b32 v64, 16, v52
    v_and_b32 v65, 0xffff0000, v52
    v_add_f32 v40, v40, v64
    v_add_f32 v41, v41, v65
    v_lshlrev_b32 v64, 16, v53
    v_and_b32 v65, 0xffff0000, v53
    v_add_f32 v42, v42, v64
    v_add_f32 v43, v43, v65
    v_lshlrev_b32 v64, 16, v54
    v_and_b32 v65, 0xffff0000, v54
    v_add_f32 v44, v44, v64
    v_add_f32 v45, v45, v65
    v_lshlrev_b32 v64, 16, v55
    v_and_b32 v65, 0xffff0000, v55
    v_add_f32 v46, v46, v64
    v_add_f32 v47, v47, v65
    v_cvt_pk_bf16_f32 v48, v32, v33
    v_cvt_pk_bf16_f32 v49, v34, v35
    v_cvt_pk_bf16_f32 v50, v36, v37
    v_cvt_pk_bf16_f32 v51, v38, v39
    v_cvt_pk_bf16_f32 v52, v40, v41
    v_cvt_pk_bf16_f32 v53, v42, v43
    v_cvt_pk_bf16_f32 v54, v44, v45
    v_cvt_pk_bf16_f32 v55, v46, v47
    v_lshlrev_b32 v103, 4, v1
    s_lshl_b32 s60, s48, 1
    s_add_u32 s60, s60, s56
    s_lshl_b32 s60, s60, 5
    s_lshl_b32 s61, s49, 2
    s_add_u32 s60, s60, s61
    s_lshl_b32 s61, s57, 1
    s_add_u32 s60, s60, s61
    s_lshl_b32 s60, s60, 10
    s_add_u32 s60, s60, 0x1800000
    v_mov_b32 v96, 0x3f803f80
    v_mov_b32 v98, 0
    v_mov_b32 v99, 0
    v_mov_b32 v100, 0
    v_mov_b32 v101, 0
    v_dot2c_f32_bf16 v98, v48, v96
    v_dot2c_f32_bf16 v100, v48, v48
    v_dot2c_f32_bf16 v99, v49, v96
    v_dot2c_f32_bf16 v101, v49, v49
    v_dot2c_f32_bf16 v98, v50, v96
    v_dot2c_f32_bf16 v100, v50, v50
    v_dot2c_f32_bf16 v99, v51, v96
    v_dot2c_f32_bf16 v101, v51, v51
    v_dot2c_f32_bf16 v98, v52, v96
    v_dot2c_f32_bf16 v100, v52, v52
    v_dot2c_f32_bf16 v99, v53, v96
    v_dot2c_f32_bf16 v101, v53, v53
    v_dot2c_f32_bf16 v98, v54, v96
    v_dot2c_f32_bf16 v100, v54, v54
    v_dot2c_f32_bf16 v99, v55, v96
    v_dot2c_f32_bf16 v101, v55, v55
    s_nop 1
    v_permlane32_swap_b32 v48, v50
    v_permlane32_swap_b32 v49, v51
    v_permlane32_swap_b32 v52, v54
    v_permlane32_swap_b32 v53, v55
    s_nop 1
    buffer_store_dwordx4 v[48:51], v103, s[20:23], s60 offen offset:0 sc1
    buffer_store_dwordx4 v[52:55], v103, s[20:23], s60 offen offset:1024 sc1
    s_nop 4
    v_add_f32 v98, v98, v99
    v_add_f32 v99, v100, v101
    v_mov_b32 v100, v98
    v_mov_b32 v101, v99
    s_nop 1
    v_permlane32_swap_b32 v98, v100
    v_permlane32_swap_b32 v99, v101
    s_nop 1
    v_add_f32 v98, v98, v100
    v_add_f32 v99, v99, v101
    v_lshlrev_b32 v102, 7, v13
    s_lshl_b32 s60, s49, 1
    s_add_u32 s60, s60, s57
    s_lshl_b32 s60, s60, 3
    s_add_u32 s60, s60, 0x230000
    v_cmp_gt_u32 vcc, 32, v1
    s_and_saveexec_b64 s[62:63], vcc
    buffer_store_dwordx2 v[98:99], v102, s[20:23], s60 offen sc1
    s_mov_b64 exec, s[62:63]
    s_add_u32 m0, s52, 131072
    s_add_u32 s54, s34, 0
    buffer_load_dwordx4 v60, s[20:23], s54 offen lds
    s_add_u32 m0, s52, 135168
    s_add_u32 s54, s34, 4096
    buffer_load_dwordx4 v60, s[20:23], s54 offen lds
    s_add_u32 m0, s52, 139264
    s_add_u32 s54, s34, 8192
    buffer_load_dwordx4 v60, s[20:23], s54 offen lds
    s_add_u32 m0, s52, 143360
    s_add_u32 s54, s34, 12288
    buffer_load_dwordx4 v60, s[20:23], s54 offen lds
    s_add_u32 m0, s52, 147456
    s_add_u32 s54, s34, 16384
    buffer_load_dwordx4 v60, s[20:23], s54 offen lds
    s_add_u32 m0, s52, 151552
    s_add_u32 s54, s34, 20480
    buffer_load_dwordx4 v60, s[20:23], s54 offen lds
    s_add_u32 m0, s52, 155648
    s_add_u32 s54, s34, 24576
    buffer_load_dwordx4 v60, s[20:23], s54 offen lds
    s_add_u32 m0, s52, 159744
    s_add_u32 s54, s34, 28672
    buffer_load_dwordx4 v60, s[20:23], s54 offen lds
    s_add_u32 m0, s52, 0
    s_add_u32 s54, s34, 32768
    buffer_load_dwordx4 v60, s[20:23], s54 offen lds
    s_add_u32 m0, s52, 4096
    s_add_u32 s54, s34, 36864
    buffer_load_dwordx4 v60, s[20:23], s54 offen lds
    s_add_u32 m0, s52, 8192
    s_add_u32 s54, s34, 40960
    buffer_load_dwordx4 v60, s[20:23], s54 offen lds
    s_add_u32 m0, s52, 12288
    s_add_u32 s54, s34, 45056
    buffer_load_dwordx4 v60, s[20:23], s54 offen lds
    s_add_u32 m0, s52, 16384
    s_add_u32 s54, s34, 49152
    buffer_load_dwordx4 v60, s[20:23], s54 offen lds
    s_add_u32 m0, s52, 20480
    s_add_u32 s54, s34, 53248
    buffer_load_dwordx4 v60, s[20:23], s54 offen lds
    s_add_u32 m0, s52, 24576
    s_add_u32 s54, s34, 57344
    buffer_load_dwordx4 v60, s[20:23], s54 offen lds
    s_add_u32 m0, s52, 28672
    s_add_u32 s54, s34, 61440
    buffer_load_dwordx4 v60, s[20:23], s54 offen lds
    s_mov_b32 s30, s48
    s_mov_b32 s31, s49
    s_mov_b32 s48, s38
    s_mov_b32 s49, s39
    v_and_b32 v2, 31, v1
    v_lshrrev_b32 v3, 5, v1
    s_lshl_b32 s50, s3, 5
    s_lshl_b32 s51, s48, 7
    s_add_u32 s50, s50, s51
    v_add_u32 v2, s50, v2
    s_lshl_b32 s57, s50, 10
    v_lshlrev_b32 v6, 7, v2
    v_lshl_add_u32 v6, v3, 6, v6
    v_lshlrev_b32 v7, 4, v1
    v_add_u32 v8, 0x10000, v7
    v_add_u32 v9, 0x20000, v7
    v_add_u32 v4, s52, v7
    s_mov_b32 s55, 0x230000
    s_add_u32 s57, s57, 0x1800000
    v_and_b32 v10, 31, v1
    v_lshlrev_b32 v10, 4, v10
    v_lshl_add_u32 v10, v3, 3, v10
    s_lshr_b32 s59, s50, 5
    s_mul_i32 s59, s59, 86
    s_mul_i32 s58, s49, 6
    s_add_u32 s59, s59, s58
    s_lshl_b32 s59, s59, 10
    s_add_u32 s59, s59, 0x800000
    s_mov_b32 s60, 0xbfb8aa3b
    s_lshl_b32 s65, s3, 8
    s_add_u32 s65, s65, s2
    s_cmp_lt_u32 s65, 8
    s_cselect_b32 s65, 1, 0
    s_add_u32 s58, s59, 2048
    s_add_u32 s64, s59, 4096
    s_lshl_b32 s61, s50, 8
    s_add_u32 s61, s61, 0x2000000
    s_add_u32 s62, s61, 2048
    s_cmp_eq_u32 s49, 15
    s_cselect_b32 s61, 4096, 0
    s_add_u32 s62, s62, s61
    s_lshl_b32 s61, s50, 8
    s_add_u32 s61, s61, 0x2000000
    v_mov_b32 v15, 1
    s_add_u32 s66, s42, 512
    s_add_u32 s67, s42, 640
    s_add_u32 s68, s42, 768
    s_cmp_ge_u32 s49, 14
    s_cselect_b32 s58, s61, s58
    s_cselect_b32 s64, s62, s64
    s_waitcnt vmcnt(16)
    s_mov_b32 s44, 0x8000
ffn_rs2:
    v_readfirstlane_b32 s4, v248
    v_readfirstlane_b32 s5, v249
    v_readfirstlane_b32 s6, v250
    v_readfirstlane_b32 s7, v251
    s_nop 3
    s_and_b32 s46, s4, s5
    s_and_b32 s47, s6, s7
    s_and_b32 s46, s46, s47
    s_and_b32 s47, s46, 0x80808080
    s_cmp_eq_u32 s47, 0x80808080
    s_cbranch_scc1 ffn_rd3
    s_sub_u32 s44, s44, 1
    s_cmp_eq_u32 s44, 0
    s_cbranch_scc1 ffn_rd3
    buffer_load_dwordx4 v[248:251], off, s[20:23], s42 sc1
    s_waitcnt vmcnt(0)
    s_branch ffn_rs2
ffn_rd3:
    s_or_b32 s47, s4, s5
    s_or_b32 s47, s47, s6
    s_or_b32 s47, s47, s7
    s_xor_b32 s47, s47, s43
    s_xor_b32 s46, s46, s43
    s_or_b32 s46, s46, s47
    s_cmp_eq_u32 s46, 0
    s_cselect_b32 s41, 1, 0
    s_barrier
    s_cmp_lg_u32 s3, 0
    s_cbranch_scc1 ffn_sk4
    s_mov_b64 exec, 1
    v_mov_b32 v56, 1
    s_cmp_eq_u32 s41, 0
    s_cbranch_scc1 ffn_sl5
    s_add_u32 s45, s42, 384
    s_add_u32 s47, s42, 2048
    s_lshl_b32 s45, s39, 7
    s_add_u32 s45, s45, s47
    s_add_u32 s47, s47, s39
    s_mov_b64 exec, 0xffff
    v_mov_b32 v56, 1
    v_lshlrev_b32 v57, 7, v1
    buffer_store_byte v56, v57, s[20:23], s47 offen
    s_branch ffn_dn6
ffn_sl5:
    s_add_u32 s45, s42, 128
    buffer_wbl2 sc1
    s_waitcnt vmcnt(0)
    buffer_atomic_add v56, off, s[20:23], s45 sc1
ffn_dn6:
    s_mov_b64 exec, -1
ffn_sk4:
    s_cmp_eq_u32 s49, 15
    s_cbranch_scc1 ffn_idle7
    s_add_u32 m0, s52, 32768
    s_add_u32 s54, s34, 65536
    buffer_load_dwordx4 v60, s[20:23], s54 offen lds
    s_add_u32 m0, s52, 36864
    s_add_u32 s54, s34, 69632
    buffer_load_dwordx4 v60, s[20:23], s54 offen lds
    s_add_u32 m0, s52, 40960
    s_add_u32 s54, s34, 73728
    buffer_load_dwordx4 v60, s[20:23], s54 offen lds
    s_add_u32 m0, s52, 45056
    s_add_u32 s54, s34, 77824
    buffer_load_dwordx4 v60, s[20:23], s54 offen lds
    s_add_u32 m0, s52, 49152
    s_add_u32 s54, s34, 81920
    buffer_load_dwordx4 v60, s[20:23], s54 offen lds
    s_add_u32 m0, s52, 53248
    s_add_u32 s54, s34, 86016
    buffer_load_dwordx4 v60, s[20:23], s54 offen lds
    s_add_u32 m0, s52, 57344
    s_add_u32 s54, s34, 90112
    buffer_load_dwordx4 v60, s[20:23], s54 offen lds
    s_add_u32 m0, s52, 61440
    s_add_u32 s54, s34, 94208
    buffer_load_dwordx4 v60, s[20:23], s54 offen lds
    s_add_u32 m0, s52, 65536
    s_add_u32 s54, s34, 98304
    buffer_load_dwordx4 v60, s[20:23], s54 offen lds
    s_add_u32 m0, s52, 69632
    s_add_u32 s54, s34, 102400
    buffer_load_dwordx4 v60, s[20:23], s54 offen lds
    s_add_u32 m0, s52, 73728
    s_add_u32 s54, s34, 106496
    buffer_load_dwordx4 v60, s[20:23], s54 offen lds
    s_add_u32 m0, s52, 77824
    s_add_u32 s54, s34, 110592
    buffer_load_dwordx4 v60, s[20:23], s54 offen lds
    s_add_u32 m0, s52, 81920
    s_add_u32 s54, s34, 114688
    buffer_load_dwordx4 v60, s[20:23], s54 offen lds
    s_add_u32 m0, s52, 86016
    s_add_u32 s54, s34, 118784
    buffer_load_dwordx4 v60, s[20:23], s54 offen lds
    s_add_u32 m0, s52, 90112
    s_add_u32 s54, s34, 122880
    buffer_load_dwordx4 v60, s[20:23], s54 offen lds
    s_add_u32 m0, s52, 94208
    s_add_u32 s54, s34, 126976
    buffer_load_dwordx4 v60, s[20:23], s54 offen lds
    s_cmp_lg_u32 s3, 0
    s_cbranch_scc1 ffn_sk9
    s_mov_b64 exec, 1
    s_mov_b32 s44, 0x8000
    s_cmp_eq_u32 s41, 0
    s_cbranch_scc1 ffn_sl10
ffn_pf12:
    s_load_dwordx4 s[8:11], s[32:33], s45 glc
    s_waitcnt lgkmcnt(0)
    s_and_b32 s8, s8, s9
    s_and_b32 s10, s10, s11
    s_and_b32 s8, s8, s10
    s_cmp_eq_u32 s8, 0x01010101
    s_cselect_b32 s46, 64, 0
    s_sub_u32 s44, s44, 1
    s_cmp_eq_u32 s44, 0
    s_cbranch_scc1 ffn_dn11
    s_cmp_lt_u32 s46, 16
    s_cbranch_scc1 ffn_pf12
    s_branch ffn_dn11
ffn_sl10:
ffn_ps13:
    buffer_load_dword v57, off, s[20:23], s45 sc1
    s_waitcnt vmcnt(0)
    v_readfirstlane_b32 s46, v57
    s_sub_u32 s44, s44, 1
    s_cmp_eq_u32 s44, 0
    s_cbranch_scc1 ffn_dn11
    s_cmp_lt_u32 s46, 16
    s_cbranch_scc1 ffn_ps13
ffn_dn11:
    s_mov_b64 exec, -1
ffn_sk9:
    s_barrier
    s_cmp_lg_u32 s41, 0
    s_cbranch_scc1 ffn_nf14
    buffer_inv sc1
    s_waitcnt vmcnt(0)
ffn_nf14:
    buffer_load_dwordx4 v[16:19], v6, s[20:23], s55 offen offset:0
    buffer_load_dwordx4 v[20:23], v6, s[20:23], s55 offen offset:16
    buffer_load_dwordx4 v[24:27], v6, s[20:23], s55 offen offset:32
    buffer_load_dwordx4 v[28:31], v6, s[20:23], s55 offen offset:48
    s_add_u32 s56, s57, 0
    buffer_load_dwordx4 v[112:115], v7, s[20:23], s56 offen
    s_add_u32 s56, s57, 1024
    buffer_load_dwordx4 v[116:119], v7, s[20:23], s56 offen
    s_add_u32 s56, s57, 2048
    buffer_load_dwordx4 v[120:123], v7, s[20:23], s56 offen
    s_add_u32 s56, s57, 3072
    buffer_load_dwordx4 v[124:127], v7, s[20:23], s56 offen
    s_add_u32 s56, s57, 4096
    buffer_load_dwordx4 v[128:131], v7, s[20:23], s56 offen
    s_add_u32 s56, s57, 5120
    buffer_load_dwordx4 v[132:135], v7, s[20:23], s56 offen
    s_add_u32 s56, s57, 6144
    buffer_load_dwordx4 v[136:139], v7, s[20:23], s56 offen
    s_add_u32 s56, s57, 7168
    buffer_load_dwordx4 v[140:143], v7, s[20:23], s56 offen
    s_waitcnt vmcnt(8)
    v_add_f32 v16, v16, v24
    v_add_f32 v17, v17, v25
    v_add_f32 v18, v18, v26
    v_add_f32 v19, v19, v27
    v_add_f32 v20, v20, v28
    v_add_f32 v21, v21, v29
    v_add_f32 v22, v22, v30
    v_add_f32 v23, v23, v31
    v_add_f32 v16, v16, v20
    v_add_f32 v17, v17, v21
    v_add_f32 v18, v18, v22
    v_add_f32 v19, v19, v23
    v_add_f32 v16, v16, v18
    v_add_f32 v17, v17, v19
    v_mov_b32 v18, v16
    v_mov_b32 v19, v17
    s_nop 1
    v_permlane32_swap_b32 v16, v18
    v_permlane32_swap_b32 v17, v19
    s_nop 1
    v_add_f32 v16, v16, v18
    v_add_f32 v17, v17, v19
    v_mul_f32 v16, 0x3b000000, v16
    v_mul_f32 v17, 0x3b000000, v17
    v_fma_f32 v17, -v16, v16, v17
    v_add_f32 v17, 0x3727c5ac, v17
    v_rsq_f32 v12, v17
    s_nop 1
    v_mul_f32 v14, v16, v12
    v_xor_b32 v14, 0x80000000, v14
    s_waitcnt vmcnt(36)
    s_barrier
    ds_read_b128 a[0:3], v9 offset:0
    ds_read_b128 a[4:7], v9 offset:1024
    ds_read_b128 a[8:11], v9 offset:2048
    ds_read_b128 a[12:15], v9 offset:3072
    s_waitcnt vmcnt(7)
    v_lshlrev_b32 v240, 16, v112
    v_and_b32 v241, 0xffff0000, v112
    v_fma_f32 v240, v240, v12, v14
    v_fma_f32 v241, v241, v12, v14
    v_cvt_pk_bf16_f32 v112, v240, v241
    v_lshlrev_b32 v242, 16, v113
    v_and_b32 v243, 0xffff0000, v113
    v_fma_f32 v242, v242, v12, v14
    v_fma_f32 v243, v243, v12, v14
    v_cvt_pk_bf16_f32 v113, v242, v243
    v_lshlrev_b32 v244, 16, v114
    v_and_b32 v245, 0xffff0000, v114
    v_fma_f32 v244, v244, v12, v14
    v_fma_f32 v245, v245, v12, v14
    v_cvt_pk_bf16_f32 v114, v244, v245
    v_lshlrev_b32 v246, 16, v115
    v_and_b32 v247, 0xffff0000, v115
    v_fma_f32 v246, v246, v12, v14
    v_fma_f32 v247, v247, v12, v14
    v_cvt_pk_bf16_f32 v115, v246, v247
    s_waitcnt vmcnt(6)
    v_lshlrev_b32 v240, 16, v116
    v_and_b32 v241, 0xffff0000, v116
    v_fma_f32 v240, v240, v12, v14
    v_fma_f32 v241, v241, v12, v14
    v_cvt_pk_bf16_f32 v116, v240, v241
    v_lshlrev_b32 v242, 16, v117
    v_and_b32 v243, 0xffff0000, v117
    v_fma_f32 v242, v242, v12, v14
    v_fma_f32 v243, v243, v12, v14
    v_cvt_pk_bf16_f32 v117, v242, v243
    v_lshlrev_b32 v244, 16, v118
    v_and_b32 v245, 0xffff0000, v118
    v_fma_f32 v244, v244, v12, v14
    v_fma_f32 v245, v245, v12, v14
    v_cvt_pk_bf16_f32 v118, v244, v245
    v_lshlrev_b32 v246, 16, v119
    v_and_b32 v247, 0xffff0000, v119
    v_fma_f32 v246, v246, v12, v14
    v_fma_f32 v247, v247, v12, v14
    v_cvt_pk_bf16_f32 v119, v246, v247
    s_nop 1
    s_waitcnt lgkmcnt(3)
    v_mfma_f32_32x32x16_bf16 v[16:31], a[0:3], v[112:115], 0
    ds_read_b128 a[16:19], v9 offset:4096
    s_waitcnt vmcnt(5)
    v_lshlrev_b32 v240, 16, v120
    v_and_b32 v241, 0xffff0000, v120
    v_fma_f32 v240, v240, v12, v14
    s_waitcnt lgkmcnt(3)
    v_mfma_f32_32x32x16_bf16 v[32:47], a[4:7], v[112:115], 0
    ds_read_b128 a[20:23], v9 offset:5120
    s_add_u32 s56, s57, 8192
    buffer_load_dwordx4 v[144:147], v7, s[20:23], s56 offen
    v_fma_f32 v241, v241, v12, v14
    v_cvt_pk_bf16_f32 v120, v240, v241
    v_lshlrev_b32 v242, 16, v121
    v_and_b32 v243, 0xffff0000, v121
    s_waitcnt lgkmcnt(3)
    v_mfma_f32_32x32x16_bf16 v[48:63], a[8:11], v[112:115], 0
    ds_read_b128 a[24:27], v9 offset:6144
    v_fma_f32 v242, v242, v12, v14
    v_fma_f32 v243, v243, v12, v14
    v_cvt_pk_bf16_f32 v121, v242, v243
    v_lshlrev_b32 v244, 16, v122
    s_waitcnt lgkmcnt(3)
    v_mfma_f32_32x32x16_bf16 v[64:79], a[12:15], v[112:115], 0
    ds_read_b128 a[28:31], v9 offset:7168
    s_add_u32 s56, s57, 9216
    buffer_load_dwordx4 v[148:151], v7, s[20:23], s56 offen
    v_and_b32 v245, 0xffff0000, v122
    v_fma_f32 v244, v244, v12, v14
    v_fma_f32 v245, v245, v12, v14
    v_cvt_pk_bf16_f32 v122, v244, v245
    s_waitcnt lgkmcnt(3)
    v_mfma_f32_32x32x16_bf16 v[80:95], a[16:19], v[112:115], 0
    ds_read_b128 a[0:3], v9 offset:8192
    v_lshlrev_b32 v246, 16, v123
    v_and_b32 v247, 0xffff0000, v123
    v_fma_f32 v246, v246, v12, v14
    v_fma_f32 v247, v247, v12, v14
    s_waitcnt lgkmcnt(3)
    v_mfma_f32_32x32x16_bf16 v[96:111], a[20:23], v[112:115], 0
    ds_read_b128 a[4:7], v9 offset:9216
    s_add_u32 s56, s57, 10240
    buffer_load_dwordx4 v[152:155], v7, s[20:23], s56 offen
    v_cvt_pk_bf16_f32 v123, v246, v247
    s_waitcnt vmcnt(7)
    v_lshlrev_b32 v240, 16, v124
    v_and_b32 v241, 0xffff0000, v124
    s_waitcnt lgkmcnt(3)
    v_mfma_f32_32x32x16_bf16 v[16:31], a[24:27], v[116:119], v[16:31]
    ds_read_b128 a[8:11], v9 offset:10240
    v_fma_f32 v240, v240, v12, v14
    v_fma_f32 v241, v241, v12, v14
    v_cvt_pk_bf16_f32 v124, v240, v241
    v_lshlrev_b32 v242, 16, v125
    s_waitcnt lgkmcnt(3)
    v_mfma_f32_32x32x16_bf16 v[32:47], a[28:31], v[116:119], v[32:47]
    ds_read_b128 a[12:15], v9 offset:11264
    s_add_u32 s56, s57, 11264
    buffer_load_dwordx4 v[156:159], v7, s[20:23], s56 offen
    v_and_b32 v243, 0xffff0000, v125
    v_fma_f32 v242, v242, v12, v14
    v_fma_f32 v243, v243, v12, v14
    v_cvt_pk_bf16_f32 v125, v242, v243
    s_waitcnt lgkmcnt(3)
    v_mfma_f32_32x32x16_bf16 v[48:63], a[0:3], v[116:119], v[48:63]
    ds_read_b128 a[16:19], v9 offset:12288
    v_lshlrev_b32 v244, 16, v126
    v_and_b32 v245, 0xffff0000, v126
    v_fma_f32 v244, v244, v12, v14
    v_fma_f32 v245, v245, v12, v14
    s_waitcnt lgkmcnt(3)
    v_mfma_f32_32x32x16_bf16 v[64:79], a[4:7], v[116:119], v[64:79]
    ds_read_b128 a[20:23], v9 offset:13312
    s_add_u32 s56, s57, 12288
    buffer_load_dwordx4 v[160:163], v7, s[20:23], s56 offen
    v_cvt_pk_bf16_f32 v126, v244, v245
    v_lshlrev_b32 v246, 16, v127
    v_and_b32 v247, 0xffff0000, v127
    v_fma_f32 v246, v246, v12, v14
    s_waitcnt lgkmcnt(3)
    v_mfma_f32_32x32x16_bf16 v[80:95], a[8:11], v[116:119], v[80:95]
    ds_read_b128 a[24:27], v9 offset:14336
    v_fma_f32 v247, v247, v12, v14
    v_cvt_pk_bf16_f32 v127, v246, v247
    s_waitcnt vmcnt(8)
    v_lshlrev_b32 v240, 16, v128
    s_waitcnt lgkmcnt(3)
    v_mfma_f32_32x32x16_bf16 v[96:111], a[12:15], v[116:119], v[96:111]
    ds_read_b128 a[28:31], v9 offset:15360
    s_add_u32 s56, s57, 13312
    buffer_load_dwordx4 v[164:167], v7, s[20:23], s56 offen
    v_and_b32 v241, 0xffff0000, v128
    v_fma_f32 v240, v240, v12, v14
    v_fma_f32 v241, v241, v12, v14
    v_cvt_pk_bf16_f32 v128, v240, v241
    s_waitcnt lgkmcnt(3)
    v_mfma_f32_32x32x16_bf16 v[16:31], a[16:19], v[120:123], v[16:31]
    ds_read_b128 a[0:3], v9 offset:16384
    v_lshlrev_b32 v242, 16, v129
    v_and_b32 v243, 0xffff0000, v129
    v_fma_f32 v242, v242, v12, v14
    v_fma_f32 v243, v243, v12, v14
    s_waitcnt lgkmcnt(3)
    v_mfma_f32_32x32x16_bf16 v[32:47], a[20:23], v[120:123], v[32:47]
    ds_read_b128 a[4:7], v9 offset:17408
    s_add_u32 s56, s57, 14336
    buffer_load_dwordx4 v[168:171], v7, s[20:23], s56 offen
    v_cvt_pk_bf16_f32 v129, v242, v243
    v_lshlrev_b32 v244, 16, v130
    v_and_b32 v245, 0xffff0000, v130
    v_fma_f32 v244, v244, v12, v14
    s_waitcnt lgkmcnt(3)
    v_mfma_f32_32x32x16_bf16 v[48:63], a[24:27], v[120:123], v[48:63]
    ds_read_b128 a[8:11], v9 offset:18432
    v_fma_f32 v245, v245, v12, v14
    v_cvt_pk_bf16_f32 v130, v244, v245
    v_lshlrev_b32 v246, 16, v131
    v_and_b32 v247, 0xffff0000, v131
    s_waitcnt lgkmcnt(3)
    v_mfma_f32_32x32x16_bf16 v[64:79], a[28:31], v[120:123], v[64:79]
    ds_read_b128 a[12:15], v9 offset:19456
    s_add_u32 s56, s57, 15360
    buffer_load_dwordx4 v[172:175], v7, s[20:23], s56 offen
    v_fma_f32 v246, v246, v12, v14
    v_fma_f32 v247, v247, v12, v14
    v_cvt_pk_bf16_f32 v131, v246, v247
    s_waitcnt vmcnt(10)
    s_waitcnt lgkmcnt(3)
    v_mfma_f32_32x32x16_bf16 v[80:95], a[0:3], v[120:123], v[80:95]
    ds_read_b128 a[16:19], v9 offset:20480
    v_lshlrev_b32 v240, 16, v132
    v_and_b32 v241, 0xffff0000, v132
    v_fma_f32 v240, v240, v12, v14
    v_fma_f32 v241, v241, v12, v14
    s_waitcnt lgkmcnt(3)
    v_mfma_f32_32x32x16_bf16 v[96:111], a[4:7], v[120:123], v[96:111]
    ds_read_b128 a[20:23], v9 offset:21504
    s_add_u32 s56, s57, 16384
    buffer_load_dwordx4 v[176:179], v7, s[20:23], s56 offen
    v_cvt_pk_bf16_f32 v132, v240, v241
    v_lshlrev_b32 v242, 16, v133
    v_and_b32 v243, 0xffff0000, v133
    v_fma_f32 v242, v242, v12, v14
    s_waitcnt lgkmcnt(3)
    v_mfma_f32_32x32x16_bf16 v[16:31], a[8:11], v[124:127], v[16:31]
    ds_read_b128 a[24:27], v9 offset:22528
    v_fma_f32 v243, v243, v12, v14
    v_cvt_pk_bf16_f32 v133, v242, v243
    v_lshlrev_b32 v244, 16, v134
    v_and_b32 v245, 0xffff0000, v134
    s_waitcnt lgkmcnt(3)
    v_mfma_f32_32x32x16_bf16 v[32:47], a[12:15], v[124:127], v[32:47]
    ds_read_b128 a[28:31], v9 offset:23552
    s_add_u32 s56, s57, 17408
    buffer_load_dwordx4 v[180:183], v7, s[20:23], s56 offen
    v_fma_f32 v244, v244, v12, v14
    v_fma_f32 v245, v245, v12, v14
    v_cvt_pk_bf16_f32 v134, v244, v245
    v_lshlrev_b32 v246, 16, v135
    s_waitcnt lgkmcnt(3)
    v_mfma_f32_32x32x16_bf16 v[48:63], a[16:19], v[124:127], v[48:63]
    ds_read_b128 a[0:3], v9 offset:24576
    v_and_b32 v247, 0xffff0000, v135
    v_fma_f32 v246, v246, v12, v14
    v_fma_f32 v247, v247, v12, v14
    v_cvt_pk_bf16_f32 v135, v246, v247
    s_waitcnt lgkmcnt(3)
    v_mfma_f32_32x32x16_bf16 v[64:79], a[20:23], v[124:127], v[64:79]
    ds_read_b128 a[4:7], v9 offset:25600
    s_add_u32 s56, s57, 18432
    buffer_load_dwordx4 v[184:187], v7, s[20:23], s56 offen
    s_waitcnt vmcnt(12)
    v_lshlrev_b32 v240, 16, v136
    v_and_b32 v241, 0xffff0000, v136
    v_fma_f32 v240, v240, v12, v14
    s_waitcnt lgkmcnt(3)
    v_mfma_f32_32x32x16_bf16 v[80:95], a[24:27], v[124:127], v[80:95]
    ds_read_b128 a[8:11], v9 offset:26624
    v_fma_f32 v241, v241, v12, v14
    v_cvt_pk_bf16_f32 v136, v240, v241
    v_lshlrev_b32 v242, 16, v137
    v_and_b32 v243, 0xffff0000, v137
    s_waitcnt lgkmcnt(3)
    v_mfma_f32_32x32x16_bf16 v[96:111], a[28:31], v[124:127], v[96:111]
    ds_read_b128 a[12:15], v9 offset:27648
    s_add_u32 s56, s57, 19456
    buffer_load_dwordx4 v[188:191], v7, s[20:23], s56 offen
    v_fma_f32 v242, v242, v12, v14
    v_fma_f32 v243, v243, v12, v14
    v_cvt_pk_bf16_f32 v137, v242, v243
    v_lshlrev_b32 v244, 16, v138
    s_waitcnt lgkmcnt(3)
    v_mfma_f32_32x32x16_bf16 v[16:31], a[0:3], v[128:131], v[16:31]
    ds_read_b128 a[16:19], v9 offset:28672
    v_and_b32 v245, 0xffff0000, v138
    v_fma_f32 v244, v244, v12, v14
    v_fma_f32 v245, v245, v12, v14
    v_cvt_pk_bf16_f32 v138, v244, v245
    s_waitcnt lgkmcnt(3)
    v_mfma_f32_32x32x16_bf16 v[32:47], a[4:7], v[128:131], v[32:47]
    ds_read_b128 a[20:23], v9 offset:29696
    s_add_u32 s56, s57, 20480
    buffer_load_dwordx4 v[192:195], v7, s[20:23], s56 offen
    v_lshlrev_b32 v246, 16, v139
    v_and_b32 v247, 0xffff0000, v139
    v_fma_f32 v246, v246, v12, v14
    v_fma_f32 v247, v247, v12, v14
    s_waitcnt lgkmcnt(3)
    v_mfma_f32_32x32x16_bf16 v[48:63], a[8:11], v[128:131], v[48:63]
    ds_read_b128 a[24:27], v9 offset:30720
    v_cvt_pk_bf16_f32 v139, v246, v247
    s_waitcnt vmcnt(13)
    v_lshlrev_b32 v240, 16, v140
    v_and_b32 v241, 0xffff0000, v140
    s_waitcnt lgkmcnt(3)
    v_mfma_f32_32x32x16_bf16 v[64:79], a[12:15], v[128:131], v[64:79]
    ds_read_b128 a[28:31], v9 offset:31744
    s_add_u32 s56, s57, 21504
    buffer_load_dwordx4 v[196:199], v7, s[20:23], s56 offen
    v_fma_f32 v240, v240, v12, v14
    v_fma_f32 v241, v241, v12, v14
    v_cvt_pk_bf16_f32 v140, v240, v241
    v_lshlrev_b32 v242, 16, v141
    s_waitcnt vmcnt(42)
    s_barrier
    s_waitcnt lgkmcnt(3)
    v_mfma_f32_32x32x16_bf16 v[80:95], a[16:19], v[128:131], v[80:95]
    ds_read_b128 a[0:3], v7 offset:0
    v_and_b32 v243, 0xffff0000, v141
    v_fma_f32 v242, v242, v12, v14
    v_fma_f32 v243, v243, v12, v14
    v_cvt_pk_bf16_f32 v141, v242, v243
    s_waitcnt lgkmcnt(3)
    v_mfma_f32_32x32x16_bf16 v[96:111], a[20:23], v[128:131], v[96:111]
    ds_read_b128 a[4:7], v7 offset:1024
    s_add_u32 s56, s57, 22528
    buffer_load_dwordx4 v[200:203], v7, s[20:23], s56 offen
    v_lshlrev_b32 v244, 16, v142
    v_and_b32 v245, 0xffff0000, v142
    v_fma_f32 v244, v244, v12, v14
    v_fma_f32 v245, v245, v12, v14
    s_waitcnt lgkmcnt(3)
    v_mfma_f32_32x32x16_bf16 v[16:31], a[24:27], v[132:135], v[16:31]
    ds_read_b128 a[8:11], v7 offset:2048
    v_cvt_pk_bf16_f32 v142, v244, v245
    v_lshlrev_b32 v246, 16, v143
    v_and_b32 v247, 0xffff0000, v143
    v_fma_f32 v246, v246, v12, v14
    s_waitcnt lgkmcnt(3)
    v_mfma_f32_32x32x16_bf16 v[32:47], a[28:31], v[132:135], v[32:47]
    ds_read_b128 a[12:15], v7 offset:3072
    s_add_u32 s56, s57, 23552
    buffer_load_dwordx4 v[204:207], v7, s[20:23], s56 offen
    v_fma_f32 v247, v247, v12, v14
    v_cvt_pk_bf16_f32 v143, v246, v247
    s_waitcnt vmcnt(15)
    v_lshlrev_b32 v240, 16, v144
    s_waitcnt lgkmcnt(3)
    v_mfma_f32_32x32x16_bf16 v[48:63], a[0:3], v[132:135], v[48:63]
    ds_read_b128 a[16:19], v7 offset:4096
    v_and_b32 v241, 0xffff0000, v144
    v_fma_f32 v240, v240, v12, v14
    v_fma_f32 v241, v241, v12, v14
    v_cvt_pk_bf16_f32 v144, v240, v241
    s_waitcnt lgkmcnt(3)
    v_mfma_f32_32x32x16_bf16 v[64:79], a[4:7], v[132:135], v[64:79]
    ds_read_b128 a[20:23], v7 offset:5120
    s_add_u32 s56, s57, 24576
    buffer_load_dwordx4 v[208:211], v7, s[20:23], s56 offen
    v_lshlrev_b32 v242, 16, v145
    v_and_b32 v243, 0xffff0000, v145
    v_fma_f32 v242, v242, v12, v14
    v_fma_f32 v243, v243, v12, v14
    s_waitcnt lgkmcnt(3)
    v_mfma_f32_32x32x16_bf16 v[80:95], a[8:11], v[132:135], v[80:95]
    ds_read_b128 a[24:27], v7 offset:6144
    v_cvt_pk_bf16_f32 v145, v242, v243
    v_lshlrev_b32 v244, 16, v146
    v_and_b32 v245, 0xffff0000, v146
    v_fma_f32 v244, v244, v12, v14
    s_waitcnt lgkmcnt(3)
    v_mfma_f32_32x32x16_bf16 v[96:111], a[12:15], v[132:135], v[96:111]
    ds_read_b128 a[28:31], v7 offset:7168
    s_add_u32 s56, s57, 25600
    buffer_load_dwordx4 v[212:215], v7, s[20:23], s56 offen
    v_fma_f32 v245, v245, v12, v14
    v_cvt_pk_bf16_f32 v146, v244, v245
    v_lshlrev_b32 v246, 16, v147
    v_and_b32 v247, 0xffff0000, v147
    s_waitcnt lgkmcnt(3)
    v_mfma_f32_32x32x16_bf16 v[16:31], a[16:19], v[136:139], v[16:31]
    ds_read_b128 a[0:3], v7 offset:8192
    v_fma_f32 v246, v246, v12, v14
    v_fma_f32 v247, v247, v12, v14
    v_cvt_pk_bf16_f32 v147, v246, v247
    s_waitcnt vmcnt(16)
    s_waitcnt lgkmcnt(3)
    v_mfma_f32_32x32x16_bf16 v[32:47], a[20:23], v[136:139], v[32:47]
    ds_read_b128 a[4:7], v7 offset:9216
    s_add_u32 s56, s57, 26624
    buffer_load_dwordx4 v[216:219], v7, s[20:23], s56 offen
    v_lshlrev_b32 v240, 16, v148
    v_and_b32 v241, 0xffff0000, v148
    v_fma_f32 v240, v240, v12, v14
    v_fma_f32 v241, v241, v12, v14
    s_waitcnt lgkmcnt(3)
    v_mfma_f32_32x32x16_bf16 v[48:63], a[24:27], v[136:139], v[48:63]
    ds_read_b128 a[8:11], v7 offset:10240
    v_cvt_pk_bf16_f32 v148, v240, v241
    v_lshlrev_b32 v242, 16, v149
    v_and_b32 v243, 0xffff0000, v149
    v_fma_f32 v242, v242, v12, v14
    s_waitcnt lgkmcnt(3)
    v_mfma_f32_32x32x16_bf16 v[64:79], a[28:31], v[136:139], v[64:79]
    ds_read_b128 a[12:15], v7 offset:11264
    s_add_u32 s56, s57, 27648
    buffer_load_dwordx4 v[220:223], v7, s[20:23], s56 offen
    v_fma_f32 v243, v243, v12, v14
    v_cvt_pk_bf16_f32 v149, v242, v243
    v_lshlrev_b32 v244, 16, v150
    v_and_b32 v245, 0xffff0000, v150
    s_waitcnt lgkmcnt(3)
    v_mfma_f32_32x32x16_bf16 v[80:95], a[0:3], v[136:139], v[80:95]
    ds_read_b128 a[16:19], v7 offset:12288
    v_fma_f32 v244, v244, v12, v14
    v_fma_f32 v245, v245, v12, v14
    v_cvt_pk_bf16_f32 v150, v244, v245
    v_lshlrev_b32 v246, 16, v151
    s_waitcnt lgkmcnt(3)
    v_mfma_f32_32x32x16_bf16 v[96:111], a[4:7], v[136:139], v[96:111]
    ds_read_b128 a[20:23], v7 offset:13312
    s_add_u32 s56, s57, 28672
    buffer_load_dwordx4 v[224:227], v7, s[20:23], s56 offen
    v_and_b32 v247, 0xffff0000, v151
    v_fma_f32 v246, v246, v12, v14
    v_fma_f32 v247, v247, v12, v14
    v_cvt_pk_bf16_f32 v151, v246, v247
    s_waitcnt lgkmcnt(3)
    v_mfma_f32_32x32x16_bf16 v[16:31], a[8:11], v[140:143], v[16:31]
    ds_read_b128 a[24:27], v7 offset:14336
    s_waitcnt vmcnt(18)
    v_lshlrev_b32 v240, 16, v152
    v_and_b32 v241, 0xffff0000, v152
    v_fma_f32 v240, v240, v12, v14
    s_waitcnt lgkmcnt(3)
    v_mfma_f32_32x32x16_bf16 v[32:47], a[12:15], v[140:143], v[32:47]
    ds_read_b128 a[28:31], v7 offset:15360
    s_add_u32 s56, s57, 29696
    buffer_load_dwordx4 v[228:231], v7, s[20:23], s56 offen
    v_fma_f32 v241, v241, v12, v14
    v_cvt_pk_bf16_f32 v152, v240, v241
    v_lshlrev_b32 v242, 16, v153
    v_and_b32 v243, 0xffff0000, v153
    s_waitcnt lgkmcnt(3)
    v_mfma_f32_32x32x16_bf16 v[48:63], a[16:19], v[140:143], v[48:63]
    ds_read_b128 a[0:3], v7 offset:16384
    v_fma_f32 v242, v242, v12, v14
    v_fma_f32 v243, v243, v12, v14
    v_cvt_pk_bf16_f32 v153, v242, v243
    v_lshlrev_b32 v244, 16, v154
    s_waitcnt lgkmcnt(3)
    v_mfma_f32_32x32x16_bf16 v[64:79], a[20:23], v[140:143], v[64:79]
    ds_read_b128 a[4:7], v7 offset:17408
    s_add_u32 s56, s57, 30720
    buffer_load_dwordx4 v[232:235], v7, s[20:23], s56 offen
    v_and_b32 v245, 0xffff0000, v154
    v_fma_f32 v244, v244, v12, v14
    v_fma_f32 v245, v245, v12, v14
    v_cvt_pk_bf16_f32 v154, v244, v245
    s_waitcnt lgkmcnt(3)
    v_mfma_f32_32x32x16_bf16 v[80:95], a[24:27], v[140:143], v[80:95]
    ds_read_b128 a[8:11], v7 offset:18432
    v_lshlrev_b32 v246, 16, v155
    v_and_b32 v247, 0xffff0000, v155
    v_fma_f32 v246, v246, v12, v14
    v_fma_f32 v247, v247, v12, v14
    s_waitcnt lgkmcnt(3)
    v_mfma_f32_32x32x16_bf16 v[96:111], a[28:31], v[140:143], v[96:111]
    ds_read_b128 a[12:15], v7 offset:19456
    s_add_u32 s56, s57, 31744
    buffer_load_dwordx4 v[236:239], v7, s[20:23], s56 offen
    v_cvt_pk_bf16_f32 v155, v246, v247
    s_waitcnt vmcnt(20)
    v_lshlrev_b32 v240, 16, v156
    v_and_b32 v241, 0xffff0000, v156
    s_waitcnt lgkmcnt(3)
    v_mfma_f32_32x32x16_bf16 v[16:31], a[0:3], v[144:147], v[16:31]
    ds_read_b128 a[16:19], v7 offset:20480
    v_fma_f32 v240, v240, v12, v14
    v_fma_f32 v241, v241, v12, v14
    v_cvt_pk_bf16_f32 v156, v240, v241
    v_lshlrev_b32 v242, 16, v157
    s_waitcnt lgkmcnt(3)
    v_mfma_f32_32x32x16_bf16 v[32:47], a[4:7], v[144:147], v[32:47]
    ds_read_b128 a[20:23], v7 offset:21504
    v_and_b32 v243, 0xffff0000, v157
    v_fma_f32 v242, v242, v12, v14
    v_fma_f32 v243, v243, v12, v14
    v_cvt_pk_bf16_f32 v157, v242, v243
    s_waitcnt lgkmcnt(3)
    v_mfma_f32_32x32x16_bf16 v[48:63], a[8:11], v[144:147], v[48:63]
    ds_read_b128 a[24:27], v7 offset:22528
    v_lshlrev_b32 v244, 16, v158
    v_and_b32 v245, 0xffff0000, v158
    v_fma_f32 v244, v244, v12, v14
    v_fma_f32 v245, v245, v12, v14
    s_waitcnt lgkmcnt(3)
    v_mfma_f32_32x32x16_bf16 v[64:79], a[12:15], v[144:147], v[64:79]
    ds_read_b128 a[28:31], v7 offset:23552
    v_cvt_pk_bf16_f32 v158, v244, v245
    v_lshlrev_b32 v246, 16, v159
    v_and_b32 v247, 0xffff0000, v159
    v_fma_f32 v246, v246, v12, v14
    s_waitcnt lgkmcnt(3)
    v_mfma_f32_32x32x16_bf16 v[80:95], a[16:19], v[144:147], v[80:95]
    ds_read_b128 a[0:3], v7 offset:24576
    v_fma_f32 v247, v247, v12, v14
    v_cvt_pk_bf16_f32 v159, v246, v247
    s_waitcnt vmcnt(19)
    v_lshlrev_b32 v240, 16, v160
    s_waitcnt lgkmcnt(3)
    v_mfma_f32_32x32x16_bf16 v[96:111], a[20:23], v[144:147], v[96:111]
    ds_read_b128 a[4:7], v7 offset:25600
    v_and_b32 v241, 0xffff0000, v160
    v_fma_f32 v240, v240, v12, v14
    v_fma_f32 v241, v241, v12, v14
    v_cvt_pk_bf16_f32 v160, v240, v241
    s_waitcnt lgkmcnt(3)
    v_mfma_f32_32x32x16_bf16 v[16:31], a[24:27], v[148:151], v[16:31]
    ds_read_b128 a[8:11], v7 offset:26624
    v_lshlrev_b32 v242, 16, v161
    v_and_b32 v243, 0xffff0000, v161
    v_fma_f32 v242, v242, v12, v14
    v_fma_f32 v243, v243, v12, v14
    s_waitcnt lgkmcnt(3)
    v_mfma_f32_32x32x16_bf16 v[32:47], a[28:31], v[148:151], v[32:47]
    ds_read_b128 a[12:15], v7 offset:27648
    v_cvt_pk_bf16_f32 v161, v242, v243
    v_lshlrev_b32 v244, 16, v162
    v_and_b32 v245, 0xffff0000, v162
    v_fma_f32 v244, v244, v12, v14
    s_waitcnt lgkmcnt(3)
    v_mfma_f32_32x32x16_bf16 v[48:63], a[0:3], v[148:151], v[48:63]
    ds_read_b128 a[16:19], v7 offset:28672
    v_fma_f32 v245, v245, v12, v14
    v_cvt_pk_bf16_f32 v162, v244, v245
    v_lshlrev_b32 v246, 16, v163
    v_and_b32 v247, 0xffff0000, v163
    s_waitcnt lgkmcnt(3)
    v_mfma_f32_32x32x16_bf16 v[64:79], a[4:7], v[148:151], v[64:79]
    ds_read_b128 a[20:23], v7 offset:29696
    v_fma_f32 v246, v246, v12, v14
    v_fma_f32 v247, v247, v12, v14
    v_cvt_pk_bf16_f32 v163, v246, v247
    s_waitcnt vmcnt(18)
    s_waitcnt lgkmcnt(3)
    v_mfma_f32_32x32x16_bf16 v[80:95], a[8:11], v[148:151], v[80:95]
    ds_read_b128 a[24:27], v7 offset:30720
    v_lshlrev_b32 v240, 16, v164
    v_and_b32 v241, 0xffff0000, v164
    v_fma_f32 v240, v240, v12, v14
    v_fma_f32 v241, v241, v12, v14
    s_waitcnt lgkmcnt(3)
    v_mfma_f32_32x32x16_bf16 v[96:111], a[12:15], v[148:151], v[96:111]
    ds_read_b128 a[28:31], v7 offset:31744
    v_cvt_pk_bf16_f32 v164, v240, v241
    v_lshlrev_b32 v242, 16, v165
    v_and_b32 v243, 0xffff0000, v165
    v_fma_f32 v242, v242, v12, v14
    s_waitcnt vmcnt(44)
    s_barrier
    s_waitcnt lgkmcnt(3)
    v_mfma_f32_32x32x16_bf16 v[16:31], a[16:19], v[152:155], v[16:31]
    ds_read_b128 a[0:3], v7 offset:32768
    s_add_u32 s69, s35, 0
    buffer_load_dwordx4 a[32:35], v7, s[20:23], s69 offen offset:0
    v_fma_f32 v243, v243, v12, v14
    v_cvt_pk_bf16_f32 v165, v242, v243
    v_lshlrev_b32 v244, 16, v166
    v_and_b32 v245, 0xffff0000, v166
    s_waitcnt lgkmcnt(3)
    v_mfma_f32_32x32x16_bf16 v[32:47], a[20:23], v[152:155], v[32:47]
    ds_read_b128 a[4:7], v7 offset:33792
    s_add_u32 m0, s52, 98304
    s_add_u32 s54, s34, 131072
    buffer_load_dwordx4 v4, s[20:23], s54 offen lds
    v_fma_f32 v244, v244, v12, v14
    v_fma_f32 v245, v245, v12, v14
    v_cvt_pk_bf16_f32 v166, v244, v245
    v_lshlrev_b32 v246, 16, v167
    s_waitcnt lgkmcnt(3)
    v_mfma_f32_32x32x16_bf16 v[48:63], a[24:27], v[152:155], v[48:63]
    ds_read_b128 a[8:11], v7 offset:34816
    buffer_load_dwordx4 a[36:39], v7, s[20:23], s69 offen offset:1024
    v_and_b32 v247, 0xffff0000, v167
    v_fma_f32 v246, v246, v12, v14
    v_fma_f32 v247, v247, v12, v14
    v_cvt_pk_bf16_f32 v167, v246, v247
    s_waitcnt lgkmcnt(3)
    v_mfma_f32_32x32x16_bf16 v[64:79], a[28:31], v[152:155], v[64:79]
    ds_read_b128 a[12:15], v7 offset:35840
    s_add_u32 m0, s52, 102400
    s_add_u32 s54, s34, 135168
    buffer_load_dwordx4 v4, s[20:23], s54 offen lds
    s_waitcnt vmcnt(21)
    v_lshlrev_b32 v240, 16, v168
    v_and_b32 v241, 0xffff0000, v168
    v_fma_f32 v240, v240, v12, v14
    s_waitcnt lgkmcnt(3)
    v_mfma_f32_32x32x16_bf16 v[80:95], a[0:3], v[152:155], v[80:95]
    ds_read_b128 a[16:19], v7 offset:36864
    buffer_load_dwordx4 a[40:43], v7, s[20:23], s69 offen offset:2048
    v_fma_f32 v241, v241, v12, v14
    v_cvt_pk_bf16_f32 v168, v240, v241
    v_lshlrev_b32 v242, 16, v169
    v_and_b32 v243, 0xffff0000, v169
    s_waitcnt lgkmcnt(3)
    v_mfma_f32_32x32x16_bf16 v[96:111], a[4:7], v[152:155], v[96:111]
    ds_read_b128 a[20:23], v7 offset:37888
    s_add_u32 m0, s52, 106496
    s_add_u32 s54, s34, 139264
    buffer_load_dwordx4 v4, s[20:23], s54 offen lds
    v_fma_f32 v242, v242, v12, v14
    v_fma_f32 v243, v243, v12, v14
    v_cvt_pk_bf16_f32 v169, v242, v243
    v_lshlrev_b32 v244, 16, v170
    s_waitcnt lgkmcnt(3)
    v_mfma_f32_32x32x16_bf16 v[16:31], a[8:11], v[156:159], v[16:31]
    ds_read_b128 a[24:27], v7 offset:38912
    buffer_load_dwordx4 a[44:47], v7, s[20:23], s69 offen offset:3072
    v_and_b32 v245, 0xffff0000, v170
    v_fma_f32 v244, v244, v12, v14
    v_fma_f32 v245, v245, v12, v14
    v_cvt_pk_bf16_f32 v170, v244, v245
    s_waitcnt lgkmcnt(3)
    v_mfma_f32_32x32x16_bf16 v[32:47], a[12:15], v[156:159], v[32:47]
    ds_read_b128 a[28:31], v7 offset:39936
    s_add_u32 m0, s52, 110592
    s_add_u32 s54, s34, 143360
    buffer_load_dwordx4 v4, s[20:23], s54 offen lds
    v_lshlrev_b32 v246, 16, v171
    v_and_b32 v247, 0xffff0000, v171
    v_fma_f32 v246, v246, v12, v14
    v_fma_f32 v247, v247, v12, v14
    s_waitcnt lgkmcnt(3)
    v_mfma_f32_32x32x16_bf16 v[48:63], a[16:19], v[156:159], v[48:63]
    ds_read_b128 a[0:3], v7 offset:40960
    s_add_u32 s69, s35, 4096
    buffer_load_dwordx4 a[48:51], v7, s[20:23], s69 offen offset:0
    v_cvt_pk_bf16_f32 v171, v246, v247
    s_waitcnt vmcnt(25)
    v_lshlrev_b32 v240, 16, v172
    v_and_b32 v241, 0xffff0000, v172
    s_waitcnt lgkmcnt(3)
    v_mfma_f32_32x32x16_bf16 v[64:79], a[20:23], v[156:159], v[64:79]
    ds_read_b128 a[4:7], v7 offset:41984
    s_add_u32 m0, s52, 114688
    s_add_u32 s54, s34, 147456
    buffer_load_dwordx4 v4, s[20:23], s54 offen lds
    v_fma_f32 v240, v240, v12, v14
    v_fma_f32 v241, v241, v12, v14
    v_cvt_pk_bf16_f32 v172, v240, v241
    v_lshlrev_b32 v242, 16, v173
    s_waitcnt lgkmcnt(3)
    v_mfma_f32_32x32x16_bf16 v[80:95], a[24:27], v[156:159], v[80:95]
    ds_read_b128 a[8:11], v7 offset:43008
    buffer_load_dwordx4 a[52:55], v7, s[20:23], s69 offen offset:1024
    v_and_b32 v243, 0xffff0000, v173
    v_fma_f32 v242, v242, v12, v14
    v_fma_f32 v243, v243, v12, v14
    v_cvt_pk_bf16_f32 v173, v242, v243
    s_waitcnt lgkmcnt(3)
    v_mfma_f32_32x32x16_bf16 v[96:111], a[28:31], v[156:159], v[96:111]
    ds_read_b128 a[12:15], v7 offset:44032
    s_add_u32 m0, s52, 118784
    s_add_u32 s54, s34, 151552
    buffer_load_dwordx4 v4, s[20:23], s54 offen lds
    v_lshlrev_b32 v244, 16, v174
    v_and_b32 v245, 0xffff0000, v174
    v_fma_f32 v244, v244, v12, v14
    v_fma_f32 v245, v245, v12, v14
    s_waitcnt lgkmcnt(3)
    v_mfma_f32_32x32x16_bf16 v[16:31], a[0:3], v[160:163], v[16:31]
    ds_read_b128 a[16:19], v7 offset:45056
    buffer_load_dwordx4 a[56:59], v7, s[20:23], s69 offen offset:2048
    v_cvt_pk_bf16_f32 v174, v244, v245
    v_lshlrev_b32 v246, 16, v175
    v_and_b32 v247, 0xffff0000, v175
    v_fma_f32 v246, v246, v12, v14
    s_waitcnt lgkmcnt(3)
    v_mfma_f32_32x32x16_bf16 v[32:47], a[4:7], v[160:163], v[32:47]
    ds_read_b128 a[20:23], v7 offset:46080
    s_add_u32 m0, s52, 122880
    s_add_u32 s54, s34, 155648
    buffer_load_dwordx4 v4, s[20:23], s54 offen lds
    v_fma_f32 v247, v247, v12, v14
    v_cvt_pk_bf16_f32 v175, v246, v247
    s_waitcnt vmcnt(29)
    v_lshlrev_b32 v240, 16, v176
    s_waitcnt lgkmcnt(3)
    v_mfma_f32_32x32x16_bf16 v[48:63], a[8:11], v[160:163], v[48:63]
    ds_read_b128 a[24:27], v7 offset:47104
    buffer_load_dwordx4 a[60:63], v7, s[20:23], s69 offen offset:3072
    v_and_b32 v241, 0xffff0000, v176
    v_fma_f32 v240, v240, v12, v14
    v_fma_f32 v241, v241, v12, v14
    v_cvt_pk_bf16_f32 v176, v240, v241
    s_waitcnt lgkmcnt(3)
    v_mfma_f32_32x32x16_bf16 v[64:79], a[12:15], v[160:163], v[64:79]
    ds_read_b128 a[28:31], v7 offset:48128
    s_add_u32 m0, s52, 126976
    s_add_u32 s54, s34, 159744
    buffer_load_dwordx4 v4, s[20:23], s54 offen lds
    v_lshlrev_b32 v242, 16, v177
    v_and_b32 v243, 0xffff0000, v177
    v_fma_f32 v242, v242, v12, v14
    v_fma_f32 v243, v243, v12, v14
    s_waitcnt lgkmcnt(3)
    v_mfma_f32_32x32x16_bf16 v[80:95], a[16:19], v[160:163], v[80:95]
    ds_read_b128 a[0:3], v7 offset:49152
    s_add_u32 s69, s35, 8192
    buffer_load_dwordx4 a[64:67], v7, s[20:23], s69 offen offset:0
    v_cvt_pk_bf16_f32 v177, v242, v243
    v_lshlrev_b32 v244, 16, v178
    v_and_b32 v245, 0xffff0000, v178
    v_fma_f32 v244, v244, v12, v14
    s_waitcnt lgkmcnt(3)
    v_mfma_f32_32x32x16_bf16 v[96:111], a[20:23], v[160:163], v[96:111]
    ds_read_b128 a[4:7], v7 offset:50176
    v_fma_f32 v245, v245, v12, v14
    v_cvt_pk_bf16_f32 v178, v244, v245
    v_lshlrev_b32 v246, 16, v179
    v_and_b32 v247, 0xffff0000, v179
    s_waitcnt lgkmcnt(3)
    v_mfma_f32_32x32x16_bf16 v[16:31], a[24:27], v[164:167], v[16:31]
    ds_read_b128 a[8:11], v7 offset:51200
    buffer_load_dwordx4 a[68:71], v7, s[20:23], s69 offen offset:1024
    v_fma_f32 v246, v246, v12, v14
    v_fma_f32 v247, v247, v12, v14
    v_cvt_pk_bf16_f32 v179, v246, v247
    s_waitcnt vmcnt(32)
    s_waitcnt lgkmcnt(3)
    v_mfma_f32_32x32x16_bf16 v[32:47], a[28:31], v[164:167], v[32:47]
    ds_read_b128 a[12:15], v7 offset:52224
    v_lshlrev_b32 v240, 16, v180
    v_and_b32 v241, 0xffff0000, v180
    v_fma_f32 v240, v240, v12, v14
    v_fma_f32 v241, v241, v12, v14
    s_waitcnt lgkmcnt(3)
    v_mfma_f32_32x32x16_bf16 v[48:63], a[0:3], v[164:167], v[48:63]
    ds_read_b128 a[16:19], v7 offset:53248
    buffer_load_dwordx4 a[72:75], v7, s[20:23], s69 offen offset:2048
    v_cvt_pk_bf16_f32 v180, v240, v241
    v_lshlrev_b32 v242, 16, v181
    v_and_b32 v243, 0xffff0000, v181
    v_fma_f32 v242, v242, v12, v14
    s_waitcnt lgkmcnt(3)
    v_mfma_f32_32x32x16_bf16 v[64:79], a[4:7], v[164:167], v[64:79]
    ds_read_b128 a[20:23], v7 offset:54272
    v_fma_f32 v243, v243, v12, v14
    v_cvt_pk_bf16_f32 v181, v242, v243
    v_lshlrev_b32 v244, 16, v182
    v_and_b32 v245, 0xffff0000, v182
    s_waitcnt lgkmcnt(3)
    v_mfma_f32_32x32x16_bf16 v[80:95], a[8:11], v[164:167], v[80:95]
    ds_read_b128 a[24:27], v7 offset:55296
    buffer_load_dwordx4 a[76:79], v7, s[20:23], s69 offen offset:3072
    v_fma_f32 v244, v244, v12, v14
    v_fma_f32 v245, v245, v12, v14
    v_cvt_pk_bf16_f32 v182, v244, v245
    v_lshlrev_b32 v246, 16, v183
    s_waitcnt lgkmcnt(3)
    v_mfma_f32_32x32x16_bf16 v[96:111], a[12:15], v[164:167], v[96:111]
    ds_read_b128 a[28:31], v7 offset:56320
    v_and_b32 v247, 0xffff0000, v183
    v_fma_f32 v246, v246, v12, v14
    v_fma_f32 v247, v247, v12, v14
    v_cvt_pk_bf16_f32 v183, v246, v247
    s_waitcnt lgkmcnt(3)
    v_mfma_f32_32x32x16_bf16 v[16:31], a[16:19], v[168:171], v[16:31]
    ds_read_b128 a[0:3], v7 offset:57344
    s_add_u32 s69, s35, 12288
    buffer_load_dwordx4 a[80:83], v7, s[20:23], s69 offen offset:0
    s_waitcnt vmcnt(34)
    v_lshlrev_b32 v240, 16, v184
    v_and_b32 v241, 0xffff0000, v184
    v_fma_f32 v240, v240, v12, v14
    s_waitcnt lgkmcnt(3)
    v_mfma_f32_32x32x16_bf16 v[32:47], a[20:23], v[168:171], v[32:47]
    ds_read_b128 a[4:7], v7 offset:58368
    v_fma_f32 v241, v241, v12, v14
    v_cvt_pk_bf16_f32 v184, v240, v241
    v_lshlrev_b32 v242, 16, v185
    v_and_b32 v243, 0xffff0000, v185
    s_waitcnt lgkmcnt(3)
    v_mfma_f32_32x32x16_bf16 v[48:63], a[24:27], v[168:171], v[48:63]
    ds_read_b128 a[8:11], v7 offset:59392
    buffer_load_dwordx4 a[84:87], v7, s[20:23], s69 offen offset:1024
    v_fma_f32 v242, v242, v12, v14
    v_fma_f32 v243, v243, v12, v14
    v_cvt_pk_bf16_f32 v185, v242, v243
    v_lshlrev_b32 v244, 16, v186
    s_waitcnt lgkmcnt(3)
    v_mfma_f32_32x32x16_bf16 v[64:79], a[28:31], v[168:171], v[64:79]
    ds_read_b128 a[12:15], v7 offset:60416
    v_and_b32 v245, 0xffff0000, v186
    v_fma_f32 v244, v244, v12, v14
    v_fma_f32 v245, v245, v12, v14
    v_cvt_pk_bf16_f32 v186, v244, v245
    s_waitcnt lgkmcnt(3)
    v_mfma_f32_32x32x16_bf16 v[80:95], a[0:3], v[168:171], v[80:95]
    ds_read_b128 a[16:19], v7 offset:61440
    buffer_load_dwordx4 a[88:91], v7, s[20:23], s69 offen offset:2048
    v_lshlrev_b32 v246, 16, v187
    v_and_b32 v247, 0xffff0000, v187
    v_fma_f32 v246, v246, v12, v14
    v_fma_f32 v247, v247, v12, v14
    s_waitcnt lgkmcnt(3)
    v_mfma_f32_32x32x16_bf16 v[96:111], a[4:7], v[168:171], v[96:111]
    ds_read_b128 a[20:23], v7 offset:62464
    v_cvt_pk_bf16_f32 v187, v246, v247
    s_waitcnt vmcnt(35)
    v_lshlrev_b32 v240, 16, v188
    v_and_b32 v241, 0xffff0000, v188
    s_waitcnt lgkmcnt(3)
    v_mfma_f32_32x32x16_bf16 v[16:31], a[8:11], v[172:175], v[16:31]
    ds_read_b128 a[24:27], v7 offset:63488
    buffer_load_dwordx4 a[92:95], v7, s[20:23], s69 offen offset:3072
    v_fma_f32 v240, v240, v12, v14
    v_fma_f32 v241, v241, v12, v14
    v_cvt_pk_bf16_f32 v188, v240, v241
    v_lshlrev_b32 v242, 16, v189
    s_waitcnt lgkmcnt(3)
    v_mfma_f32_32x32x16_bf16 v[32:47], a[12:15], v[172:175], v[32:47]
    ds_read_b128 a[28:31], v7 offset:64512
    v_and_b32 v243, 0xffff0000, v189
    v_fma_f32 v242, v242, v12, v14
    v_fma_f32 v243, v243, v12, v14
    v_cvt_pk_bf16_f32 v189, v242, v243
    s_waitcnt vmcnt(60)
    s_barrier
    s_waitcnt lgkmcnt(3)
    v_mfma_f32_32x32x16_bf16 v[48:63], a[16:19], v[172:175], v[48:63]
    ds_read_b128 a[0:3], v8 offset:0
    s_add_u32 s69, s35, 16384
    buffer_load_dwordx4 a[96:99], v7, s[20:23], s69 offen offset:0
    v_lshlrev_b32 v244, 16, v190
    v_and_b32 v245, 0xffff0000, v190
    v_fma_f32 v244, v244, v12, v14
    v_fma_f32 v245, v245, v12, v14
    s_waitcnt lgkmcnt(3)
    v_mfma_f32_32x32x16_bf16 v[64:79], a[20:23], v[172:175], v[64:79]
    ds_read_b128 a[4:7], v8 offset:1024
    s_add_u32 m0, s52, 131072
    s_add_u32 s54, s34, 163840
    buffer_load_dwordx4 v4, s[20:23], s54 offen lds
    v_cvt_pk_bf16_f32 v190, v244, v245
    v_lshlrev_b32 v246, 16, v191
    v_and_b32 v247, 0xffff0000, v191
    v_fma_f32 v246, v246, v12, v14
    s_waitcnt lgkmcnt(3)
    v_mfma_f32_32x32x16_bf16 v[80:95], a[24:27], v[172:175], v[80:95]
    ds_read_b128 a[8:11], v8 offset:2048
    buffer_load_dwordx4 a[100:103], v7, s[20:23], s69 offen offset:1024
    v_fma_f32 v247, v247, v12, v14
    v_cvt_pk_bf16_f32 v191, v246, v247
    s_waitcnt vmcnt(38)
    v_lshlrev_b32 v240, 16, v192
    s_waitcnt lgkmcnt(3)
    v_mfma_f32_32x32x16_bf16 v[96:111], a[28:31], v[172:175], v[96:111]
    ds_read_b128 a[12:15], v8 offset:3072
    s_add_u32 m0, s52, 135168
    s_add_u32 s54, s34, 167936
    buffer_load_dwordx4 v4, s[20:23], s54 offen lds
    v_and_b32 v241, 0xffff0000, v192
    v_fma_f32 v240, v240, v12, v14
    v_fma_f32 v241, v241, v12, v14
    v_cvt_pk_bf16_f32 v192, v240, v241
    s_waitcnt lgkmcnt(3)
    v_mfma_f32_32x32x16_bf16 v[16:31], a[0:3], v[176:179], v[16:31]
    ds_read_b128 a[16:19], v8 offset:4096
    buffer_load_dwordx4 a[104:107], v7, s[20:23], s69 offen offset:2048
    v_lshlrev_b32 v242, 16, v193
    v_and_b32 v243, 0xffff0000, v193
    v_fma_f32 v242, v242, v12, v14
    v_fma_f32 v243, v243, v12, v14
    s_waitcnt lgkmcnt(3)
    v_mfma_f32_32x32x16_bf16 v[64:79], a[4:7], v[176:179], v[64:79]
    ds_read_b128 a[20:23], v8 offset:5120
    s_add_u32 m0, s52, 139264
    s_add_u32 s54, s34, 172032
    buffer_load_dwordx4 v4, s[20:23], s54 offen lds
    v_cvt_pk_bf16_f32 v193, v242, v243
    v_lshlrev_b32 v244, 16, v194
    v_and_b32 v245, 0xffff0000, v194
    v_fma_f32 v244, v244, v12, v14
    s_waitcnt lgkmcnt(3)
    v_mfma_f32_32x32x16_bf16 v[16:31], a[8:11], v[180:183], v[16:31]
    ds_read_b128 a[24:27], v8 offset:6144
    buffer_load_dwordx4 a[108:111], v7, s[20:23], s69 offen offset:3072
    v_fma_f32 v245, v245, v12, v14
    v_cvt_pk_bf16_f32 v194, v244, v245
    v_lshlrev_b32 v246, 16, v195
    v_and_b32 v247, 0xffff0000, v195
    s_waitcnt lgkmcnt(3)
    v_mfma_f32_32x32x16_bf16 v[64:79], a[12:15], v[180:183], v[64:79]
    ds_read_b128 a[28:31], v8 offset:7168
    s_add_u32 m0, s52, 143360
    s_add_u32 s54, s34, 176128
    buffer_load_dwordx4 v4, s[20:23], s54 offen lds
    v_fma_f32 v246, v246, v12, v14
    v_fma_f32 v247, v247, v12, v14
    v_cvt_pk_bf16_f32 v195, v246, v247
    s_waitcnt vmcnt(42)
    s_waitcnt lgkmcnt(3)
    v_mfma_f32_32x32x16_bf16 v[16:31], a[16:19], v[184:187], v[16:31]
    ds_read_b128 a[0:3], v8 offset:8192
    s_add_u32 s69, s35, 20480
    buffer_load_dwordx4 a[112:115], v7, s[20:23], s69 offen offset:0
    v_lshlrev_b32 v240, 16, v196
    v_and_b32 v241, 0xffff0000, v196
    v_fma_f32 v240, v240, v12, v14
    v_fma_f32 v241, v241, v12, v14
    s_waitcnt lgkmcnt(3)
    v_mfma_f32_32x32x16_bf16 v[64:79], a[20:23], v[184:187], v[64:79]
    ds_read_b128 a[4:7], v8 offset:9216
    s_add_u32 m0, s52, 147456
    s_add_u32 s54, s34, 180224
    buffer_load_dwordx4 v4, s[20:23], s54 offen lds
    v_cvt_pk_bf16_f32 v196, v240, v241
    v_lshlrev_b32 v242, 16, v197
    v_and_b32 v243, 0xffff0000, v197
    v_fma_f32 v242, v242, v12, v14
    s_waitcnt lgkmcnt(3)
    v_mfma_f32_32x32x16_bf16 v[16:31], a[24:27], v[188:191], v[16:31]
    ds_read_b128 a[8:11], v8 offset:10240
    buffer_load_dwordx4 a[116:119], v7, s[20:23], s69 offen offset:1024
    v_fma_f32 v243, v243, v12, v14
    v_cvt_pk_bf16_f32 v197, v242, v243
    v_lshlrev_b32 v244, 16, v198
    v_and_b32 v245, 0xffff0000, v198
    s_waitcnt lgkmcnt(3)
    v_mfma_f32_32x32x16_bf16 v[64:79], a[28:31], v[188:191], v[64:79]
    ds_read_b128 a[12:15], v8 offset:11264
    s_add_u32 m0, s52, 151552
    s_add_u32 s54, s34, 184320
    buffer_load_dwordx4 v4, s[20:23], s54 offen lds
    v_fma_f32 v244, v244, v12, v14
    v_fma_f32 v245, v245, v12, v14
    v_cvt_pk_bf16_f32 v198, v244, v245
    v_lshlrev_b32 v246, 16, v199
    v_and_b32 v247, 0xffff0000, v199
    v_fma_f32 v246, v246, v12, v14
    v_fma_f32 v247, v247, v12, v14
    v_cvt_pk_bf16_f32 v199, v246, v247
    s_nop 1
    s_waitcnt lgkmcnt(3)
    v_mfma_f32_32x32x16_bf16 v[16:31], a[0:3], v[192:195], v[16:31]
    ds_read_b128 a[16:19], v8 offset:12288
    buffer_load_dwordx4 a[120:123], v7, s[20:23], s69 offen offset:2048
    s_waitcnt vmcnt(46)
    v_lshlrev_b32 v240, 16, v200
    v_and_b32 v241, 0xffff0000, v200
    v_fma_f32 v240, v240, v12, v14
    s_waitcnt lgkmcnt(3)
    v_mfma_f32_32x32x16_bf16 v[64:79], a[4:7], v[192:195], v[64:79]
    ds_read_b128 a[20:23], v8 offset:13312
    s_add_u32 m0, s52, 155648
    s_add_u32 s54, s34, 188416
    buffer_load_dwordx4 v4, s[20:23], s54 offen lds
    v_fma_f32 v241, v241, v12, v14
    v_cvt_pk_bf16_f32 v200, v240, v241
    v_lshlrev_b32 v242, 16, v201
    v_and_b32 v243, 0xffff0000, v201
    v_fma_f32 v242, v242, v12, v14
    v_fma_f32 v243, v243, v12, v14
    v_cvt_pk_bf16_f32 v201, v242, v243
    v_lshlrev_b32 v244, 16, v202
    v_and_b32 v245, 0xffff0000, v202
    v_fma_f32 v244, v244, v12, v14
    v_fma_f32 v245, v245, v12, v14
    v_cvt_pk_bf16_f32 v202, v244, v245
    v_lshlrev_b32 v246, 16, v203
    v_and_b32 v247, 0xffff0000, v203
    v_fma_f32 v246, v246, v12, v14
    v_fma_f32 v247, v247, v12, v14
    v_cvt_pk_bf16_f32 v203, v246, v247
    s_nop 1
    s_waitcnt lgkmcnt(3)
    v_mfma_f32_32x32x16_bf16 v[16:31], a[8:11], v[196:199], v[16:31]
    ds_read_b128 a[24:27], v8 offset:14336
    buffer_load_dwordx4 a[124:127], v7, s[20:23], s69 offen offset:3072
    s_waitcnt vmcnt(47)
    v_lshlrev_b32 v240, 16, v204
    v_and_b32 v241, 0xffff0000, v204
    v_fma_f32 v240, v240, v12, v14
    s_waitcnt lgkmcnt(3)
    v_mfma_f32_32x32x16_bf16 v[64:79], a[12:15], v[196:199], v[64:79]
    ds_read_b128 a[28:31], v8 offset:15360
    s_add_u32 m0, s52, 159744
    s_add_u32 s54, s34, 192512
    buffer_load_dwordx4 v4, s[20:23], s54 offen lds
    v_fma_f32 v241, v241, v12, v14
    v_cvt_pk_bf16_f32 v204, v240, v241
    v_lshlrev_b32 v242, 16, v205
    v_and_b32 v243, 0xffff0000, v205
    v_fma_f32 v242, v242, v12, v14
    v_fma_f32 v243, v243, v12, v14
    v_cvt_pk_bf16_f32 v205, v242, v243
    v_lshlrev_b32 v244, 16, v206
    v_and_b32 v245, 0xffff0000, v206
    v_fma_f32 v244, v244, v12, v14
    v_fma_f32 v245, v245, v12, v14
    v_cvt_pk_bf16_f32 v206, v244, v245
    v_lshlrev_b32 v246, 16, v207
    v_and_b32 v247, 0xffff0000, v207
    v_fma_f32 v246, v246, v12, v14
    v_fma_f32 v247, v247, v12, v14
    v_cvt_pk_bf16_f32 v207, v246, v247
    s_nop 1
    s_waitcnt lgkmcnt(3)
    v_mfma_f32_32x32x16_bf16 v[16:31], a[16:19], v[200:203], v[16:31]
    ds_read_b128 a[0:3], v8 offset:16384
    s_add_u32 s69, s35, 24576
    buffer_load_dwordx4 a[128:131], v7, s[20:23], s69 offen offset:0
    s_waitcnt vmcnt(48)
    v_lshlrev_b32 v240, 16, v208
    v_and_b32 v241, 0xffff0000, v208
    v_fma_f32 v240, v240, v12, v14
    s_waitcnt lgkmcnt(3)
    v_mfma_f32_32x32x16_bf16 v[64:79], a[20:23], v[200:203], v[64:79]
    ds_read_b128 a[4:7], v8 offset:17408
    v_fma_f32 v241, v241, v12, v14
    v_cvt_pk_bf16_f32 v208, v240, v241
    v_lshlrev_b32 v242, 16, v209
    v_and_b32 v243, 0xffff0000, v209
    v_fma_f32 v242, v242, v12, v14
    v_fma_f32 v243, v243, v12, v14
    v_cvt_pk_bf16_f32 v209, v242, v243
    v_lshlrev_b32 v244, 16, v210
    v_and_b32 v245, 0xffff0000, v210
    v_fma_f32 v244, v244, v12, v14
    v_fma_f32 v245, v245, v12, v14
    v_cvt_pk_bf16_f32 v210, v244, v245
    v_lshlrev_b32 v246, 16, v211
    v_and_b32 v247, 0xffff0000, v211
    v_fma_f32 v246, v246, v12, v14
    v_fma_f32 v247, v247, v12, v14
    v_cvt_pk_bf16_f32 v211, v246, v247
    s_nop 1
    s_waitcnt lgkmcnt(3)
    v_mfma_f32_32x32x16_bf16 v[16:31], a[24:27], v[204:207], v[16:31]
    ds_read_b128 a[8:11], v8 offset:18432
    buffer_load_dwordx4 a[132:135], v7, s[20:23], s69 offen offset:1024
    s_waitcnt vmcnt(48)
    v_lshlrev_b32 v240, 16, v212
    v_and_b32 v241, 0xffff0000, v212
    v_fma_f32 v240, v240, v12, v14
    s_waitcnt lgkmcnt(3)
    v_mfma_f32_32x32x16_bf16 v[64:79], a[28:31], v[204:207], v[64:79]
    ds_read_b128 a[12:15], v8 offset:19456
    v_fma_f32 v241, v241, v12, v14
    v_cvt_pk_bf16_f32 v212, v240, v241
    v_lshlrev_b32 v242, 16, v213
    v_and_b32 v243, 0xffff0000, v213
    v_fma_f32 v242, v242, v12, v14
    v_fma_f32 v243, v243, v12, v14
    v_cvt_pk_bf16_f32 v213, v242, v243
    v_lshlrev_b32 v244, 16, v214
    v_and_b32 v245, 0xffff0000, v214
    v_fma_f32 v244, v244, v12, v14
    v_fma_f32 v245, v245, v12, v14
    v_cvt_pk_bf16_f32 v214, v244, v245
    v_lshlrev_b32 v246, 16, v215
    v_and_b32 v247, 0xffff0000, v215
    v_fma_f32 v246, v246, v12, v14
    v_fma_f32 v247, v247, v12, v14
    v_cvt_pk_bf16_f32 v215, v246, v247
    s_nop 1
    s_waitcnt lgkmcnt(3)
    v_mfma_f32_32x32x16_bf16 v[16:31], a[0:3], v[208:211], v[16:31]
    ds_read_b128 a[16:19], v8 offset:20480
    buffer_load_dwordx4 a[136:139], v7, s[20:23], s69 offen offset:2048
    s_waitcnt vmcnt(48)
    v_lshlrev_b32 v240, 16, v216
    v_and_b32 v241, 0xffff0000, v216
    v_fma_f32 v240, v240, v12, v14
    s_waitcnt lgkmcnt(3)
    v_mfma_f32_32x32x16_bf16 v[64:79], a[4:7], v[208:211], v[64:79]
    ds_read_b128 a[20:23], v8 offset:21504
    v_fma_f32 v241, v241, v12, v14
    v_cvt_pk_bf16_f32 v216, v240, v241
    v_lshlrev_b32 v242, 16, v217
    v_and_b32 v243, 0xffff0000, v217
    v_fma_f32 v242, v242, v12, v14
    v_fma_f32 v243, v243, v12, v14
    v_cvt_pk_bf16_f32 v217, v242, v243
    v_lshlrev_b32 v244, 16, v218
    v_and_b32 v245, 0xffff0000, v218
    v_fma_f32 v244, v244, v12, v14
    v_fma_f32 v245, v245, v12, v14
    v_cvt_pk_bf16_f32 v218, v244, v245
    v_lshlrev_b32 v246, 16, v219
    v_and_b32 v247, 0xffff0000, v219
    v_fma_f32 v246, v246, v12, v14
    v_fma_f32 v247, v247, v12, v14
    v_cvt_pk_bf16_f32 v219, v246, v247
    s_nop 1
    s_waitcnt lgkmcnt(3)
    v_mfma_f32_32x32x16_bf16 v[16:31], a[8:11], v[212:215], v[16:31]
    ds_read_b128 a[24:27], v8 offset:22528
    buffer_load_dwordx4 a[140:143], v7, s[20:23], s69 offen offset:3072
    s_waitcnt vmcnt(48)
    v_lshlrev_b32 v240, 16, v220
    v_and_b32 v241, 0xffff0000, v220
    v_fma_f32 v240, v240, v12, v14
    s_waitcnt lgkmcnt(3)
    v_mfma_f32_32x32x16_bf16 v[64:79], a[12:15], v[212:215], v[64:79]
    ds_read_b128 a[28:31], v8 offset:23552
    v_fma_f32 v241, v241, v12, v14
    v_cvt_pk_bf16_f32 v220, v240, v241
    v_lshlrev_b32 v242, 16, v221
    v_and_b32 v243, 0xffff0000, v221
    v_fma_f32 v242, v242, v12, v14
    v_fma_f32 v243, v243, v12, v14
    v_cvt_pk_bf16_f32 v221, v242, v243
    v_lshlrev_b32 v244, 16, v222
    v_and_b32 v245, 0xffff0000, v222
    v_fma_f32 v244, v244, v12, v14
    v_fma_f32 v245, v245, v12, v14
    v_cvt_pk_bf16_f32 v222, v244, v245
    v_lshlrev_b32 v246, 16, v223
    v_and_b32 v247, 0xffff0000, v223
    v_fma_f32 v246, v246, v12, v14
    v_fma_f32 v247, v247, v12, v14
    v_cvt_pk_bf16_f32 v223, v246, v247
    s_nop 1
    s_waitcnt lgkmcnt(3)
    v_mfma_f32_32x32x16_bf16 v[16:31], a[16:19], v[216:219], v[16:31]
    ds_read_b128 a[0:3], v8 offset:24576
    s_add_u32 s69, s35, 28672
    buffer_load_dwordx4 a[144:147], v7, s[20:23], s69 offen offset:0
    s_waitcnt vmcnt(48)
    v_lshlrev_b32 v240, 16, v224
    v_and_b32 v241, 0xffff0000, v224
    v_fma_f32 v240, v240, v12, v14
    s_waitcnt lgkmcnt(3)
    v_mfma_f32_32x32x16_bf16 v[64:79], a[20:23], v[216:219], v[64:79]
    ds_read_b128 a[4:7], v8 offset:25600
    v_fma_f32 v241, v241, v12, v14
    v_cvt_pk_bf16_f32 v224, v240, v241
    v_lshlrev_b32 v242, 16, v225
    v_and_b32 v243, 0xffff0000, v225
    v_fma_f32 v242, v242, v12, v14
    v_fma_f32 v243, v243, v12, v14
    v_cvt_pk_bf16_f32 v225, v242, v243
    v_lshlrev_b32 v244, 16, v226
    v_and_b32 v245, 0xffff0000, v226
    v_fma_f32 v244, v244, v12, v14
    v_fma_f32 v245, v245, v12, v14
    v_cvt_pk_bf16_f32 v226, v244, v245
    v_lshlrev_b32 v246, 16, v227
    v_and_b32 v247, 0xffff0000, v227
    v_fma_f32 v246, v246, v12, v14
    v_fma_f32 v247, v247, v12, v14
    v_cvt_pk_bf16_f32 v227, v246, v247
    s_nop 1
    s_waitcnt lgkmcnt(3)
    v_mfma_f32_32x32x16_bf16 v[16:31], a[24:27], v[220:223], v[16:31]
    ds_read_b128 a[8:11], v8 offset:26624
    buffer_load_dwordx4 a[148:151], v7, s[20:23], s69 offen offset:1024
    s_waitcnt vmcnt(48)
    v_lshlrev_b32 v240, 16, v228
    v_and_b32 v241, 0xffff0000, v228
    v_fma_f32 v240, v240, v12, v14
    s_waitcnt lgkmcnt(3)
    v_mfma_f32_32x32x16_bf16 v[64:79], a[28:31], v[220:223], v[64:79]
    ds_read_b128 a[12:15], v8 offset:27648
    v_fma_f32 v241, v241, v12, v14
    v_cvt_pk_bf16_f32 v228, v240, v241
    v_lshlrev_b32 v242, 16, v229
    v_and_b32 v243, 0xffff0000, v229
    v_fma_f32 v242, v242, v12, v14
    v_fma_f32 v243, v243, v12, v14
    v_cvt_pk_bf16_f32 v229, v242, v243
    v_lshlrev_b32 v244, 16, v230
    v_and_b32 v245, 0xffff0000, v230
    v_fma_f32 v244, v244, v12, v14
    v_fma_f32 v245, v245, v12, v14
    v_cvt_pk_bf16_f32 v230, v244, v245
    v_lshlrev_b32 v246, 16, v231
    v_and_b32 v247, 0xffff0000, v231
    v_fma_f32 v246, v246, v12, v14
    v_fma_f32 v247, v247, v12, v14
    v_cvt_pk_bf16_f32 v231, v246, v247
    s_nop 1
    s_waitcnt lgkmcnt(3)
    v_mfma_f32_32x32x16_bf16 v[16:31], a[0:3], v[224:227], v[16:31]
    ds_read_b128 a[16:19], v8 offset:28672
    buffer_load_dwordx4 a[152:155], v7, s[20:23], s69 offen offset:2048
    s_waitcnt vmcnt(48)
    v_lshlrev_b32 v240, 16, v232
    v_and_b32 v241, 0xffff0000, v232
    v_fma_f32 v240, v240, v12, v14
    s_waitcnt lgkmcnt(3)
    v_mfma_f32_32x32x16_bf16 v[64:79], a[4:7], v[224:227], v[64:79]
    ds_read_b128 a[20:23], v8 offset:29696
    v_fma_f32 v241, v241, v12, v14
    v_cvt_pk_bf16_f32 v232, v240, v241
    v_lshlrev_b32 v242, 16, v233
    v_and_b32 v243, 0xffff0000, v233
    v_fma_f32 v242, v242, v12, v14
    v_fma_f32 v243, v243, v12, v14
    v_cvt_pk_bf16_f32 v233, v242, v243
    v_lshlrev_b32 v244, 16, v234
    v_and_b32 v245, 0xffff0000, v234
    v_fma_f32 v244, v244, v12, v14
    v_fma_f32 v245, v245, v12, v14
    v_cvt_pk_bf16_f32 v234, v244, v245
    v_lshlrev_b32 v246, 16, v235
    v_and_b32 v247, 0xffff0000, v235
    v_fma_f32 v246, v246, v12, v14
    v_fma_f32 v247, v247, v12, v14
    v_cvt_pk_bf16_f32 v235, v246, v247
    s_nop 1
    s_waitcnt lgkmcnt(3)
    v_mfma_f32_32x32x16_bf16 v[16:31], a[8:11], v[228:231], v[16:31]
    ds_read_b128 a[24:27], v8 offset:30720
    buffer_load_dwordx4 a[156:159], v7, s[20:23], s69 offen offset:3072
    s_waitcnt vmcnt(48)
    v_lshlrev_b32 v240, 16, v236
    v_and_b32 v241, 0xffff0000, v236
    v_fma_f32 v240, v240, v12, v14
    s_waitcnt lgkmcnt(3)
    v_mfma_f32_32x32x16_bf16 v[64:79], a[12:15], v[228:231], v[64:79]
    ds_read_b128 a[28:31], v8 offset:31744
    v_fma_f32 v241, v241, v12, v14
    v_cvt_pk_bf16_f32 v236, v240, v241
    v_lshlrev_b32 v242, 16, v237
    v_and_b32 v243, 0xffff0000, v237
    s_waitcnt vmcnt(32)
    s_barrier
    v_fma_f32 v242, v242, v12, v14
    v_fma_f32 v243, v243, v12, v14
    v_cvt_pk_bf16_f32 v237, v242, v243
    v_lshlrev_b32 v244, 16, v238
    v_and_b32 v245, 0xffff0000, v238
    v_fma_f32 v244, v244, v12, v14
    v_fma_f32 v245, v245, v12, v14
    v_cvt_pk_bf16_f32 v238, v244, v245
    v_lshlrev_b32 v246, 16, v239
    v_and_b32 v247, 0xffff0000, v239
    v_fma_f32 v246, v246, v12, v14
    v_fma_f32 v247, v247, v12, v14
    v_cvt_pk_bf16_f32 v239, v246, v247
    s_nop 1
    s_waitcnt lgkmcnt(3)
    v_mfma_f32_32x32x16_bf16 v[16:31], a[16:19], v[232:235], v[16:31]
    ds_read_b128 a[0:3], v8 offset:32768
    s_add_u32 s69, s35, 32768
    buffer_load_dwordx4 a[160:163], v7, s[20:23], s69 offen offset:0
    s_waitcnt lgkmcnt(3)
    v_mfma_f32_32x32x16_bf16 v[64:79], a[20:23], v[232:235], v[64:79]
    ds_read_b128 a[4:7], v8 offset:33792
    s_waitcnt lgkmcnt(3)
    v_mfma_f32_32x32x16_bf16 v[16:31], a[24:27], v[236:239], v[16:31]
    ds_read_b128 a[8:11], v8 offset:34816
    buffer_load_dwordx4 a[164:167], v7, s[20:23], s69 offen offset:1024
    s_waitcnt lgkmcnt(3)
    v_mfma_f32_32x32x16_bf16 v[64:79], a[28:31], v[236:239], v[64:79]
    ds_read_b128 a[12:15], v8 offset:35840
    s_nop 15
    v_mul_f32 v240, s60, v16
    v_mul_f32 v241, s60, v17
    v_mul_f32 v242, s60, v18
    s_waitcnt lgkmcnt(3)
    v_mfma_f32_32x32x16_bf16 v[32:47], a[0:3], v[176:179], v[32:47]
    ds_read_b128 a[16:19], v8 offset:36864
    buffer_load_dwordx4 a[168:171], v7, s[20:23], s69 offen offset:2048
    v_mul_f32 v243, s60, v19
    v_mul_f32 v244, s60, v20
    v_mul_f32 v245, s60, v21
    v_mul_f32 v246, s60, v22
    s_waitcnt lgkmcnt(3)
    v_mfma_f32_32x32x16_bf16 v[80:95], a[4:7], v[176:179], v[80:95]
    ds_read_b128 a[20:23], v8 offset:37888
    v_mul_f32 v247, s60, v23
    v_mul_f32 v248, s60, v24
    v_mul_f32 v249, s60, v25
    v_mul_f32 v250, s60, v26
    s_waitcnt lgkmcnt(3)
    v_mfma_f32_32x32x16_bf16 v[32:47], a[8:11], v[180:183], v[32:47]
    ds_read_b128 a[24:27], v8 offset:38912
    buffer_load_dwordx4 a[172:175], v7, s[20:23], s69 offen offset:3072
    v_mul_f32 v251, s60, v27
    v_mul_f32 v252, s60, v28
    v_mul_f32 v253, s60, v29
    v_mul_f32 v254, s60, v30
    s_waitcnt lgkmcnt(3)
    v_mfma_f32_32x32x16_bf16 v[80:95], a[12:15], v[180:183], v[80:95]
    ds_read_b128 a[28:31], v8 offset:39936
    v_mul_f32 v255, s60, v31
    v_exp_f32 v240, v240
    v_exp_f32 v241, v241
    v_exp_f32 v242, v242
    s_waitcnt lgkmcnt(3)
    v_mfma_f32_32x32x16_bf16 v[32:47], a[16:19], v[184:187], v[32:47]
    ds_read_b128 a[0:3], v8 offset:40960
    s_add_u32 s69, s35, 36864
    buffer_load_dwordx4 a[176:179], v7, s[20:23], s69 offen offset:0
    v_exp_f32 v243, v243
    v_exp_f32 v244, v244
    v_exp_f32 v245, v245
    v_exp_f32 v246, v246
    s_waitcnt lgkmcnt(3)
    v_mfma_f32_32x32x16_bf16 v[80:95], a[20:23], v[184:187], v[80:95]
    ds_read_b128 a[4:7], v8 offset:41984
    v_exp_f32 v247, v247
    v_exp_f32 v248, v248
    v_exp_f32 v249, v249
    v_exp_f32 v250, v250
    s_waitcnt lgkmcnt(3)
    v_mfma_f32_32x32x16_bf16 v[32:47], a[24:27], v[188:191], v[32:47]
    ds_read_b128 a[8:11], v8 offset:43008
    buffer_load_dwordx4 a[180:183], v7, s[20:23], s69 offen offset:1024
    v_exp_f32 v251, v251
    v_exp_f32 v252, v252
    v_exp_f32 v253, v253
    v_exp_f32 v254, v254
    s_waitcnt lgkmcnt(3)
    v_mfma_f32_32x32x16_bf16 v[80:95], a[28:31], v[188:191], v[80:95]
    ds_read_b128 a[12:15], v8 offset:44032
    v_exp_f32 v255, v255
    v_mul_f32 v16, v16, v64
    v_mul_f32 v17, v17, v65
    v_mul_f32 v18, v18, v66
    s_waitcnt lgkmcnt(3)
    v_mfma_f32_32x32x16_bf16 v[32:47], a[0:3], v[192:195], v[32:47]
    ds_read_b128 a[16:19], v8 offset:45056
    buffer_load_dwordx4 a[184:187], v7, s[20:23], s69 offen offset:2048
    v_mul_f32 v19, v19, v67
    v_mul_f32 v20, v20, v68
    v_mul_f32 v21, v21, v69
    v_mul_f32 v22, v22, v70
    s_waitcnt lgkmcnt(3)
    v_mfma_f32_32x32x16_bf16 v[80:95], a[4:7], v[192:195], v[80:95]
    ds_read_b128 a[20:23], v8 offset:46080
    v_mul_f32 v23, v23, v71
    v_mul_f32 v24, v24, v72
    v_mul_f32 v25, v25, v73
    v_mul_f32 v26, v26, v74
    s_waitcnt lgkmcnt(3)
    v_mfma_f32_32x32x16_bf16 v[32:47], a[8:11], v[196:199], v[32:47]
    ds_read_b128 a[24:27], v8 offset:47104
    buffer_load_dwordx4 a[188:191], v7, s[20:23], s69 offen offset:3072
    v_mul_f32 v27, v27, v75
    v_mul_f32 v28, v28, v76
    v_mul_f32 v29, v29, v77
    v_mul_f32 v30, v30, v78
    s_waitcnt lgkmcnt(3)
    v_mfma_f32_32x32x16_bf16 v[80:95], a[12:15], v[196:199], v[80:95]
    ds_read_b128 a[28:31], v8 offset:48128
    v_mul_f32 v31, v31, v79
    v_add_f32 v240, 1.0, v240
    v_add_f32 v241, 1.0, v241
    v_add_f32 v242, 1.0, v242
    s_waitcnt lgkmcnt(3)
    v_mfma_f32_32x32x16_bf16 v[32:47], a[16:19], v[200:203], v[32:47]
    ds_read_b128 a[0:3], v8 offset:49152
    s_add_u32 s69, s35, 40960
    buffer_load_dwordx4 a[192:195], v7, s[20:23], s69 offen offset:0
    v_add_f32 v243, 1.0, v243
    v_add_f32 v244, 1.0, v244
    v_add_f32 v245, 1.0, v245
    v_add_f32 v246, 1.0, v246
    s_waitcnt lgkmcnt(3)
    v_mfma_f32_32x32x16_bf16 v[80:95], a[20:23], v[200:203], v[80:95]
    ds_read_b128 a[4:7], v8 offset:50176
    v_add_f32 v247, 1.0, v247
    v_add_f32 v248, 1.0, v248
    v_add_f32 v249, 1.0, v249
    v_add_f32 v250, 1.0, v250
    s_waitcnt lgkmcnt(3)
    v_mfma_f32_32x32x16_bf16 v[32:47], a[24:27], v[204:207], v[32:47]
    ds_read_b128 a[8:11], v8 offset:51200
    buffer_load_dwordx4 a[196:199], v7, s[20:23], s69 offen offset:1024
    v_add_f32 v251, 1.0, v251
    v_add_f32 v252, 1.0, v252
    v_add_f32 v253, 1.0, v253
    v_add_f32 v254, 1.0, v254
    s_waitcnt lgkmcnt(3)
    v_mfma_f32_32x32x16_bf16 v[80:95], a[28:31], v[204:207], v[80:95]
    ds_read_b128 a[12:15], v8 offset:52224
    v_add_f32 v255, 1.0, v255
    v_rcp_f32 v240, v240
    v_rcp_f32 v241, v241
    v_rcp_f32 v242, v242
    s_waitcnt lgkmcnt(3)
    v_mfma_f32_32x32x16_bf16 v[32:47], a[0:3], v[208:211], v[32:47]
    ds_read_b128 a[16:19], v8 offset:53248
    buffer_load_dwordx4 a[200:203], v7, s[20:23], s69 offen offset:2048
    v_rcp_f32 v243, v243
    v_rcp_f32 v244, v244
    v_rcp_f32 v245, v245
    v_rcp_f32 v246, v246
    s_waitcnt lgkmcnt(3)
    v_mfma_f32_32x32x16_bf16 v[80:95], a[4:7], v[208:211], v[80:95]
    ds_read_b128 a[20:23], v8 offset:54272
    v_rcp_f32 v247, v247
    v_rcp_f32 v248, v248
    v_rcp_f32 v249, v249
    v_rcp_f32 v250, v250
    s_waitcnt lgkmcnt(3)
    v_mfma_f32_32x32x16_bf16 v[32:47], a[8:11], v[212:215], v[32:47]
    ds_read_b128 a[24:27], v8 offset:55296
    buffer_load_dwordx4 a[204:207], v7, s[20:23], s69 offen offset:3072
    v_rcp_f32 v251, v251
    v_rcp_f32 v252, v252
    v_rcp_f32 v253, v253
    v_rcp_f32 v254, v254
    s_waitcnt lgkmcnt(3)
    v_mfma_f32_32x32x16_bf16 v[80:95], a[12:15], v[212:215], v[80:95]
    ds_read_b128 a[28:31], v8 offset:56320
    v_rcp_f32 v255, v255
    v_mul_f32 v16, v16, v240
    v_mul_f32 v17, v17, v241
    v_mul_f32 v18, v18, v242
    s_waitcnt lgkmcnt(3)
    v_mfma_f32_32x32x16_bf16 v[32:47], a[16:19], v[216:219], v[32:47]
    ds_read_b128 a[0:3], v8 offset:57344
    v_mul_f32 v19, v19, v243
    v_mul_f32 v20, v20, v244
    v_mul_f32 v21, v21, v245
    v_mul_f32 v22, v22, v246
    s_waitcnt lgkmcnt(3)
    v_mfma_f32_32x32x16_bf16 v[80:95], a[20:23], v[216:219], v[80:95]
    ds_read_b128 a[4:7], v8 offset:58368
    v_mul_f32 v23, v23, v247
    v_mul_f32 v24, v24, v248
    v_mul_f32 v25, v25, v249
    v_mul_f32 v26, v26, v250
    s_waitcnt lgkmcnt(3)
    v_mfma_f32_32x32x16_bf16 v[32:47], a[24:27], v[220:223], v[32:47]
    ds_read_b128 a[8:11], v8 offset:59392
    v_mul_f32 v27, v27, v251
    v_mul_f32 v28, v28, v252
    v_mul_f32 v29, v29, v253
    v_mul_f32 v30, v30, v254
    s_waitcnt lgkmcnt(3)
    v_mfma_f32_32x32x16_bf16 v[80:95], a[28:31], v[220:223], v[80:95]
    ds_read_b128 a[12:15], v8 offset:60416
    v_mul_f32 v31, v31, v255
    v_cvt_pk_bf16_f32 v16, v16, v17
    v_cvt_pk_bf16_f32 v17, v18, v19
    v_cvt_pk_bf16_f32 v18, v20, v21
    s_waitcnt lgkmcnt(3)
    v_mfma_f32_32x32x16_bf16 v[32:47], a[0:3], v[224:227], v[32:47]
    ds_read_b128 a[16:19], v8 offset:61440
    v_cvt_pk_bf16_f32 v19, v22, v23
    v_cvt_pk_bf16_f32 v20, v24, v25
    v_cvt_pk_bf16_f32 v21, v26, v27
    v_cvt_pk_bf16_f32 v22, v28, v29
    s_waitcnt lgkmcnt(3)
    v_mfma_f32_32x32x16_bf16 v[80:95], a[4:7], v[224:227], v[80:95]
    ds_read_b128 a[20:23], v8 offset:62464
    v_cvt_pk_bf16_f32 v23, v30, v31
    s_nop 1
    v_permlane32_swap_b32 v16, v18
    v_permlane32_swap_b32 v17, v19
    s_waitcnt lgkmcnt(3)
    v_mfma_f32_32x32x16_bf16 v[32:47], a[8:11], v[228:231], v[32:47]
    ds_read_b128 a[24:27], v8 offset:63488
    v_permlane32_swap_b32 v20, v22
    v_permlane32_swap_b32 v21, v23
    s_nop 1
    buffer_store_dwordx4 v[16:19], v7, s[20:23], s59 offen offset:0 sc1
    s_waitcnt lgkmcnt(3)
    v_mfma_f32_32x32x16_bf16 v[80:95], a[12:15], v[228:231], v[80:95]
    ds_read_b128 a[28:31], v8 offset:64512
    buffer_store_dwordx4 v[20:23], v7, s[20:23], s59 offen offset:1024 sc1
    s_waitcnt vmcnt(22)
    s_barrier
    s_waitcnt lgkmcnt(3)
    v_mfma_f32_32x32x16_bf16 v[32:47], a[16:19], v[232:235], v[32:47]
    ds_read_b128 a[0:3], v9 offset:0
    s_waitcnt lgkmcnt(3)
    v_mfma_f32_32x32x16_bf16 v[80:95], a[20:23], v[232:235], v[80:95]
    ds_read_b128 a[4:7], v9 offset:1024
    s_waitcnt lgkmcnt(3)
    v_mfma_f32_32x32x16_bf16 v[32:47], a[24:27], v[236:239], v[32:47]
    ds_read_b128 a[8:11], v9 offset:2048
    s_waitcnt lgkmcnt(3)
    v_mfma_f32_32x32x16_bf16 v[80:95], a[28:31], v[236:239], v[80:95]
    ds_read_b128 a[12:15], v9 offset:3072
    s_nop 15
    v_mul_f32 v240, s60, v32
    v_mul_f32 v241, s60, v33
    v_mul_f32 v242, s60, v34
    s_cmp_eq_u32 s49, 14
    s_cbranch_scc1 ffn_dend8
    s_waitcnt lgkmcnt(3)
    v_mfma_f32_32x32x16_bf16 v[48:63], a[0:3], v[176:179], v[48:63]
    ds_read_b128 a[16:19], v9 offset:4096
    v_mul_f32 v243, s60, v35
    v_mul_f32 v244, s60, v36
    v_mul_f32 v245, s60, v37
    v_mul_f32 v246, s60, v38
    s_waitcnt lgkmcnt(3)
    v_mfma_f32_32x32x16_bf16 v[96:111], a[4:7], v[176:179], v[96:111]
    ds_read_b128 a[20:23], v9 offset:5120
    v_mul_f32 v247, s60, v39
    v_mul_f32 v248, s60, v40
    v_mul_f32 v249, s60, v41
    v_mul_f32 v250, s60, v42
    s_waitcnt lgkmcnt(3)
    v_mfma_f32_32x32x16_bf16 v[48:63], a[8:11], v[180:183], v[48:63]
    ds_read_b128 a[24:27], v9 offset:6144
    v_mul_f32 v251, s60, v43
    v_mul_f32 v252, s60, v44
    v_mul_f32 v253, s60, v45
    v_mul_f32 v254, s60, v46
    s_waitcnt lgkmcnt(3)
    v_mfma_f32_32x32x16_bf16 v[96:111], a[12:15], v[180:183], v[96:111]
    ds_read_b128 a[28:31], v9 offset:7168
    v_mul_f32 v255, s60, v47
    v_exp_f32 v240, v240
    v_exp_f32 v241, v241
    v_exp_f32 v242, v242
    s_waitcnt lgkmcnt(3)
    v_mfma_f32_32x32x16_bf16 v[48:63], a[16:19], v[184:187], v[48:63]
    ds_read_b128 a[0:3], v9 offset:8192
    v_exp_f32 v243, v243
    v_exp_f32 v244, v244
    v_exp_f32 v245, v245
    v_exp_f32 v246, v246
    s_waitcnt lgkmcnt(3)
    v_mfma_f32_32x32x16_bf16 v[96:111], a[20:23], v[184:187], v[96:111]
    ds_read_b128 a[4:7], v9 offset:9216
    v_exp_f32 v247, v247
    v_exp_f32 v248, v248
    v_exp_f32 v249, v249
    v_exp_f32 v250, v250
    s_waitcnt lgkmcnt(3)
    v_mfma_f32_32x32x16_bf16 v[48:63], a[24:27], v[188:191], v[48:63]
    ds_read_b128 a[8:11], v9 offset:10240
    v_exp_f32 v251, v251
    v_exp_f32 v252, v252
    v_exp_f32 v253, v253
    v_exp_f32 v254, v254
    s_waitcnt lgkmcnt(3)
    v_mfma_f32_32x32x16_bf16 v[96:111], a[28:31], v[188:191], v[96:111]
    ds_read_b128 a[12:15], v9 offset:11264
    v_exp_f32 v255, v255
    v_mul_f32 v32, v32, v80
    v_mul_f32 v33, v33, v81
    v_mul_f32 v34, v34, v82
    s_waitcnt lgkmcnt(3)
    v_mfma_f32_32x32x16_bf16 v[48:63], a[0:3], v[192:195], v[48:63]
    ds_read_b128 a[16:19], v9 offset:12288
    v_mul_f32 v35, v35, v83
    v_mul_f32 v36, v36, v84
    v_mul_f32 v37, v37, v85
    v_mul_f32 v38, v38, v86
    s_waitcnt lgkmcnt(3)
    v_mfma_f32_32x32x16_bf16 v[96:111], a[4:7], v[192:195], v[96:111]
    ds_read_b128 a[20:23], v9 offset:13312
    v_mul_f32 v39, v39, v87
    v_mul_f32 v40, v40, v88
    v_mul_f32 v41, v41, v89
    v_mul_f32 v42, v42, v90
    s_waitcnt lgkmcnt(3)
    v_mfma_f32_32x32x16_bf16 v[48:63], a[8:11], v[196:199], v[48:63]
    ds_read_b128 a[24:27], v9 offset:14336
    v_mul_f32 v43, v43, v91
    v_mul_f32 v44, v44, v92
    v_mul_f32 v45, v45, v93
    v_mul_f32 v46, v46, v94
    s_waitcnt lgkmcnt(3)
    v_mfma_f32_32x32x16_bf16 v[96:111], a[12:15], v[196:199], v[96:111]
    ds_read_b128 a[28:31], v9 offset:15360
    v_mul_f32 v47, v47, v95
    v_add_f32 v240, 1.0, v240
    v_add_f32 v241, 1.0, v241
    v_add_f32 v242, 1.0, v242
    s_waitcnt lgkmcnt(3)
    v_mfma_f32_32x32x16_bf16 v[48:63], a[16:19], v[200:203], v[48:63]
    ds_read_b128 a[0:3], v9 offset:16384
    v_add_f32 v243, 1.0, v243
    v_add_f32 v244, 1.0, v244
    v_add_f32 v245, 1.0, v245
    v_add_f32 v246, 1.0, v246
    s_waitcnt lgkmcnt(3)
    v_mfma_f32_32x32x16_bf16 v[96:111], a[20:23], v[200:203], v[96:111]
    ds_read_b128 a[4:7], v9 offset:17408
    v_add_f32 v247, 1.0, v247
    v_add_f32 v248, 1.0, v248
    v_add_f32 v249, 1.0, v249
    v_add_f32 v250, 1.0, v250
    s_waitcnt lgkmcnt(3)
    v_mfma_f32_32x32x16_bf16 v[48:63], a[24:27], v[204:207], v[48:63]
    ds_read_b128 a[8:11], v9 offset:18432
    v_add_f32 v251, 1.0, v251
    v_add_f32 v252, 1.0, v252
    v_add_f32 v253, 1.0, v253
    v_add_f32 v254, 1.0, v254
    s_waitcnt lgkmcnt(3)
    v_mfma_f32_32x32x16_bf16 v[96:111], a[28:31], v[204:207], v[96:111]
    ds_read_b128 a[12:15], v9 offset:19456
    v_add_f32 v255, 1.0, v255
    v_rcp_f32 v240, v240
    v_rcp_f32 v241, v241
    v_rcp_f32 v242, v242
    s_waitcnt lgkmcnt(3)
    v_mfma_f32_32x32x16_bf16 v[48:63], a[0:3], v[208:211], v[48:63]
    ds_read_b128 a[16:19], v9 offset:20480
    v_rcp_f32 v243, v243
    v_rcp_f32 v244, v244
    v_rcp_f32 v245, v245
    v_rcp_f32 v246, v246
    s_waitcnt lgkmcnt(3)
    v_mfma_f32_32x32x16_bf16 v[96:111], a[4:7], v[208:211], v[96:111]
    ds_read_b128 a[20:23], v9 offset:21504
    v_rcp_f32 v247, v247
    v_rcp_f32 v248, v248
    v_rcp_f32 v249, v249
    v_rcp_f32 v250, v250
    s_waitcnt lgkmcnt(3)
    v_mfma_f32_32x32x16_bf16 v[48:63], a[8:11], v[212:215], v[48:63]
    ds_read_b128 a[24:27], v9 offset:22528
    v_rcp_f32 v251, v251
    v_rcp_f32 v252, v252
    v_rcp_f32 v253, v253
    v_rcp_f32 v254, v254
    s_waitcnt lgkmcnt(3)
    v_mfma_f32_32x32x16_bf16 v[96:111], a[12:15], v[212:215], v[96:111]
    ds_read_b128 a[28:31], v9 offset:23552
    v_rcp_f32 v255, v255
    v_mul_f32 v32, v32, v240
    v_mul_f32 v33, v33, v241
    v_mul_f32 v34, v34, v242
    s_waitcnt lgkmcnt(3)
    v_mfma_f32_32x32x16_bf16 v[48:63], a[16:19], v[216:219], v[48:63]
    ds_read_b128 a[0:3], v9 offset:24576
    v_mul_f32 v35, v35, v243
    v_mul_f32 v36, v36, v244
    v_mul_f32 v37, v37, v245
    v_mul_f32 v38, v38, v246
    s_waitcnt lgkmcnt(3)
    v_mfma_f32_32x32x16_bf16 v[96:111], a[20:23], v[216:219], v[96:111]
    ds_read_b128 a[4:7], v9 offset:25600
    v_mul_f32 v39, v39, v247
    v_mul_f32 v40, v40, v248
    v_mul_f32 v41, v41, v249
    v_mul_f32 v42, v42, v250
    s_waitcnt lgkmcnt(3)
    v_mfma_f32_32x32x16_bf16 v[48:63], a[24:27], v[220:223], v[48:63]
    ds_read_b128 a[8:11], v9 offset:26624
    v_mul_f32 v43, v43, v251
    v_mul_f32 v44, v44, v252
    v_mul_f32 v45, v45, v253
    v_mul_f32 v46, v46, v254
    s_waitcnt lgkmcnt(3)
    v_mfma_f32_32x32x16_bf16 v[96:111], a[28:31], v[220:223], v[96:111]
    ds_read_b128 a[12:15], v9 offset:27648
    v_mul_f32 v47, v47, v255
    v_cvt_pk_bf16_f32 v32, v32, v33
    v_cvt_pk_bf16_f32 v33, v34, v35
    v_cvt_pk_bf16_f32 v34, v36, v37
    s_waitcnt lgkmcnt(3)
    v_mfma_f32_32x32x16_bf16 v[48:63], a[0:3], v[224:227], v[48:63]
    ds_read_b128 a[16:19], v9 offset:28672
    v_cvt_pk_bf16_f32 v35, v38, v39
    v_cvt_pk_bf16_f32 v36, v40, v41
    v_cvt_pk_bf16_f32 v37, v42, v43
    v_cvt_pk_bf16_f32 v38, v44, v45
    s_waitcnt lgkmcnt(3)
    v_mfma_f32_32x32x16_bf16 v[96:111], a[4:7], v[224:227], v[96:111]
    ds_read_b128 a[20:23], v9 offset:29696
    v_cvt_pk_bf16_f32 v39, v46, v47
    s_nop 1
    v_permlane32_swap_b32 v32, v34
    v_permlane32_swap_b32 v33, v35
    s_waitcnt lgkmcnt(3)
    v_mfma_f32_32x32x16_bf16 v[48:63], a[8:11], v[228:231], v[48:63]
    ds_read_b128 a[24:27], v9 offset:30720
    v_permlane32_swap_b32 v36, v38
    v_permlane32_swap_b32 v37, v39
    s_nop 1
    buffer_store_dwordx4 v[32:35], v7, s[20:23], s58 offen offset:0 sc1
    s_waitcnt lgkmcnt(3)
    v_mfma_f32_32x32x16_bf16 v[96:111], a[12:15], v[228:231], v[96:111]
    ds_read_b128 a[28:31], v9 offset:31744
    buffer_store_dwordx4 v[36:39], v7, s[20:23], s58 offen offset:1024 sc1
    s_waitcnt lgkmcnt(3)
    v_mfma_f32_32x32x16_bf16 v[48:63], a[16:19], v[232:235], v[48:63]
    s_waitcnt lgkmcnt(2)
    v_mfma_f32_32x32x16_bf16 v[96:111], a[20:23], v[232:235], v[96:111]
    s_waitcnt lgkmcnt(1)
    v_mfma_f32_32x32x16_bf16 v[48:63], a[24:27], v[236:239], v[48:63]
    s_waitcnt lgkmcnt(0)
    v_mfma_f32_32x32x16_bf16 v[96:111], a[28:31], v[236:239], v[96:111]
    s_nop 15
    v_mul_f32 v240, s60, v48
    v_mul_f32 v241, s60, v49
    v_mul_f32 v242, s60, v50
    v_mul_f32 v243, s60, v51
    v_mul_f32 v244, s60, v52
    v_mul_f32 v245, s60, v53
    v_mul_f32 v246, s60, v54
    v_mul_f32 v247, s60, v55
    v_mul_f32 v248, s60, v56
    v_mul_f32 v249, s60, v57
    v_mul_f32 v250, s60, v58
    v_mul_f32 v251, s60, v59
    v_mul_f32 v252, s60, v60
    v_mul_f32 v253, s60, v61
    v_mul_f32 v254, s60, v62
    v_mul_f32 v255, s60, v63
    v_exp_f32 v240, v240
    v_exp_f32 v241, v241
    v_exp_f32 v242, v242
    v_exp_f32 v243, v243
    v_exp_f32 v244, v244
    v_exp_f32 v245, v245
    v_exp_f32 v246, v246
    v_exp_f32 v247, v247
    v_exp_f32 v248, v248
    v_exp_f32 v249, v249
    v_exp_f32 v250, v250
    v_exp_f32 v251, v251
    v_exp_f32 v252, v252
    v_exp_f32 v253, v253
    v_exp_f32 v254, v254
    v_exp_f32 v255, v255
    v_mul_f32 v48, v48, v96
    v_mul_f32 v49, v49, v97
    v_mul_f32 v50, v50, v98
    v_mul_f32 v51, v51, v99
    v_mul_f32 v52, v52, v100
    v_mul_f32 v53, v53, v101
    v_mul_f32 v54, v54, v102
    v_mul_f32 v55, v55, v103
    v_mul_f32 v56, v56, v104
    v_mul_f32 v57, v57, v105
    v_mul_f32 v58, v58, v106
    v_mul_f32 v59, v59, v107
    v_mul_f32 v60, v60, v108
    v_mul_f32 v61, v61, v109
    v_mul_f32 v62, v62, v110
    v_mul_f32 v63, v63, v111
    v_add_f32 v240, 1.0, v240
    v_add_f32 v241, 1.0, v241
    v_add_f32 v242, 1.0, v242
    v_add_f32 v243, 1.0, v243
    v_add_f32 v244, 1.0, v244
    v_add_f32 v245, 1.0, v245
    v_add_f32 v246, 1.0, v246
    v_add_f32 v247, 1.0, v247
    v_add_f32 v248, 1.0, v248
    v_add_f32 v249, 1.0, v249
    v_add_f32 v250, 1.0, v250
    v_add_f32 v251, 1.0, v251
    v_add_f32 v252, 1.0, v252
    v_add_f32 v253, 1.0, v253
    v_add_f32 v254, 1.0, v254
    v_add_f32 v255, 1.0, v255
    v_rcp_f32 v240, v240
    v_rcp_f32 v241, v241
    v_rcp_f32 v242, v242
    v_rcp_f32 v243, v243
    v_rcp_f32 v244, v244
    v_rcp_f32 v245, v245
    v_rcp_f32 v246, v246
    v_rcp_f32 v247, v247
    v_rcp_f32 v248, v248
    v_rcp_f32 v249, v249
    v_rcp_f32 v250, v250
    v_rcp_f32 v251, v251
    v_rcp_f32 v252, v252
    v_rcp_f32 v253, v253
    v_rcp_f32 v254, v254
    v_rcp_f32 v255, v255
    v_mul_f32 v48, v48, v240
    v_mul_f32 v49, v49, v241
    v_mul_f32 v50, v50, v242
    v_mul_f32 v51, v51, v243
    v_mul_f32 v52, v52, v244
    v_mul_f32 v53, v53, v245
    v_mul_f32 v54, v54, v246
    v_mul_f32 v55, v55, v247
    v_mul_f32 v56, v56, v248
    v_mul_f32 v57, v57, v249
    v_mul_f32 v58, v58, v250
    v_mul_f32 v59, v59, v251
    v_mul_f32 v60, v60, v252
    v_mul_f32 v61, v61, v253
    v_mul_f32 v62, v62, v254
    v_mul_f32 v63, v63, v255
    v_cvt_pk_bf16_f32 v48, v48, v49
    v_cvt_pk_bf16_f32 v49, v50, v51
    v_cvt_pk_bf16_f32 v50, v52, v53
    v_cvt_pk_bf16_f32 v51, v54, v55
    v_cvt_pk_bf16_f32 v52, v56, v57
    v_cvt_pk_bf16_f32 v53, v58, v59
    v_cvt_pk_bf16_f32 v54, v60, v61
    v_cvt_pk_bf16_f32 v55, v62, v63
    s_nop 1
    v_permlane32_swap_b32 v48, v50
    v_permlane32_swap_b32 v49, v51
    v_permlane32_swap_b32 v52, v54
    v_permlane32_swap_b32 v53, v55
    s_nop 1
    buffer_store_dwordx4 v[48:51], v7, s[20:23], s64 offen offset:0 sc1
    buffer_store_dwordx4 v[52:55], v7, s[20:23], s64 offen offset:1024 sc1
    s_branch ffn_dend8
ffn_idle7:
    v_lshlrev_b32 v7, 4, v1
    s_waitcnt vmcnt(0)
    s_barrier
    s_add_u32 s69, s35, 0
    buffer_load_dwordx4 a[32:35], v7, s[20:23], s69 offen offset:0
    buffer_load_dwordx4 a[36:39], v7, s[20:23], s69 offen offset:1024
    buffer_load_dwordx4 a[40:43], v7, s[20:23], s69 offen offset:2048
    buffer_load_dwordx4 a[44:47], v7, s[20:23], s69 offen offset:3072
    s_add_u32 s69, s35, 4096
    buffer_load_dwordx4 a[48:51], v7, s[20:23], s69 offen offset:0
    buffer_load_dwordx4 a[52:55], v7, s[20:23], s69 offen offset:1024
    buffer_load_dwordx4 a[56:59], v7, s[20:23], s69 offen offset:2048
    buffer_load_dwordx4 a[60:63], v7, s[20:23], s69 offen offset:3072
    s_add_u32 s69, s35, 8192
    buffer_load_dwordx4 a[64:67], v7, s[20:23], s69 offen offset:0
    buffer_load_dwordx4 a[68:71], v7, s[20:23], s69 offen offset:1024
    buffer_load_dwordx4 a[72:75], v7, s[20:23], s69 offen offset:2048
    buffer_load_dwordx4 a[76:79], v7, s[20:23], s69 offen offset:3072
    s_add_u32 s69, s35, 12288
    buffer_load_dwordx4 a[80:83], v7, s[20:23], s69 offen offset:0
    buffer_load_dwordx4 a[84:87], v7, s[20:23], s69 offen offset:1024
    buffer_load_dwordx4 a[88:91], v7, s[20:23], s69 offen offset:2048
    buffer_load_dwordx4 a[92:95], v7, s[20:23], s69 offen offset:3072
    s_add_u32 s69, s35, 16384
    buffer_load_dwordx4 a[96:99], v7, s[20:23], s69 offen offset:0
    buffer_load_dwordx4 a[100:103], v7, s[20:23], s69 offen offset:1024
    buffer_load_dwordx4 a[104:107], v7, s[20:23], s69 offen offset:2048
    buffer_load_dwordx4 a[108:111], v7, s[20:23], s69 offen offset:3072
    s_add_u32 s69, s35, 20480
    buffer_load_dwordx4 a[112:115], v7, s[20:23], s69 offen offset:0
    buffer_load_dwordx4 a[116:119], v7, s[20:23], s69 offen offset:1024
    buffer_load_dwordx4 a[120:123], v7, s[20:23], s69 offen offset:2048
    buffer_load_dwordx4 a[124:127], v7, s[20:23], s69 offen offset:3072
    s_add_u32 s69, s35, 24576
    buffer_load_dwordx4 a[128:131], v7, s[20:23], s69 offen offset:0
    buffer_load_dwordx4 a[132:135], v7, s[20:23], s69 offen offset:1024
    buffer_load_dwordx4 a[136:139], v7, s[20:23], s69 offen offset:2048
    buffer_load_dwordx4 a[140:143], v7, s[20:23], s69 offen offset:3072
    s_add_u32 s69, s35, 28672
    buffer_load_dwordx4 a[144:147], v7, s[20:23], s69 offen offset:0
    buffer_load_dwordx4 a[148:151], v7, s[20:23], s69 offen offset:1024
    buffer_load_dwordx4 a[152:155], v7, s[20:23], s69 offen offset:2048
    buffer_load_dwordx4 a[156:159], v7, s[20:23], s69 offen offset:3072
    s_add_u32 s69, s35, 32768
    buffer_load_dwordx4 a[160:163], v7, s[20:23], s69 offen offset:0
    buffer_load_dwordx4 a[164:167], v7, s[20:23], s69 offen offset:1024
    buffer_load_dwordx4 a[168:171], v7, s[20:23], s69 offen offset:2048
    buffer_load_dwordx4 a[172:175], v7, s[20:23], s69 offen offset:3072
    s_add_u32 s69, s35, 36864
    buffer_load_dwordx4 a[176:179], v7, s[20:23], s69 offen offset:0
    buffer_load_dwordx4 a[180:183], v7, s[20:23], s69 offen offset:1024
    buffer_load_dwordx4 a[184:187], v7, s[20:23], s69 offen offset:2048
    buffer_load_dwordx4 a[188:191], v7, s[20:23], s69 offen offset:3072
    s_add_u32 s69, s35, 40960
    buffer_load_dwordx4 a[192:195], v7, s[20:23], s69 offen offset:0
    buffer_load_dwordx4 a[196:199], v7, s[20:23], s69 offen offset:1024
    buffer_load_dwordx4 a[200:203], v7, s[20:23], s69 offen offset:2048
    buffer_load_dwordx4 a[204:207], v7, s[20:23], s69 offen offset:3072
ffn_dend8:
    s_mov_b32 s37, s49
    s_mov_b32 s48, s30
    s_mov_b32 s49, s31
    s_and_b32 s56, s3, 1
    s_lshr_b32 s57, s3, 1
    v_lshlrev_b32 v4, 4, v1
    s_lshl_b32 s50, s56, 13
    s_lshl_b32 s51, s57, 12
    s_add_u32 s50, s50, s51
    s_add_u32 s50, s50, 98304
    s_lshl_b32 s52, s48, 1
    s_add_u32 s52, s52, s56
    s_mul_i32 s52, s52, 88064
    s_add_u32 s52, s52, s51
    s_add_u32 s52, s52, 0x800000
    s_mul_i32 s52, s3, 22
    s_lshr_b32 s61, s3, 1
    s_and_b32 s61, s61, s3
    s_sub_u32 s52, s52, s61
    s_mul_i32 s61, s48, 172
    s_add_u32 s52, s52, s61
    s_lshl_b32 s52, s52, 10
    s_add_u32 s52, s52, 0x800000
    s_lshl_b32 s58, s48, 6
    s_lshl_b32 s59, s56, 5
    s_add_u32 s58, s58, s59
    v_and_b32 v13, 31, v1
    v_add_u32 v13, s58, v13
    v_lshrrev_b32 v8, 5, v1
    v_lshlrev_b32 v12, 3, v8
    v_lshl_add_u32 v12, v13, 10, v12
    s_lshl_b32 s59, s49, 7
    s_lshl_b32 s60, s57, 6
    s_add_u32 s59, s59, s60
    v_and_b32 v14, 31, v1
    v_lshlrev_b32 v14, 4, v14
    v_lshl_add_u32 v14, v8, 3, v14
    s_lshl_b32 s60, s48, 1
    s_add_u32 s60, s60, s56
    s_lshl_b32 s60, s60, 5
    s_lshl_b32 s61, s49, 2
    s_add_u32 s60, s60, s61
    s_lshl_b32 s61, s57, 1
    s_add_u32 s60, s60, s61
    s_lshl_b32 s60, s60, 10
    s_add_u32 s60, s60, 0x1800000
    s_lshl_b32 s61, s56, 13
    s_add_u32 s61, s61, 98304
    s_lshl_b32 s62, s57, 10
    v_add_u32 v16, s61, v4
    v_add_u32 v20, s62, v4
    v_add_u32 v21, 0x10000, v20
    s_cmp_eq_u32 s37, 15
    s_cselect_b32 s37, 0, 1
    v_mov_b32 v58, s37
    s_waitcnt vmcnt(0)
    s_barrier
    s_cmp_lg_u32 s3, 0
    s_cbranch_scc1 ffn_sk16
    s_mov_b64 exec, 1
    v_mov_b32 v56, v58
    s_cmp_eq_u32 s41, 0
    s_cbranch_scc1 ffn_sl17
    s_add_u32 s45, s42, 512
    s_add_u32 s47, s42, 4096
    s_lshl_b32 s45, s39, 7
    s_add_u32 s45, s45, s47
    s_add_u32 s47, s47, s39
    s_mov_b64 exec, 0xffff
    v_mov_b32 v56, 1
    v_lshlrev_b32 v57, 7, v1
    buffer_store_byte v56, v57, s[20:23], s47 offen
    s_branch ffn_dn18
ffn_sl17:
    s_add_u32 s45, s42, 256
    buffer_wbl2 sc1
    s_waitcnt vmcnt(0)
    buffer_atomic_add v56, off, s[20:23], s45 sc1
ffn_dn18:
    s_mov_b64 exec, -1
ffn_sk16:
    s_cmp_lg_u32 s3, 0
    s_cbranch_scc1 ffn_sk19
    s_mov_b64 exec, 1
    s_mov_b32 s44, 0x8000
    s_cmp_eq_u32 s41, 0
    s_cbranch_scc1 ffn_sl20
ffn_pf22:
    s_load_dwordx4 s[8:11], s[32:33], s45 glc
    s_waitcnt lgkmcnt(0)
    s_and_b32 s8, s8, s9
    s_and_b32 s10, s10, s11
    s_and_b32 s8, s8, s10
    s_cmp_eq_u32 s8, 0x01010101
    s_cselect_b32 s46, 64, 0
    s_sub_u32 s44, s44, 1
    s_cmp_eq_u32 s44, 0
    s_cbranch_scc1 ffn_dn21
    s_cmp_lt_u32 s46, 15
    s_cbranch_scc1 ffn_pf22
    s_branch ffn_dn21
ffn_sl20:
ffn_ps23:
    buffer_load_dword v57, off, s[20:23], s45 sc1
    s_waitcnt vmcnt(0)
    v_readfirstlane_b32 s46, v57
    s_sub_u32 s44, s44, 1
    s_cmp_eq_u32 s44, 0
    s_cbranch_scc1 ffn_dn21
    s_cmp_lt_u32 s46, 15
    s_cbranch_scc1 ffn_ps23
ffn_dn21:
    s_mov_b64 exec, -1
ffn_sk19:
    buffer_load_dwordx2 v[96:97], v14, s[20:23], s60 offen offset:0
    buffer_load_dwordx2 v[98:99], v14, s[20:23], s60 offen offset:512
    buffer_load_dwordx2 v[100:101], v14, s[20:23], s60 offen offset:1024
    buffer_load_dwordx2 v[102:103], v14, s[20:23], s60 offen offset:1536
    s_barrier
    s_cmp_lg_u32 s41, 0
    s_cbranch_scc1 ffn_nf24
    buffer_inv sc1
    s_waitcnt vmcnt(0)
ffn_nf24:
    s_add_u32 s54, s52, 0
    buffer_load_dwordx4 v[104:107], v4, s[20:23], s54 offen offset:0
    s_add_u32 s55, s52, 88064
    buffer_load_dwordx4 v[108:111], v4, s[20:23], s55 offen offset:0
    buffer_load_dwordx4 v[112:115], v4, s[20:23], s54 offen offset:1024
    buffer_load_dwordx4 v[116:119], v4, s[20:23], s55 offen offset:1024
    buffer_load_dwordx4 v[120:123], v4, s[20:23], s54 offen offset:2048
    buffer_load_dwordx4 v[124:127], v4, s[20:23], s55 offen offset:2048
    buffer_load_dwordx4 v[128:131], v4, s[20:23], s54 offen offset:3072
    buffer_load_dwordx4 v[132:135], v4, s[20:23], s55 offen offset:3072
    s_add_u32 s54, s52, 4096
    buffer_load_dwordx4 v[136:139], v4, s[20:23], s54 offen offset:0
    s_add_u32 s55, s52, 92160
    buffer_load_dwordx4 v[140:143], v4, s[20:23], s55 offen offset:0
    buffer_load_dwordx4 v[144:147], v4, s[20:23], s54 offen offset:1024
    buffer_load_dwordx4 v[148:151], v4, s[20:23], s55 offen offset:1024
    s_sub_u32 s61, s3, 1
    s_and_b32 s61, s61, 3
    s_lshl_b32 s61, s61, 12
    s_add_u32 s61, s61, 0
    v_add_u32 v20, s61, v4
    s_sub_u32 s61, s3, 2
    s_and_b32 s61, s61, 3
    s_lshl_b32 s61, s61, 12
    s_add_u32 s61, s61, 12288
    v_add_u32 v21, s61, v4
    s_sub_u32 s61, s3, 3
    s_and_b32 s61, s61, 3
    s_lshl_b32 s61, s61, 12
    s_add_u32 s61, s61, 24576
    v_add_u32 v22, s61, v4
    s_sub_u32 s61, s3, 4
    s_and_b32 s61, s61, 3
    s_lshl_b32 s61, s61, 12
    s_add_u32 s61, s61, 36864
    v_add_u32 v23, s61, v4
    s_mul_i32 s61, s3, 12288
    v_add_u32 v24, s61, v4
    s_waitcnt vmcnt(11)
    v_mfma_f32_32x32x16_bf16 v[32:47], a[32:35], v[104:107], 0
    buffer_load_dwordx4 v[152:155], v4, s[20:23], s54 offen offset:2048
    v_mfma_f32_32x32x16_bf16 v[64:79], a[36:39], v[104:107], 0
    s_waitcnt vmcnt(11)
    v_mfma_f32_32x32x16_bf16 v[48:63], a[32:35], v[108:111], 0
    buffer_load_dwordx4 v[156:159], v4, s[20:23], s55 offen offset:2048
    v_mfma_f32_32x32x16_bf16 v[80:95], a[36:39], v[108:111], 0
    s_waitcnt vmcnt(11)
    v_mfma_f32_32x32x16_bf16 v[32:47], a[40:43], v[112:115], v[32:47]
    buffer_load_dwordx4 v[160:163], v4, s[20:23], s54 offen offset:3072
    v_mfma_f32_32x32x16_bf16 v[64:79], a[44:47], v[112:115], v[64:79]
    s_waitcnt vmcnt(11)
    v_mfma_f32_32x32x16_bf16 v[48:63], a[40:43], v[116:119], v[48:63]
    buffer_load_dwordx4 v[164:167], v4, s[20:23], s55 offen offset:3072
    v_mfma_f32_32x32x16_bf16 v[80:95], a[44:47], v[116:119], v[80:95]
    s_waitcnt vmcnt(11)
    v_mfma_f32_32x32x16_bf16 v[32:47], a[48:51], v[120:123], v[32:47]
    s_add_u32 s54, s52, 8192
    buffer_load_dwordx4 v[168:171], v4, s[20:23], s54 offen offset:0
    v_mfma_f32_32x32x16_bf16 v[64:79], a[52:55], v[120:123], v[64:79]
    s_waitcnt vmcnt(11)
    v_mfma_f32_32x32x16_bf16 v[48:63], a[48:51], v[124:127], v[48:63]
    s_add_u32 s55, s52, 96256
    buffer_load_dwordx4 v[172:175], v4, s[20:23], s55 offen offset:0
    v_mfma_f32_32x32x16_bf16 v[80:95], a[52:55], v[124:127], v[80:95]
    s_waitcnt vmcnt(11)
    v_mfma_f32_32x32x16_bf16 v[32:47], a[56:59], v[128:131], v[32:47]
    buffer_load_dwordx4 v[176:179], v4, s[20:23], s54 offen offset:1024
    v_mfma_f32_32x32x16_bf16 v[64:79], a[60:63], v[128:131], v[64:79]
    s_waitcnt vmcnt(11)
    v_mfma_f32_32x32x16_bf16 v[48:63], a[56:59], v[132:135], v[48:63]
    buffer_load_dwordx4 v[180:183], v4, s[20:23], s55 offen offset:1024
    v_mfma_f32_32x32x16_bf16 v[80:95], a[60:63], v[132:135], v[80:95]
    s_waitcnt vmcnt(11)
    v_mfma_f32_32x32x16_bf16 v[32:47], a[64:67], v[136:139], v[32:47]
    buffer_load_dwordx4 v[184:187], v4, s[20:23], s54 offen offset:2048
    v_mfma_f32_32x32x16_bf16 v[64:79], a[68:71], v[136:139], v[64:79]
    s_waitcnt vmcnt(11)
    v_mfma_f32_32x32x16_bf16 v[48:63], a[64:67], v[140:143], v[48:63]
    buffer_load_dwordx4 v[188:191], v4, s[20:23], s55 offen offset:2048
    v_mfma_f32_32x32x16_bf16 v[80:95], a[68:71], v[140:143], v[80:95]
    s_waitcnt vmcnt(11)
    v_mfma_f32_32x32x16_bf16 v[32:47], a[72:75], v[144:147], v[32:47]
    buffer_load_dwordx4 v[192:195], v4, s[20:23], s54 offen offset:3072
    v_mfma_f32_32x32x16_bf16 v[64:79], a[76:79], v[144:147], v[64:79]
    s_waitcnt vmcnt(11)
    v_mfma_f32_32x32x16_bf16 v[48:63], a[72:75], v[148:151], v[48:63]
    buffer_load_dwordx4 v[196:199], v4, s[20:23], s55 offen offset:3072
    v_mfma_f32_32x32x16_bf16 v[80:95], a[76:79], v[148:151], v[80:95]
    s_waitcnt vmcnt(11)
    v_mfma_f32_32x32x16_bf16 v[32:47], a[80:83], v[152:155], v[32:47]
    s_add_u32 s54, s52, 12288
    buffer_load_dwordx4 v[200:203], v4, s[20:23], s54 offen offset:0
    v_mfma_f32_32x32x16_bf16 v[64:79], a[84:87], v[152:155], v[64:79]
    s_waitcnt vmcnt(11)
    v_mfma_f32_32x32x16_bf16 v[48:63], a[80:83], v[156:159], v[48:63]
    s_add_u32 s55, s52, 100352
    buffer_load_dwordx4 v[204:207], v4, s[20:23], s55 offen offset:0
    v_mfma_f32_32x32x16_bf16 v[80:95], a[84:87], v[156:159], v[80:95]
    s_waitcnt vmcnt(11)
    v_mfma_f32_32x32x16_bf16 v[32:47], a[88:91], v[160:163], v[32:47]
    buffer_load_dwordx4 v[208:211], v4, s[20:23], s54 offen offset:1024
    v_mfma_f32_32x32x16_bf16 v[64:79], a[92:95], v[160:163], v[64:79]
    s_waitcnt vmcnt(11)
    v_mfma_f32_32x32x16_bf16 v[48:63], a[88:91], v[164:167], v[48:63]
    buffer_load_dwordx4 v[212:215], v4, s[20:23], s55 offen offset:1024
    v_mfma_f32_32x32x16_bf16 v[80:95], a[92:95], v[164:167], v[80:95]
    s_waitcnt vmcnt(11)
    v_mfma_f32_32x32x16_bf16 v[32:47], a[96:99], v[168:171], v[32:47]
    buffer_load_dwordx4 v[216:219], v4, s[20:23], s54 offen offset:2048
    v_mfma_f32_32x32x16_bf16 v[64:79], a[100:103], v[168:171], v[64:79]
    s_waitcnt vmcnt(11)
    v_mfma_f32_32x32x16_bf16 v[48:63], a[96:99], v[172:175], v[48:63]
    buffer_load_dwordx4 v[220:223], v4, s[20:23], s55 offen offset:2048
    v_mfma_f32_32x32x16_bf16 v[80:95], a[100:103], v[172:175], v[80:95]
    s_waitcnt vmcnt(11)
    v_mfma_f32_32x32x16_bf16 v[32:47], a[104:107], v[176:179], v[32:47]
    buffer_load_dwordx4 v[224:227], v4, s[20:23], s54 offen offset:3072
    v_mfma_f32_32x32x16_bf16 v[64:79], a[108:111], v[176:179], v[64:79]
    s_waitcnt vmcnt(11)
    v_mfma_f32_32x32x16_bf16 v[48:63], a[104:107], v[180:183], v[48:63]
    buffer_load_dwordx4 v[228:231], v4, s[20:23], s55 offen offset:3072
    v_mfma_f32_32x32x16_bf16 v[80:95], a[108:111], v[180:183], v[80:95]
    s_waitcnt vmcnt(11)
    v_mfma_f32_32x32x16_bf16 v[32:47], a[112:115], v[184:187], v[32:47]
    s_add_u32 s54, s52, 16384
    buffer_load_dwordx4 v[232:235], v4, s[20:23], s54 offen offset:0
    v_mfma_f32_32x32x16_bf16 v[64:79], a[116:119], v[184:187], v[64:79]
    s_waitcnt vmcnt(11)
    v_mfma_f32_32x32x16_bf16 v[48:63], a[112:115], v[188:191], v[48:63]
    s_add_u32 s55, s52, 104448
    buffer_load_dwordx4 v[236:239], v4, s[20:23], s55 offen offset:0
    v_mfma_f32_32x32x16_bf16 v[80:95], a[116:119], v[188:191], v[80:95]
    s_waitcnt vmcnt(11)
    v_mfma_f32_32x32x16_bf16 v[32:47], a[120:123], v[192:195], v[32:47]
    buffer_load_dwordx4 v[240:243], v4, s[20:23], s54 offen offset:1024
    v_mfma_f32_32x32x16_bf16 v[64:79], a[124:127], v[192:195], v[64:79]
    s_waitcnt vmcnt(11)
    v_mfma_f32_32x32x16_bf16 v[48:63], a[120:123], v[196:199], v[48:63]
    buffer_load_dwordx4 v[244:247], v4, s[20:23], s55 offen offset:1024
    v_mfma_f32_32x32x16_bf16 v[80:95], a[124:127], v[196:199], v[80:95]
    s_waitcnt vmcnt(11)
    v_mfma_f32_32x32x16_bf16 v[32:47], a[128:131], v[200:203], v[32:47]
    buffer_load_dwordx4 v[248:251], v4, s[20:23], s54 offen offset:2048
    v_mfma_f32_32x32x16_bf16 v[64:79], a[132:135], v[200:203], v[64:79]
    s_waitcnt vmcnt(11)
    v_mfma_f32_32x32x16_bf16 v[48:63], a[128:131], v[204:207], v[48:63]
    buffer_load_dwordx4 v[252:255], v4, s[20:23], s55 offen offset:2048
    v_mfma_f32_32x32x16_bf16 v[80:95], a[132:135], v[204:207], v[80:95]
    s_waitcnt vmcnt(11)
    v_mfma_f32_32x32x16_bf16 v[32:47], a[136:139], v[208:211], v[32:47]
    buffer_load_dwordx4 a[208:211], v4, s[20:23], s54 offen offset:3072
    v_mfma_f32_32x32x16_bf16 v[64:79], a[140:143], v[208:211], v[64:79]
    s_waitcnt vmcnt(11)
    v_mfma_f32_32x32x16_bf16 v[48:63], a[136:139], v[212:215], v[48:63]
    buffer_load_dwordx4 a[212:215], v4, s[20:23], s55 offen offset:3072
    v_mfma_f32_32x32x16_bf16 v[80:95], a[140:143], v[212:215], v[80:95]
    s_waitcnt vmcnt(11)
    v_mfma_f32_32x32x16_bf16 v[32:47], a[144:147], v[216:219], v[32:47]
    s_add_u32 s54, s52, 20480
    buffer_load_dwordx4 a[216:219], v4, s[20:23], s54 offen offset:0
    v_mfma_f32_32x32x16_bf16 v[64:79], a[148:151], v[216:219], v[64:79]
    s_waitcnt vmcnt(11)
    v_mfma_f32_32x32x16_bf16 v[48:63], a[144:147], v[220:223], v[48:63]
    s_add_u32 s55, s52, 108544
    buffer_load_dwordx4 a[220:223], v4, s[20:23], s55 offen offset:0
    v_mfma_f32_32x32x16_bf16 v[80:95], a[148:151], v[220:223], v[80:95]
    s_waitcnt vmcnt(11)
    v_mfma_f32_32x32x16_bf16 v[32:47], a[152:155], v[224:227], v[32:47]
    buffer_load_dwordx4 a[224:227], v4, s[20:23], s54 offen offset:1024
    v_mfma_f32_32x32x16_bf16 v[64:79], a[156:159], v[224:227], v[64:79]
    s_waitcnt vmcnt(11)
    v_mfma_f32_32x32x16_bf16 v[48:63], a[152:155], v[228:231], v[48:63]
    buffer_load_dwordx4 a[228:231], v4, s[20:23], s55 offen offset:1024
    v_mfma_f32_32x32x16_bf16 v[80:95], a[156:159], v[228:231], v[80:95]
    s_waitcnt vmcnt(11)
    v_mfma_f32_32x32x16_bf16 v[32:47], a[160:163], v[232:235], v[32:47]
    v_mfma_f32_32x32x16_bf16 v[64:79], a[164:167], v[232:235], v[64:79]
    s_waitcnt vmcnt(10)
    v_mfma_f32_32x32x16_bf16 v[48:63], a[160:163], v[236:239], v[48:63]
    v_mfma_f32_32x32x16_bf16 v[80:95], a[164:167], v[236:239], v[80:95]
    s_waitcnt vmcnt(9)
    v_mfma_f32_32x32x16_bf16 v[32:47], a[168:171], v[240:243], v[32:47]
    v_mfma_f32_32x32x16_bf16 v[64:79], a[172:175], v[240:243], v[64:79]
    s_waitcnt vmcnt(8)
    v_mfma_f32_32x32x16_bf16 v[48:63], a[168:171], v[244:247], v[48:63]
    v_mfma_f32_32x32x16_bf16 v[80:95], a[172:175], v[244:247], v[80:95]
    s_waitcnt vmcnt(7)
    v_mfma_f32_32x32x16_bf16 v[32:47], a[176:179], v[248:251], v[32:47]
    v_mfma_f32_32x32x16_bf16 v[64:79], a[180:183], v[248:251], v[64:79]
    s_waitcnt vmcnt(6)
    v_mfma_f32_32x32x16_bf16 v[48:63], a[176:179], v[252:255], v[48:63]
    v_mfma_f32_32x32x16_bf16 v[80:95], a[180:183], v[252:255], v[80:95]
    s_waitcnt vmcnt(5)
    v_mfma_f32_32x32x16_bf16 v[32:47], a[184:187], a[208:211], v[32:47]
    v_mfma_f32_32x32x16_bf16 v[64:79], a[188:191], a[208:211], v[64:79]
    s_waitcnt vmcnt(4)
    v_mfma_f32_32x32x16_bf16 v[48:63], a[184:187], a[212:215], v[48:63]
    v_mfma_f32_32x32x16_bf16 v[80:95], a[188:191], a[212:215], v[80:95]
    s_waitcnt vmcnt(3)
    v_mfma_f32_32x32x16_bf16 v[32:47], a[192:195], a[216:219], v[32:47]
    v_mfma_f32_32x32x16_bf16 v[64:79], a[196:199], a[216:219], v[64:79]
    s_waitcnt vmcnt(2)
    v_mfma_f32_32x32x16_bf16 v[48:63], a[192:195], a[220:223], v[48:63]
    v_mfma_f32_32x32x16_bf16 v[80:95], a[196:199], a[220:223], v[80:95]
    s_cmp_ge_u32 s3, 2
    s_cbranch_scc1 ffn_esk25
    s_waitcnt vmcnt(1)
    v_mfma_f32_32x32x16_bf16 v[32:47], a[200:203], a[224:227], v[32:47]
    v_mfma_f32_32x32x16_bf16 v[64:79], a[204:207], a[224:227], v[64:79]
    s_waitcnt vmcnt(0)
    v_mfma_f32_32x32x16_bf16 v[48:63], a[200:203], a[228:231], v[48:63]
    v_mfma_f32_32x32x16_bf16 v[80:95], a[204:207], a[228:231], v[80:95]
ffn_esk25:
    s_nop 15
    s_nop 3
    s_cmp_eq_u32 s3, 0
    s_cbranch_scc1 ffn_eo27
    ds_write_b128 v20, v[32:35] offset:0
    ds_write_b128 v20, v[36:39] offset:1024
    ds_write_b128 v20, v[40:43] offset:2048
    ds_write_b128 v20, v[44:47] offset:3072
    s_branch ffn_ew26
ffn_eo27:
    v_mov_b32 v104, v32
    v_mov_b32 v105, v33
    v_mov_b32 v106, v34
    v_mov_b32 v107, v35
    v_mov_b32 v108, v36
    v_mov_b32 v109, v37
    v_mov_b32 v110, v38
    v_mov_b32 v111, v39
    v_mov_b32 v112, v40
    v_mov_b32 v113, v41
    v_mov_b32 v114, v42
    v_mov_b32 v115, v43
    v_mov_b32 v116, v44
    v_mov_b32 v117, v45
    v_mov_b32 v118, v46
    v_mov_b32 v119, v47
ffn_ew26:
    s_cmp_eq_u32 s3, 1
    s_cbranch_scc1 ffn_eo29
    ds_write_b128 v21, v[48:51] offset:0
    ds_write_b128 v21, v[52:55] offset:1024
    ds_write_b128 v21, v[56:59] offset:2048
    ds_write_b128 v21, v[60:63] offset:3072
    s_branch ffn_ew28
ffn_eo29:
    v_mov_b32 v104, v48
    v_mov_b32 v105, v49
    v_mov_b32 v106, v50
    v_mov_b32 v107, v51
    v_mov_b32 v108, v52
    v_mov_b32 v109, v53
    v_mov_b32 v110, v54
    v_mov_b32 v111, v55
    v_mov_b32 v112, v56
    v_mov_b32 v113, v57
    v_mov_b32 v114, v58
    v_mov_b32 v115, v59
    v_mov_b32 v116, v60
    v_mov_b32 v117, v61
    v_mov_b32 v118, v62
    v_mov_b32 v119, v63
ffn_ew28:
    s_cmp_eq_u32 s3, 2
    s_cbranch_scc1 ffn_eo31
    ds_write_b128 v22, v[64:67] offset:0
    ds_write_b128 v22, v[68:71] offset:1024
    ds_write_b128 v22, v[72:75] offset:2048
    ds_write_b128 v22, v[76:79] offset:3072
    s_branch ffn_ew30
ffn_eo31:
    v_mov_b32 v104, v64
    v_mov_b32 v105, v65
    v_mov_b32 v106, v66
    v_mov_b32 v107, v67
    v_mov_b32 v108, v68
    v_mov_b32 v109, v69
    v_mov_b32 v110, v70
    v_mov_b32 v111, v71
    v_mov_b32 v112, v72
    v_mov_b32 v113, v73
    v_mov_b32 v114, v74
    v_mov_b32 v115, v75
    v_mov_b32 v116, v76
    v_mov_b32 v117, v77
    v_mov_b32 v118, v78
    v_mov_b32 v119, v79
ffn_ew30:
    s_cmp_eq_u32 s3, 3
    s_cbranch_scc1 ffn_eo33
    ds_write_b128 v23, v[80:83] offset:0
    ds_write_b128 v23, v[84:87] offset:1024
    ds_write_b128 v23, v[88:91] offset:2048
    ds_write_b128 v23, v[92:95] offset:3072
    s_branch ffn_ew32
ffn_eo33:
    v_mov_b32 v104, v80
    v_mov_b32 v105, v81
    v_mov_b32 v106, v82
    v_mov_b32 v107, v83
    v_mov_b32 v108, v84
    v_mov_b32 v109, v85
    v_mov_b32 v110, v86
    v_mov_b32 v111, v87
    v_mov_b32 v112, v88
    v_mov_b32 v113, v89
    v_mov_b32 v114, v90
    v_mov_b32 v115, v91
    v_mov_b32 v116, v92
    v_mov_b32 v117, v93
    v_mov_b32 v118, v94
    v_mov_b32 v119, v95
ffn_ew32:
    s_waitcnt lgkmcnt(0)
    s_barrier
    ds_read_b128 v[120:123], v24 offset:0
    ds_read_b128 v[124:127], v24 offset:1024
    ds_read_b128 v[128:131], v24 offset:2048
    ds_read_b128 v[132:135], v24 offset:3072
    ds_read_b128 v[136:139], v24 offset:4096
    ds_read_b128 v[140:143], v24 offset:5120
    ds_read_b128 v[144:147], v24 offset:6144
    ds_read_b128 v[148:151], v24 offset:7168
    ds_read_b128 v[152:155], v24 offset:8192
    ds_read_b128 v[156:159], v24 offset:9216
    ds_read_b128 v[160:163], v24 offset:10240
    ds_read_b128 v[164:167], v24 offset:11264
    s_waitcnt lgkmcnt(8)
    v_add_f32 v104, v104, v120
    v_add_f32 v105, v105, v121
    v_add_f32 v106, v106, v122
    v_add_f32 v107, v107, v123
    v_add_f32 v108, v108, v124
    v_add_f32 v109, v109, v125
    v_add_f32 v110, v110, v126
    v_add_f32 v111, v111, v127
    v_add_f32 v112, v112, v128
    v_add_f32 v113, v113, v129
    v_add_f32 v114, v114, v130
    v_add_f32 v115, v115, v131
    v_add_f32 v116, v116, v132
    v_add_f32 v117, v117, v133
    v_add_f32 v118, v118, v134
    v_add_f32 v119, v119, v135
    s_waitcnt lgkmcnt(4)
    v_add_f32 v104, v104, v136
    v_add_f32 v105, v105, v137
    v_add_f32 v106, v106, v138
    v_add_f32 v107, v107, v139
    v_add_f32 v108, v108, v140
    v_add_f32 v109, v109, v141
    v_add_f32 v110, v110, v142
    v_add_f32 v111, v111, v143
    v_add_f32 v112, v112, v144
    v_add_f32 v113, v113, v145
    v_add_f32 v114, v114, v146
    v_add_f32 v115, v115, v147
    v_add_f32 v116, v116, v148
    v_add_f32 v117, v117, v149
    v_add_f32 v118, v118, v150
    v_add_f32 v119, v119, v151
    s_waitcnt lgkmcnt(0)
    v_add_f32 v104, v104, v152
    v_add_f32 v105, v105, v153
    v_add_f32 v106, v106, v154
    v_add_f32 v107, v107, v155
    v_add_f32 v108, v108, v156
    v_add_f32 v109, v109, v157
    v_add_f32 v110, v110, v158
    v_add_f32 v111, v111, v159
    v_add_f32 v112, v112, v160
    v_add_f32 v113, v113, v161
    v_add_f32 v114, v114, v162
    v_add_f32 v115, v115, v163
    v_add_f32 v116, v116, v164
    v_add_f32 v117, v117, v165
    v_add_f32 v118, v118, v166
    v_add_f32 v119, v119, v167
    s_waitcnt vmcnt(0)
    s_nop 15
    v_lshlrev_b32 v200, 16, v96
    v_and_b32 v201, 0xffff0000, v96
    v_add_f32 v104, v104, v200
    v_add_f32 v105, v105, v201
    v_lshlrev_b32 v200, 16, v97
    v_and_b32 v201, 0xffff0000, v97
    v_add_f32 v106, v106, v200
    v_add_f32 v107, v107, v201
    v_lshlrev_b32 v200, 16, v98
    v_and_b32 v201, 0xffff0000, v98
    v_add_f32 v108, v108, v200
    v_add_f32 v109, v109, v201
    v_lshlrev_b32 v200, 16, v99
    v_and_b32 v201, 0xffff0000, v99
    v_add_f32 v110, v110, v200
    v_add_f32 v111, v111, v201
    v_lshlrev_b32 v200, 16, v100
    v_and_b32 v201, 0xffff0000, v100
    v_add_f32 v112, v112, v200
    v_add_f32 v113, v113, v201
    v_lshlrev_b32 v200, 16, v101
    v_and_b32 v201, 0xffff0000, v101
    v_add_f32 v114, v114, v200
    v_add_f32 v115, v115, v201
    v_lshlrev_b32 v200, 16, v102
    v_and_b32 v201, 0xffff0000, v102
    v_add_f32 v116, v116, v200
    v_add_f32 v117, v117, v201
    v_lshlrev_b32 v200, 16, v103
    v_and_b32 v201, 0xffff0000, v103
    v_add_f32 v118, v118, v200
    v_add_f32 v119, v119, v201
    v_cvt_pk_bf16_f32 v96, v104, v105
    v_cvt_pk_bf16_f32 v97, v106, v107
    v_cvt_pk_bf16_f32 v98, v108, v109
    v_cvt_pk_bf16_f32 v99, v110, v111
    v_cvt_pk_bf16_f32 v100, v112, v113
    v_cvt_pk_bf16_f32 v101, v114, v115
    v_cvt_pk_bf16_f32 v102, v116, v117
    v_cvt_pk_bf16_f32 v103, v118, v119
    buffer_store_dwordx2 v[96:97], v12, s[16:19], s59 offen offset:0
    buffer_store_dwordx2 v[98:99], v12, s[16:19], s59 offen offset:16
    buffer_store_dwordx2 v[100:101], v12, s[16:19], s59 offen offset:32
    buffer_store_dwordx2 v[102:103], v12, s[16:19], s59 offen offset:48
ffn_end1:
    s_endpgm
.section .rodata,"a"
.p2align 6
.amdhsa_kernel sequential_preLN__grouped_kv_mqa__swiglu_ffn__prompt_kernel
  .amdhsa_next_free_vgpr 256
  .amdhsa_next_free_sgpr 102
  .amdhsa_accum_offset 256
  .amdhsa_group_segment_fixed_size 0
  .amdhsa_kernarg_size 96
  .amdhsa_user_sgpr_count 2
  .amdhsa_user_sgpr_kernarg_segment_ptr 1
  .amdhsa_system_sgpr_workgroup_id_x 1
.end_amdhsa_kernel
.p2align 6
.amdhsa_kernel attn_kernel
  .amdhsa_next_free_vgpr 128
  .amdhsa_next_free_sgpr 102
  .amdhsa_accum_offset 128
  .amdhsa_group_segment_fixed_size 0
  .amdhsa_kernarg_size 96
  .amdhsa_user_sgpr_count 2
  .amdhsa_user_sgpr_kernarg_segment_ptr 1
  .amdhsa_system_sgpr_workgroup_id_x 1
.end_amdhsa_kernel
.p2align 6
.amdhsa_kernel ffn_kernel
  .amdhsa_next_free_vgpr 512
  .amdhsa_next_free_sgpr 102
  .amdhsa_accum_offset 256
  .amdhsa_group_segment_fixed_size 0
  .amdhsa_kernarg_size 96
  .amdhsa_user_sgpr_count 2
  .amdhsa_user_sgpr_kernarg_segment_ptr 1
  .amdhsa_system_sgpr_workgroup_id_x 1
.end_amdhsa_kernel
```
